```python
import torch

def _softmax(x, axis=-1):
    return torch.softmax(x, dim=axis)
def _gelu(x):
    return torch.nn.functional.gelu(x, approximate="tanh")
def _silu(x):
    return torch.nn.functional.silu(x)
def _sigmoid(x):
    return torch.sigmoid(x)
def _layernorm(x, axis=-1, eps=1e-5):
    m = x.mean(dim=axis, keepdim=True)
    v = x.var(dim=axis, keepdim=True, unbiased=False)
    return (x - m) / torch.sqrt(v + eps)
def _scatter_add(tgt, idx, src, axis=0):
    return tgt.clone().index_add_(axis, idx, src)
def _segment_sum(src, seg, n):
    out = torch.zeros((n,) + src.shape[1:], dtype=src.dtype)
    return out.index_add_(0, seg, src)
def _pad(x, pw):
    flat = tuple(v for pair in reversed(pw) for v in pair)
    return torch.nn.functional.pad(x, flat)

kernel_name = 'standalone__gqa_block_cached__near_ridge'

def setup_inputs():

    _w = (lambda a: (lambda t: t.to(torch.bfloat16) if t.is_floating_point() else t)(torch.as_tensor(a)))
    B, Sq, D = 8, 112, 448
    Hq, Hkv, Sk, Dh = 16, 8, 512, 256
    assert Hq % Hkv == 0, (Hq, Hkv)
    return {
        "x": _w((lambda *s: torch.randn(*s, dtype=torch.bfloat16) * 0.8)(B, Sq, D)),
        "k_cache": _w((lambda *s: torch.randn(*s, dtype=torch.bfloat16) * 0.8)(B, Hkv, Sk, Dh)),
        "v_cache": _w((lambda *s: torch.randn(*s, dtype=torch.bfloat16) * 0.05)(B, Hkv, Sk, Dh)),
        "wq": _w((lambda *s: torch.randn(*s, dtype=torch.bfloat16) * 0.8)(D, Hq * Dh) * (D ** -0.5)),
        "wo": _w((lambda *s: torch.randn(*s, dtype=torch.bfloat16) * 0.05)(Hq * Dh, D) * ((Hq * Dh) ** -0.5)),
    }

def reference(x, k_cache, v_cache, wq, wo):
    B, Sq, D = x.shape
    Hq, Dh = 16, 256
    Hkv = k_cache.shape[1]
    rep = Hq // Hkv
    q = (lambda x, *d: x.permute(*d))((x @ wq).reshape(B, Sq, Hq, Dh), 0, 2, 1, 3)
    k = (lambda x, n, axis: torch.repeat_interleave(x, n, dim=axis))(k_cache, rep, axis=1)
    v = (lambda x, n, axis: torch.repeat_interleave(x, n, dim=axis))(v_cache, rep, axis=1)
    scores = torch.einsum("bhqd,bhkd->bhqk", q, k) * (Dh ** -0.5)
    p = _softmax(scores, axis=-1)
    o = torch.einsum("bhqk,bhkd->bhqd", p, v)
    return (lambda x, *d: x.permute(*d))(o, 0, 2, 1, 3).reshape(B, Sq, Hq * Dh) @ wo
```

```asm
; @launch grid=(256,1,1) block=(256,1,1) lds=163840
.amdgcn_target "amdgcn-amd-amdhsa--gfx950"
.text
.globl standalone__gqa_block_cached__near_ridge_kernel
.p2align 8
.type standalone__gqa_block_cached__near_ridge_kernel,@function
standalone__gqa_block_cached__near_ridge_kernel:
  s_cmp_ge_u32 s2, 256
  s_cbranch_scc1 L_end
  s_load_dwordx4 s[4:7], s[0:1], 0
  s_load_dwordx4 s[8:11], s[0:1], 16
  s_load_dwordx8 s[84:91], s[0:1], 32
  v_lshrrev_b32 v112, 6, v0
  v_and_b32 v1, 63, v0
  v_readfirstlane_b32 s45, v112
  v_lshlrev_b32 v29, 4, v1
  s_getpc_b64 s[14:15]
L_pc:
  s_lshr_b32 s52, s2, 1
  s_and_b32 s52, s52, 60
  s_add_u32 s52, s52, s45
  s_lshl_b32 s52, s52, 10
  s_min_u32 s52, s52, L_end-L_pc-1024
  s_add_u32 s14, s14, s52
  s_addc_u32 s15, s15, 0
  v_mov_b32 v113, s15
  v_add_co_u32 v112, vcc, s14, v29
  s_nop 1
  v_addc_co_u32 v113, vcc, 0, v113, vcc
  global_load_dwordx4 a[128:131], v[112:113], off
  s_and_b32 s40, s2, 7
  s_lshr_b32 s41, s2, 5
  s_bfe_u32 s42, s2, 0x10004
  s_bfe_u32 s43, s2, 0x10003
  s_lshl_b32 s44, s40, 1
  s_add_u32 s44, s44, s42
  s_mul_i32 s46, s45, 40960
  s_mul_i32 s75, s42, 3
  s_add_u32 s75, s75, s41
  s_add_u32 s75, s75, s40
  s_sub_u32 s52, s75, 7
  s_cmp_ge_u32 s75, 7
  s_cselect_b32 s75, s52, s75
  s_sub_u32 s52, s75, 7
  s_cmp_ge_u32 s75, 7
  s_cselect_b32 s75, s52, s75
  s_bfe_u32 s49, s2, 0x20003
  s_add_u32 s49, s49, s45
  s_and_b32 s49, s49, 3
  s_lshl_b32 s58, s49, 7
  v_lshrrev_b32 v112, 3, v1
  v_and_b32 v113, 7, v1
  v_lshrrev_b32 v114, 1, v112
  v_xor_b32 v115, v113, v114
  v_lshlrev_b32 v115, 4, v115
  v_xor_b32 v116, 64, v115
  v_lshlrev_b32 v117, 1, v114
  v_xor_b32 v117, v113, v117
  v_lshlrev_b32 v117, 4, v117
  v_mul_u32_u24 v118, 896, v112
  v_add_u32 v22, v118, v115
  v_add_u32 v23, v118, v116
  v_add_u32 v23, 6144, v23
  v_add_u32 v24, v118, v117
  v_lshrrev_b32 v118, 2, v112
  v_lshlrev_b32 v118, 3, v118
  v_and_b32 v119, 3, v112
  v_add_u32 v118, v118, v119
  v_lshlrev_b32 v118, 13, v118
  v_add_u32 v10, v118, v117
  v_add_u32 v11, 130048, v10
  v_add_u32 v12, 32768, v10
  v_add_u32 v13, 162816, v10
  s_mul_i32 s59, s45, 14336
  s_lshl_b32 s60, s75, 7
  s_add_u32 s60, s60, s59
  s_lshl_b32 s67, s75, 19
  s_add_u32 s67, s67, s58
  s_add_u32 s75, s75, 1
  s_cmp_eq_u32 s75, 7
  s_cselect_b32 s75, 0, s75
  s_lshl_b32 s61, s75, 7
  s_add_u32 s61, s61, s59
  s_lshl_b32 s68, s75, 19
  s_add_u32 s68, s68, s58
  s_add_u32 s75, s75, 1
  s_cmp_eq_u32 s75, 7
  s_cselect_b32 s75, 0, s75
  s_lshl_b32 s62, s75, 7
  s_add_u32 s62, s62, s59
  s_lshl_b32 s69, s75, 19
  s_add_u32 s69, s69, s58
  s_add_u32 s75, s75, 1
  s_cmp_eq_u32 s75, 7
  s_cselect_b32 s75, 0, s75
  s_mul_i32 s16, s41, 112
  s_lshl_b32 s53, s43, 6
  s_add_u32 s16, s16, s53
  s_mul_i32 s16, s16, 896
  s_mul_i32 s53, s43, 14336
  s_sub_u32 s18, 57344, s53
  s_mov_b32 s19, 0x20000
  s_lshl_b32 s28, s44, 9
  s_sub_u32 s30, 3670016, s28
  s_mov_b32 s31, 0x20000
  s_waitcnt lgkmcnt(0)
  s_add_u32 s16, s4, s16
  s_addc_u32 s17, s5, 0
  s_add_u32 s28, s10, s28
  s_addc_u32 s29, s11, 0
  s_add_u32 m0, s46, 0
  s_nop 0
  buffer_load_dwordx4 v22, s[16:19], s60 offen lds
  buffer_load_dwordx4 v23, s[16:19], s60 offen offset:1024 lds
  s_add_u32 m0, s46, 32768
  s_nop 0
  buffer_load_dwordx4 v10, s[28:31], s67 offen lds
  buffer_load_dwordx4 v11, s[28:31], s67 offen offset:1024 lds
  s_add_u32 m0, s46, 34816
  s_nop 0
  buffer_load_dwordx4 v12, s[28:31], s67 offen lds
  buffer_load_dwordx4 v13, s[28:31], s67 offen offset:1024 lds
  s_mov_b32 s36, s90
  s_mov_b32 s37, s91
  s_mov_b32 s38, 14778496
  s_mov_b32 s39, 0x20000
  v_mov_b32 v8, 0
  s_mov_b32 s74, 14778368
  s_or_b32 s52, s2, s45
  s_cmp_lg_u32 s52, 0
  s_cbranch_scc1 L_nold
  buffer_load_dword v4, v8, s[36:39], s74 offen sc1
L_nold:
  s_add_u32 m0, s46, 36864
  s_add_u32 s51, s67, 262144
  buffer_load_dwordx4 v10, s[28:31], s51 offen lds
  buffer_load_dwordx4 v11, s[28:31], s51 offen offset:1024 lds
  s_add_u32 m0, s46, 38912
  s_nop 0
  buffer_load_dwordx4 v12, s[28:31], s51 offen lds
  buffer_load_dwordx4 v13, s[28:31], s51 offen offset:1024 lds
  s_add_u32 m0, s46, 2048
  s_nop 0
  buffer_load_dwordx4 v22, s[16:19], s61 offen lds
  buffer_load_dwordx4 v23, s[16:19], s61 offen offset:1024 lds
  s_lshl_b32 s63, s75, 7
  s_add_u32 s63, s63, s59
  s_lshl_b32 s70, s75, 19
  s_add_u32 s70, s70, s58
  s_add_u32 s75, s75, 1
  s_cmp_eq_u32 s75, 7
  s_cselect_b32 s75, 0, s75
  s_lshl_b32 s64, s75, 7
  s_add_u32 s64, s64, s59
  s_lshl_b32 s71, s75, 19
  s_add_u32 s71, s71, s58
  s_add_u32 s75, s75, 1
  s_cmp_eq_u32 s75, 7
  s_cselect_b32 s75, 0, s75
  s_lshl_b32 s65, s75, 7
  s_add_u32 s65, s65, s59
  s_lshl_b32 s72, s75, 19
  s_add_u32 s72, s72, s58
  s_add_u32 s75, s75, 1
  s_cmp_eq_u32 s75, 7
  s_cselect_b32 s75, 0, s75
  s_lshl_b32 s66, s75, 7
  s_add_u32 s66, s66, s59
  s_lshl_b32 s73, s75, 19
  s_add_u32 s73, s73, s58
  v_lshrrev_b32 v120, 4, v1
  v_and_b32 v121, 15, v1
  v_and_b32 v122, 3, v1
  v_lshrrev_b32 v123, 2, v1
  v_lshrrev_b32 v124, 1, v123
  v_and_b32 v124, 3, v124
  v_lshlrev_b32 v124, 5, v124
  v_lshlrev_b32 v118, 7, v123
  v_lshl_add_u32 v125, v122, 3, v118
  v_add_u32 v118, s46, v125
  v_xor_b32 v119, 0, v124
  v_add_u32 v31, v118, v119
  v_xor_b32 v119, 32, v124
  v_add_u32 v32, v118, v119
  v_xor_b32 v119, 64, v124
  v_add_u32 v33, v118, v119
  v_xor_b32 v119, 96, v124
  v_add_u32 v34, v118, v119
  v_lshlrev_b32 v118, 7, v121
  v_lshrrev_b32 v119, 1, v121
  v_xor_b32 v119, v120, v119
  v_lshl_add_u32 v37, v119, 4, v118
  v_xor_b32 v39, 64, v37
  v_add_u32 v35, s46, v37
  v_add_u32 v36, s46, v39
  v_add_u32 v38, 81920, v37
  v_add_u32 v40, 81920, v39
  s_mul_i32 s75, s41, 8
  s_add_u32 s75, s75, s40
  s_lshl_b32 s75, s75, 18
  s_add_u32 s20, s6, s75
  s_addc_u32 s21, s7, 0
  s_mov_b32 s22, 262144
  s_mov_b32 s23, 0x20000
  s_add_u32 s24, s8, s75
  s_addc_u32 s25, s9, 0
  s_mov_b32 s26, 262144
  s_mov_b32 s27, 0x20000
  s_mul_i32 s75, s44, 229376
  s_add_u32 s32, s84, s75
  s_addc_u32 s33, s85, 0
  s_mov_b32 s34, 229376
  s_mov_b32 s35, 0x20000
  s_mov_b32 s76, s86
  s_mov_b32 s77, s87
  s_mov_b32 s78, 802816
  s_mov_b32 s79, 0x20000
  s_mov_b32 s80, s88
  s_mov_b32 s81, s89
  s_mov_b32 s82, 256
  s_mov_b32 s83, 0x20000
  s_add_u32 m0, s46, 4096
  s_nop 0
  buffer_load_dwordx4 v22, s[16:19], s62 offen lds
  buffer_load_dwordx4 v23, s[16:19], s62 offen offset:1024 lds
  s_add_u32 m0, s46, 6144
  s_nop 0
  buffer_load_dwordx4 v22, s[16:19], s63 offen lds
  buffer_load_dwordx4 v23, s[16:19], s63 offen offset:1024 lds
  s_add_u32 m0, s46, 16384
  s_nop 0
  buffer_load_dwordx4 v10, s[28:31], s68 offen lds
  s_lshl_b32 s56, s45, 16
  s_add_u32 s4, s58, 0
  s_and_b32 s4, s4, 0x180
  s_add_u32 s4, s4, s56
  s_add_u32 s5, s58, 128
  s_and_b32 s5, s5, 0x180
  s_add_u32 s5, s5, s56
  s_add_u32 s6, s58, 256
  s_and_b32 s6, s6, 0x180
  s_add_u32 s6, s6, s56
  s_add_u32 s7, s58, 384
  s_and_b32 s7, s7, 0x180
  s_add_u32 s7, s7, s56
  s_lshl_b32 s57, s49, 7
  s_add_u32 s57, s57, s56
  s_mul_i32 s12, s49, 57344
  s_mov_b32 s54, 0x3db8aa3b
  s_mov_b32 s55, s54
  v_lshlrev_b32 v118, 9, v112
  v_add_u32 v14, v118, v117
  v_add_u32 v15, 3072, v14
  v_add_u32 v16, 8192, v14
  v_add_u32 v17, 11264, v14
  v_add_u32 v18, v118, v115
  v_add_u32 v19, v118, v116
  v_add_u32 v19, 3072, v19
  v_add_u32 v20, 8192, v18
  v_add_u32 v21, 8192, v19
  v_add_u32 v25, 6144, v24
  v_add_u32 v26, 14336, v24
  v_add_u32 v27, 20480, v24
  s_lshl_b32 s75, s45, 5
  v_xor_b32 v119, s75, v124
  v_add_u32 v119, v125, v119
  v_add_u32 v41, s46, v29
  v_add_u32 v49, s46, v119
  s_add_u32 s75, s45, 1
  s_and_b32 s75, s75, 3
  s_mul_i32 s75, s75, 40960
  v_add_u32 v42, s75, v29
  v_add_u32 v50, s75, v119
  s_add_u32 s75, s45, 2
  s_and_b32 s75, s75, 3
  s_mul_i32 s75, s75, 40960
  v_add_u32 v43, s75, v29
  v_add_u32 v51, s75, v119
  s_add_u32 s75, s45, 3
  s_and_b32 s75, s75, 3
  s_mul_i32 s75, s75, 40960
  v_add_u32 v44, s75, v29
  v_add_u32 v52, s75, v119
  v_lshrrev_b32 v118, 1, v120
  v_lshl_add_u32 v118, v118, 4, v121
  v_lshlrev_b32 v118, 4, v118
  v_and_b32 v119, 1, v120
  v_lshl_add_u32 v118, v119, 3, v118
  v_add_u32 v45, s46, v118
  v_lshlrev_b32 v119, 1, v119
  v_lshrrev_b32 v118, 1, v120
  v_add_u32 v118, v118, v119
  v_lshl_add_u32 v118, v118, 4, v121
  v_lshlrev_b32 v118, 4, v118
  s_lshl_b32 s75, s45, 2
  v_add_u32 v47, s75, v118
  s_lshl_b32 s14, 15, s75
  s_mov_b32 s15, 0
  v_lshlrev_b32 v48, 4, v121
  buffer_load_dwordx4 v11, s[28:31], s68 offen offset:1024 lds
  s_add_u32 m0, s46, 18432
  s_nop 0
  buffer_load_dwordx4 v12, s[28:31], s68 offen lds
  buffer_load_dwordx4 v13, s[28:31], s68 offen offset:1024 lds
  s_add_u32 m0, s46, 20480
  s_add_u32 s51, s68, 262144
  buffer_load_dwordx4 v10, s[28:31], s51 offen lds
  buffer_load_dwordx4 v11, s[28:31], s51 offen offset:1024 lds
  v_and_b32 v118, 1, v112
  v_lshlrev_b32 v118, 9, v118
  v_lshl_add_u32 v119, v120, 3, v113
  v_lshl_add_u32 v28, v119, 4, v118
  v_lshrrev_b32 v118, 5, v1
  v_mul_u32_u24 v118, 512, v118
  v_add_u32 v30, v118, v29
  v_lshrrev_b32 v118, 5, v1
  v_lshl_add_u32 v118, v118, 4, v113
  v_mul_u32_u24 v118, 896, v118
  v_and_b32 v119, 3, v112
  v_lshl_add_u32 v6, v119, 3, v118
  v_lshlrev_b32 v7, 3, v121
  v_lshlrev_b32 v9, 7, v1
  s_lshl_b32 s75, s41, 1
  s_add_u32 s75, s75, s43
  s_lshl_b32 s13, s75, 2
  s_add_u32 s13, s13, s45
  s_mul_i32 s13, s13, 3584
  s_mul_i32 s97, s75, 917504
  s_mul_i32 s96, s45, 32768
  s_add_u32 s96, s96, s97
  s_mul_i32 s52, s44, 1024
  s_add_u32 s96, s96, s52
  s_lshr_b32 s52, s44, 2
  s_lshl_b32 s52, s52, 4
  s_and_b32 s47, s44, 3
  s_add_u32 s47, s47, s52
  s_lshl_b32 s52, s45, 2
  s_add_u32 s47, s47, s52
  s_lshl_b32 s53, s41, 1
  s_add_u32 s53, s53, s44
  s_and_b32 s53, s53, 15
  s_lshr_b32 s52, s53, 2
  s_lshl_b32 s52, s52, 4
  s_and_b32 s48, s53, 3
  s_add_u32 s48, s48, s52
  s_lshl_b32 s52, s45, 2
  s_add_u32 s48, s48, s52
  s_add_u32 s48, s48, 64
  s_mov_b32 s98, s97
  s_mul_i32 s99, s41, 112
  s_lshl_b32 s52, s43, 6
  s_add_u32 s99, s99, s52
  s_mul_i32 s99, s99, 896
  s_mov_b32 s100, s99
  s_lshr_b32 s52, s47, 1
  s_mul_i32 s52, s52, 16384
  s_add_u32 s97, s97, s52
  s_and_b32 s52, s47, 1
  s_lshl_b32 s53, s52, 9
  s_add_u32 s97, s97, s53
  s_mul_i32 s52, s52, 7168
  s_add_u32 s99, s99, s52
  s_and_b32 s52, s47, 2
  s_mul_i32 s52, s52, 14336
  s_add_u32 s99, s99, s52
  s_lshr_b32 s52, s47, 2
  s_lshl_b32 s52, s52, 5
  s_add_u32 s99, s99, s52
  s_lshr_b32 s52, s48, 1
  s_mul_i32 s52, s52, 16384
  s_add_u32 s98, s98, s52
  s_and_b32 s52, s48, 1
  s_lshl_b32 s53, s52, 9
  s_add_u32 s98, s98, s53
  s_mul_i32 s52, s52, 7168
  s_add_u32 s100, s100, s52
  s_and_b32 s52, s48, 2
  s_mul_i32 s52, s52, 14336
  s_add_u32 s100, s100, s52
  s_lshr_b32 s52, s48, 2
  s_lshl_b32 s52, s52, 5
  s_add_u32 s100, s100, s52
  s_lshl_b32 s3, s75, 11
  s_add_u32 s3, s3, 14680064
  s_lshl_b32 s52, s44, 7
  s_add_u32 s101, s3, s52
  s_lshl_b32 s52, s44, 3
  s_add_u32 s3, s3, s52
  s_add_u32 s59, s101, 32768
  s_mov_b32 s50, 200000
  s_waitcnt vmcnt(10)
  s_or_b32 s52, s2, s45
  s_cmp_lg_u32 s52, 0
  s_cbranch_scc1 L_nonon
  s_mov_b32 s52, 1664525
  v_mul_lo_u32 v4, v4, s52
  v_add_u32 v4, 1013904223, v4
  v_mov_b32 v5, 1
  s_mov_b64 exec, 1
  buffer_store_dwordx2 v[4:5], v8, s[80:83], 0 offen sc1
  buffer_store_dword v4, v8, s[36:39], s74 offen sc1
  s_mov_b64 exec, -1
L_nonon:
  s_bfe_u32 s52, s2, 65539
  s_cmp_eq_u32 s52, 1
  s_cbranch_scc1 L_body1
L_body0:
  s_barrier
  ds_read_b64_tr_b16 v[64:65], v31 offset:32768
  ds_read_b128 v[80:83], v37 offset:0
  ds_read_b64_tr_b16 v[66:67], v31 offset:34816
  ds_read_b128 v[84:87], v37 offset:40960
  ds_read_b64_tr_b16 v[68:69], v32 offset:32768
  ds_read_b128 v[88:91], v38 offset:0
  ds_read_b64_tr_b16 v[70:71], v32 offset:34816
  ds_read_b128 v[92:95], v38 offset:40960
  ds_read_b64_tr_b16 v[72:73], v33 offset:32768
  ds_read_b64_tr_b16 v[74:75], v33 offset:34816
  ds_read_b64_tr_b16 v[76:77], v34 offset:32768
  ds_read_b64_tr_b16 v[78:79], v34 offset:34816
  s_waitcnt lgkmcnt(0)
  v_mfma_f32_16x16x32_bf16 v[128:131], v[64:67], v[80:83], 0
  s_add_u32 m0, s46, 22528
  ds_read_b64_tr_b16 v[96:97], v31 offset:36864
  ds_read_b128 v[112:115], v39 offset:0
  v_mfma_f32_16x16x32_bf16 v[132:135], v[64:67], v[84:87], 0
  buffer_load_dwordx4 v12, s[28:31], s51 offen lds
  v_mfma_f32_16x16x32_bf16 v[136:139], v[64:67], v[88:91], 0
  ds_read_b64_tr_b16 v[98:99], v31 offset:38912
  ds_read_b128 v[116:119], v39 offset:40960
  v_mfma_f32_16x16x32_bf16 v[140:143], v[64:67], v[92:95], 0
  buffer_load_dwordx4 v13, s[28:31], s51 offen offset:1024 lds
  v_mfma_f32_16x16x32_bf16 v[144:147], v[68:71], v[80:83], 0
  s_add_u32 m0, s46, 24576
  ds_read_b64_tr_b16 v[100:101], v32 offset:36864
  ds_read_b128 v[120:123], v40 offset:0
  v_mfma_f32_16x16x32_bf16 v[148:151], v[68:71], v[84:87], 0
  buffer_load_dwordx4 v10, s[28:31], s69 offen lds
  v_mfma_f32_16x16x32_bf16 v[152:155], v[68:71], v[88:91], 0
  ds_read_b64_tr_b16 v[102:103], v32 offset:38912
  ds_read_b128 v[124:127], v40 offset:40960
  v_mfma_f32_16x16x32_bf16 v[156:159], v[68:71], v[92:95], 0
  v_mfma_f32_16x16x32_bf16 v[160:163], v[72:75], v[80:83], 0
  ds_read_b64_tr_b16 v[104:105], v33 offset:36864
  ds_read_b64_tr_b16 v[106:107], v33 offset:38912
  v_mfma_f32_16x16x32_bf16 v[164:167], v[72:75], v[84:87], 0
  buffer_load_dwordx4 v11, s[28:31], s69 offen offset:1024 lds
  v_mfma_f32_16x16x32_bf16 v[168:171], v[72:75], v[88:91], 0
  s_add_u32 m0, s46, 26624
  ds_read_b64_tr_b16 v[108:109], v34 offset:36864
  ds_read_b64_tr_b16 v[110:111], v34 offset:38912
  v_mfma_f32_16x16x32_bf16 v[172:175], v[72:75], v[92:95], 0
  buffer_load_dwordx4 v12, s[28:31], s69 offen lds
  v_mfma_f32_16x16x32_bf16 v[176:179], v[76:79], v[80:83], 0
  v_mfma_f32_16x16x32_bf16 v[180:183], v[76:79], v[84:87], 0
  buffer_load_dwordx4 v13, s[28:31], s69 offen offset:1024 lds
  v_mfma_f32_16x16x32_bf16 v[184:187], v[76:79], v[88:91], 0
  v_mfma_f32_16x16x32_bf16 v[188:191], v[76:79], v[92:95], 0
  s_waitcnt vmcnt(8) lgkmcnt(0)
  v_mfma_f32_16x16x32_bf16 v[128:131], v[96:99], v[112:115], v[128:131]
  s_add_u32 m0, s46, 8192
  ds_read_b64_tr_b16 v[64:65], v31 offset:16384
  ds_read_b128 v[80:83], v37 offset:2048
  v_mfma_f32_16x16x32_bf16 v[132:135], v[96:99], v[116:119], v[132:135]
  buffer_load_dwordx4 v22, s[16:19], s64 offen lds
  v_mfma_f32_16x16x32_bf16 v[136:139], v[96:99], v[120:123], v[136:139]
  ds_read_b64_tr_b16 v[66:67], v31 offset:18432
  ds_read_b128 v[84:87], v37 offset:43008
  v_mfma_f32_16x16x32_bf16 v[140:143], v[96:99], v[124:127], v[140:143]
  buffer_load_dwordx4 v23, s[16:19], s64 offen offset:1024 lds
  v_mfma_f32_16x16x32_bf16 v[144:147], v[100:103], v[112:115], v[144:147]
  s_add_u32 m0, s46, 28672
  s_add_u32 s51, s69, 262144
  ds_read_b64_tr_b16 v[68:69], v32 offset:16384
  ds_read_b128 v[88:91], v38 offset:2048
  v_mfma_f32_16x16x32_bf16 v[148:151], v[100:103], v[116:119], v[148:151]
  buffer_load_dwordx4 v10, s[28:31], s51 offen lds
  v_mfma_f32_16x16x32_bf16 v[152:155], v[100:103], v[120:123], v[152:155]
  ds_read_b64_tr_b16 v[70:71], v32 offset:18432
  ds_read_b128 v[92:95], v38 offset:43008
  v_mfma_f32_16x16x32_bf16 v[156:159], v[100:103], v[124:127], v[156:159]
  v_mfma_f32_16x16x32_bf16 v[160:163], v[104:107], v[112:115], v[160:163]
  ds_read_b64_tr_b16 v[72:73], v33 offset:16384
  ds_read_b64_tr_b16 v[74:75], v33 offset:18432
  v_mfma_f32_16x16x32_bf16 v[164:167], v[104:107], v[116:119], v[164:167]
  buffer_load_dwordx4 v11, s[28:31], s51 offen offset:1024 lds
  v_mfma_f32_16x16x32_bf16 v[168:171], v[104:107], v[120:123], v[168:171]
  s_add_u32 m0, s46, 14336
  ds_read_b64_tr_b16 v[76:77], v34 offset:16384
  ds_read_b64_tr_b16 v[78:79], v34 offset:18432
  v_mfma_f32_16x16x32_bf16 v[172:175], v[104:107], v[124:127], v[172:175]
  buffer_load_dwordx4 v12, s[28:31], s51 offen lds
  v_mfma_f32_16x16x32_bf16 v[176:179], v[108:111], v[112:115], v[176:179]
  v_mfma_f32_16x16x32_bf16 v[180:183], v[108:111], v[116:119], v[180:183]
  buffer_load_dwordx4 v13, s[28:31], s51 offen offset:1024 lds
  v_mfma_f32_16x16x32_bf16 v[184:187], v[108:111], v[120:123], v[184:187]
  v_mfma_f32_16x16x32_bf16 v[188:191], v[108:111], v[124:127], v[188:191]
  s_waitcnt vmcnt(10) lgkmcnt(0)
  v_mfma_f32_16x16x32_bf16 v[128:131], v[64:67], v[80:83], v[128:131]
  s_add_u32 m0, s46, 10240
  ds_read_b64_tr_b16 v[96:97], v31 offset:20480
  ds_read_b128 v[112:115], v39 offset:2048
  v_mfma_f32_16x16x32_bf16 v[132:135], v[64:67], v[84:87], v[132:135]
  buffer_load_dwordx4 v22, s[16:19], s65 offen lds
  v_mfma_f32_16x16x32_bf16 v[136:139], v[64:67], v[88:91], v[136:139]
  ds_read_b64_tr_b16 v[98:99], v31 offset:22528
  ds_read_b128 v[116:119], v39 offset:43008
  v_mfma_f32_16x16x32_bf16 v[140:143], v[64:67], v[92:95], v[140:143]
  buffer_load_dwordx4 v23, s[16:19], s65 offen offset:1024 lds
  v_mfma_f32_16x16x32_bf16 v[144:147], v[68:71], v[80:83], v[144:147]
  s_add_u32 m0, s46, 32768
  ds_read_b64_tr_b16 v[100:101], v32 offset:20480
  ds_read_b128 v[120:123], v40 offset:2048
  v_mfma_f32_16x16x32_bf16 v[148:151], v[68:71], v[84:87], v[148:151]
  buffer_load_dwordx4 v10, s[28:31], s70 offen lds
  v_mfma_f32_16x16x32_bf16 v[152:155], v[68:71], v[88:91], v[152:155]
  ds_read_b64_tr_b16 v[102:103], v32 offset:22528
  ds_read_b128 v[124:127], v40 offset:43008
  v_mfma_f32_16x16x32_bf16 v[156:159], v[68:71], v[92:95], v[156:159]
  v_mfma_f32_16x16x32_bf16 v[160:163], v[72:75], v[80:83], v[160:163]
  ds_read_b64_tr_b16 v[104:105], v33 offset:20480
  ds_read_b64_tr_b16 v[106:107], v33 offset:22528
  v_mfma_f32_16x16x32_bf16 v[164:167], v[72:75], v[84:87], v[164:167]
  buffer_load_dwordx4 v11, s[28:31], s70 offen offset:1024 lds
  v_mfma_f32_16x16x32_bf16 v[168:171], v[72:75], v[88:91], v[168:171]
  s_add_u32 m0, s46, 34816
  ds_read_b64_tr_b16 v[108:109], v34 offset:20480
  ds_read_b64_tr_b16 v[110:111], v34 offset:22528
  v_mfma_f32_16x16x32_bf16 v[172:175], v[72:75], v[92:95], v[172:175]
  buffer_load_dwordx4 v12, s[28:31], s70 offen lds
  v_mfma_f32_16x16x32_bf16 v[176:179], v[76:79], v[80:83], v[176:179]
  v_mfma_f32_16x16x32_bf16 v[180:183], v[76:79], v[84:87], v[180:183]
  buffer_load_dwordx4 v13, s[28:31], s70 offen offset:1024 lds
  v_mfma_f32_16x16x32_bf16 v[184:187], v[76:79], v[88:91], v[184:187]
  v_mfma_f32_16x16x32_bf16 v[188:191], v[76:79], v[92:95], v[188:191]
  s_waitcnt vmcnt(12) lgkmcnt(0)
  s_barrier
  v_mfma_f32_16x16x32_bf16 v[128:131], v[96:99], v[112:115], v[128:131]
  s_add_u32 m0, s46, 12288
  ds_read_b64_tr_b16 v[64:65], v31 offset:24576
  ds_read_b128 v[80:83], v37 offset:4096
  v_mfma_f32_16x16x32_bf16 v[132:135], v[96:99], v[116:119], v[132:135]
  buffer_load_dwordx4 v22, s[16:19], s66 offen lds
  v_mfma_f32_16x16x32_bf16 v[136:139], v[96:99], v[120:123], v[136:139]
  ds_read_b64_tr_b16 v[66:67], v31 offset:26624
  ds_read_b128 v[84:87], v37 offset:45056
  v_mfma_f32_16x16x32_bf16 v[140:143], v[96:99], v[124:127], v[140:143]
  buffer_load_dwordx4 v23, s[16:19], s66 offen offset:1024 lds
  v_mfma_f32_16x16x32_bf16 v[144:147], v[100:103], v[112:115], v[144:147]
  s_add_u32 m0, s46, 36864
  s_add_u32 s51, s70, 262144
  ds_read_b64_tr_b16 v[68:69], v32 offset:24576
  ds_read_b128 v[88:91], v38 offset:4096
  v_mfma_f32_16x16x32_bf16 v[148:151], v[100:103], v[116:119], v[148:151]
  buffer_load_dwordx4 v10, s[28:31], s51 offen lds
  v_mfma_f32_16x16x32_bf16 v[152:155], v[100:103], v[120:123], v[152:155]
  ds_read_b64_tr_b16 v[70:71], v32 offset:26624
  ds_read_b128 v[92:95], v38 offset:45056
  v_mfma_f32_16x16x32_bf16 v[156:159], v[100:103], v[124:127], v[156:159]
  v_mfma_f32_16x16x32_bf16 v[160:163], v[104:107], v[112:115], v[160:163]
  ds_read_b64_tr_b16 v[72:73], v33 offset:24576
  ds_read_b64_tr_b16 v[74:75], v33 offset:26624
  v_mfma_f32_16x16x32_bf16 v[164:167], v[104:107], v[116:119], v[164:167]
  buffer_load_dwordx4 v11, s[28:31], s51 offen offset:1024 lds
  v_mfma_f32_16x16x32_bf16 v[168:171], v[104:107], v[120:123], v[168:171]
  s_add_u32 m0, s46, 38912
  ds_read_b64_tr_b16 v[76:77], v34 offset:24576
  ds_read_b64_tr_b16 v[78:79], v34 offset:26624
  v_mfma_f32_16x16x32_bf16 v[172:175], v[104:107], v[124:127], v[172:175]
  buffer_load_dwordx4 v12, s[28:31], s51 offen lds
  v_mfma_f32_16x16x32_bf16 v[176:179], v[108:111], v[112:115], v[176:179]
  v_mfma_f32_16x16x32_bf16 v[180:183], v[108:111], v[116:119], v[180:183]
  buffer_load_dwordx4 v13, s[28:31], s51 offen offset:1024 lds
  v_mfma_f32_16x16x32_bf16 v[184:187], v[108:111], v[120:123], v[184:187]
  v_mfma_f32_16x16x32_bf16 v[188:191], v[108:111], v[124:127], v[188:191]
  s_waitcnt vmcnt(12) lgkmcnt(0)
  v_mfma_f32_16x16x32_bf16 v[128:131], v[64:67], v[80:83], v[128:131]
  s_add_u32 m0, s46, 16384
  ds_read_b64_tr_b16 v[96:97], v31 offset:28672
  ds_read_b128 v[112:115], v39 offset:4096
  v_mfma_f32_16x16x32_bf16 v[132:135], v[64:67], v[84:87], v[132:135]
  buffer_load_dwordx4 v10, s[28:31], s71 offen lds
  v_mfma_f32_16x16x32_bf16 v[136:139], v[64:67], v[88:91], v[136:139]
  ds_read_b64_tr_b16 v[98:99], v31 offset:14336
  ds_read_b128 v[116:119], v39 offset:45056
  v_mfma_f32_16x16x32_bf16 v[140:143], v[64:67], v[92:95], v[140:143]
  buffer_load_dwordx4 v11, s[28:31], s71 offen offset:1024 lds
  v_mfma_f32_16x16x32_bf16 v[144:147], v[68:71], v[80:83], v[144:147]
  s_add_u32 m0, s46, 18432
  ds_read_b64_tr_b16 v[100:101], v32 offset:28672
  ds_read_b128 v[120:123], v40 offset:4096
  v_mfma_f32_16x16x32_bf16 v[148:151], v[68:71], v[84:87], v[148:151]
  buffer_load_dwordx4 v12, s[28:31], s71 offen lds
  v_mfma_f32_16x16x32_bf16 v[152:155], v[68:71], v[88:91], v[152:155]
  ds_read_b64_tr_b16 v[102:103], v32 offset:14336
  ds_read_b128 v[124:127], v40 offset:45056
  v_mfma_f32_16x16x32_bf16 v[156:159], v[68:71], v[92:95], v[156:159]
  v_mfma_f32_16x16x32_bf16 v[160:163], v[72:75], v[80:83], v[160:163]
  ds_read_b64_tr_b16 v[104:105], v33 offset:28672
  ds_read_b64_tr_b16 v[106:107], v33 offset:14336
  v_mfma_f32_16x16x32_bf16 v[164:167], v[72:75], v[84:87], v[164:167]
  buffer_load_dwordx4 v13, s[28:31], s71 offen offset:1024 lds
  v_mfma_f32_16x16x32_bf16 v[168:171], v[72:75], v[88:91], v[168:171]
  s_add_u32 m0, s46, 20480
  s_add_u32 s51, s71, 262144
  ds_read_b64_tr_b16 v[108:109], v34 offset:28672
  ds_read_b64_tr_b16 v[110:111], v34 offset:14336
  v_mfma_f32_16x16x32_bf16 v[172:175], v[72:75], v[92:95], v[172:175]
  buffer_load_dwordx4 v10, s[28:31], s51 offen lds
  v_mfma_f32_16x16x32_bf16 v[176:179], v[76:79], v[80:83], v[176:179]
  v_mfma_f32_16x16x32_bf16 v[180:183], v[76:79], v[84:87], v[180:183]
  buffer_load_dwordx4 v11, s[28:31], s51 offen offset:1024 lds
  v_mfma_f32_16x16x32_bf16 v[184:187], v[76:79], v[88:91], v[184:187]
  v_mfma_f32_16x16x32_bf16 v[188:191], v[76:79], v[92:95], v[188:191]
  s_waitcnt vmcnt(12) lgkmcnt(0)
  v_mfma_f32_16x16x32_bf16 v[128:131], v[96:99], v[112:115], v[128:131]
  s_add_u32 m0, s46, 22528
  ds_read_b64_tr_b16 v[64:65], v31 offset:32768
  ds_read_b128 v[80:83], v37 offset:6144
  v_mfma_f32_16x16x32_bf16 v[132:135], v[96:99], v[116:119], v[132:135]
  buffer_load_dwordx4 v12, s[28:31], s51 offen lds
  v_mfma_f32_16x16x32_bf16 v[136:139], v[96:99], v[120:123], v[136:139]
  ds_read_b64_tr_b16 v[66:67], v31 offset:34816
  ds_read_b128 v[84:87], v37 offset:47104
  v_mfma_f32_16x16x32_bf16 v[140:143], v[96:99], v[124:127], v[140:143]
  buffer_load_dwordx4 v13, s[28:31], s51 offen offset:1024 lds
  v_mfma_f32_16x16x32_bf16 v[144:147], v[100:103], v[112:115], v[144:147]
  s_add_u32 m0, s46, 24576
  ds_read_b64_tr_b16 v[68:69], v32 offset:32768
  ds_read_b128 v[88:91], v38 offset:6144
  v_mfma_f32_16x16x32_bf16 v[148:151], v[100:103], v[116:119], v[148:151]
  buffer_load_dwordx4 v10, s[28:31], s72 offen lds
  v_mfma_f32_16x16x32_bf16 v[152:155], v[100:103], v[120:123], v[152:155]
  ds_read_b64_tr_b16 v[70:71], v32 offset:34816
  ds_read_b128 v[92:95], v38 offset:47104
  v_mfma_f32_16x16x32_bf16 v[156:159], v[100:103], v[124:127], v[156:159]
  v_mfma_f32_16x16x32_bf16 v[160:163], v[104:107], v[112:115], v[160:163]
  ds_read_b64_tr_b16 v[72:73], v33 offset:32768
  ds_read_b64_tr_b16 v[74:75], v33 offset:34816
  v_mfma_f32_16x16x32_bf16 v[164:167], v[104:107], v[116:119], v[164:167]
  buffer_load_dwordx4 v11, s[28:31], s72 offen offset:1024 lds
  v_mfma_f32_16x16x32_bf16 v[168:171], v[104:107], v[120:123], v[168:171]
  s_add_u32 m0, s46, 26624
  ds_read_b64_tr_b16 v[76:77], v34 offset:32768
  ds_read_b64_tr_b16 v[78:79], v34 offset:34816
  v_mfma_f32_16x16x32_bf16 v[172:175], v[104:107], v[124:127], v[172:175]
  buffer_load_dwordx4 v12, s[28:31], s72 offen lds
  v_mfma_f32_16x16x32_bf16 v[176:179], v[108:111], v[112:115], v[176:179]
  v_mfma_f32_16x16x32_bf16 v[180:183], v[108:111], v[116:119], v[180:183]
  buffer_load_dwordx4 v13, s[28:31], s72 offen offset:1024 lds
  v_mfma_f32_16x16x32_bf16 v[184:187], v[108:111], v[120:123], v[184:187]
  v_mfma_f32_16x16x32_bf16 v[188:191], v[108:111], v[124:127], v[188:191]
  s_waitcnt vmcnt(12) lgkmcnt(0)
  v_mfma_f32_16x16x32_bf16 v[128:131], v[64:67], v[80:83], v[128:131]
  s_add_u32 m0, s46, 28672
  s_add_u32 s51, s72, 262144
  ds_read_b64_tr_b16 v[96:97], v31 offset:36864
  ds_read_b128 v[112:115], v39 offset:6144
  v_mfma_f32_16x16x32_bf16 v[132:135], v[64:67], v[84:87], v[132:135]
  buffer_load_dwordx4 v10, s[28:31], s51 offen lds
  v_mfma_f32_16x16x32_bf16 v[136:139], v[64:67], v[88:91], v[136:139]
  ds_read_b64_tr_b16 v[98:99], v31 offset:38912
  ds_read_b128 v[116:119], v39 offset:47104
  v_mfma_f32_16x16x32_bf16 v[140:143], v[64:67], v[92:95], v[140:143]
  buffer_load_dwordx4 v11, s[28:31], s51 offen offset:1024 lds
  v_mfma_f32_16x16x32_bf16 v[144:147], v[68:71], v[80:83], v[144:147]
  s_add_u32 m0, s46, 14336
  ds_read_b64_tr_b16 v[100:101], v32 offset:36864
  ds_read_b128 v[120:123], v40 offset:6144
  v_mfma_f32_16x16x32_bf16 v[148:151], v[68:71], v[84:87], v[148:151]
  buffer_load_dwordx4 v12, s[28:31], s51 offen lds
  v_mfma_f32_16x16x32_bf16 v[152:155], v[68:71], v[88:91], v[152:155]
  ds_read_b64_tr_b16 v[102:103], v32 offset:38912
  ds_read_b128 v[124:127], v40 offset:47104
  v_mfma_f32_16x16x32_bf16 v[156:159], v[68:71], v[92:95], v[156:159]
  v_mfma_f32_16x16x32_bf16 v[160:163], v[72:75], v[80:83], v[160:163]
  ds_read_b64_tr_b16 v[104:105], v33 offset:36864
  ds_read_b64_tr_b16 v[106:107], v33 offset:38912
  v_mfma_f32_16x16x32_bf16 v[164:167], v[72:75], v[84:87], v[164:167]
  buffer_load_dwordx4 v13, s[28:31], s51 offen offset:1024 lds
  v_mfma_f32_16x16x32_bf16 v[168:171], v[72:75], v[88:91], v[168:171]
  s_add_u32 m0, s46, 32768
  ds_read_b64_tr_b16 v[108:109], v34 offset:36864
  ds_read_b64_tr_b16 v[110:111], v34 offset:38912
  v_mfma_f32_16x16x32_bf16 v[172:175], v[72:75], v[92:95], v[172:175]
  buffer_load_dwordx4 v10, s[28:31], s73 offen lds
  v_mfma_f32_16x16x32_bf16 v[176:179], v[76:79], v[80:83], v[176:179]
  v_mfma_f32_16x16x32_bf16 v[180:183], v[76:79], v[84:87], v[180:183]
  buffer_load_dwordx4 v11, s[28:31], s73 offen offset:1024 lds
  v_mfma_f32_16x16x32_bf16 v[184:187], v[76:79], v[88:91], v[184:187]
  v_mfma_f32_16x16x32_bf16 v[188:191], v[76:79], v[92:95], v[188:191]
  s_waitcnt vmcnt(14) lgkmcnt(0)
  s_barrier
  v_mfma_f32_16x16x32_bf16 v[128:131], v[96:99], v[112:115], v[128:131]
  s_add_u32 m0, s46, 34816
  ds_read_b64_tr_b16 v[64:65], v31 offset:16384
  ds_read_b128 v[80:83], v37 offset:8192
  v_mfma_f32_16x16x32_bf16 v[132:135], v[96:99], v[116:119], v[132:135]
  buffer_load_dwordx4 v12, s[28:31], s73 offen lds
  v_mfma_f32_16x16x32_bf16 v[136:139], v[96:99], v[120:123], v[136:139]
  ds_read_b64_tr_b16 v[66:67], v31 offset:18432
  ds_read_b128 v[84:87], v37 offset:49152
  v_mfma_f32_16x16x32_bf16 v[140:143], v[96:99], v[124:127], v[140:143]
  buffer_load_dwordx4 v13, s[28:31], s73 offen offset:1024 lds
  v_mfma_f32_16x16x32_bf16 v[144:147], v[100:103], v[112:115], v[144:147]
  s_add_u32 m0, s46, 36864
  s_add_u32 s51, s73, 262144
  ds_read_b64_tr_b16 v[68:69], v32 offset:16384
  ds_read_b128 v[88:91], v38 offset:8192
  v_mfma_f32_16x16x32_bf16 v[148:151], v[100:103], v[116:119], v[148:151]
  buffer_load_dwordx4 v10, s[28:31], s51 offen lds
  v_mfma_f32_16x16x32_bf16 v[152:155], v[100:103], v[120:123], v[152:155]
  ds_read_b64_tr_b16 v[70:71], v32 offset:18432
  ds_read_b128 v[92:95], v38 offset:49152
  v_mfma_f32_16x16x32_bf16 v[156:159], v[100:103], v[124:127], v[156:159]
  v_mfma_f32_16x16x32_bf16 v[160:163], v[104:107], v[112:115], v[160:163]
  ds_read_b64_tr_b16 v[72:73], v33 offset:16384
  ds_read_b64_tr_b16 v[74:75], v33 offset:18432
  v_mfma_f32_16x16x32_bf16 v[164:167], v[104:107], v[116:119], v[164:167]
  buffer_load_dwordx4 v11, s[28:31], s51 offen offset:1024 lds
  v_mfma_f32_16x16x32_bf16 v[168:171], v[104:107], v[120:123], v[168:171]
  ds_read_b64_tr_b16 v[76:77], v34 offset:16384
  ds_read_b64_tr_b16 v[78:79], v34 offset:18432
  v_mfma_f32_16x16x32_bf16 v[172:175], v[104:107], v[124:127], v[172:175]
  v_mfma_f32_16x16x32_bf16 v[176:179], v[108:111], v[112:115], v[176:179]
  s_add_u32 m0, s46, 38912
  v_mfma_f32_16x16x32_bf16 v[180:183], v[108:111], v[116:119], v[180:183]
  buffer_load_dwordx4 v12, s[28:31], s51 offen lds
  v_mfma_f32_16x16x32_bf16 v[184:187], v[108:111], v[120:123], v[184:187]
  v_mfma_f32_16x16x32_bf16 v[188:191], v[108:111], v[124:127], v[188:191]
  s_waitcnt vmcnt(15) lgkmcnt(0)
  v_mfma_f32_16x16x32_bf16 v[128:131], v[64:67], v[80:83], v[128:131]
  ds_read_b64_tr_b16 v[96:97], v31 offset:20480
  ds_read_b128 v[112:115], v39 offset:8192
  v_mfma_f32_16x16x32_bf16 v[132:135], v[64:67], v[84:87], v[132:135]
  buffer_load_dwordx4 v13, s[28:31], s51 offen offset:1024 lds
  v_mfma_f32_16x16x32_bf16 v[136:139], v[64:67], v[88:91], v[136:139]
  s_add_u32 m0, s46, 0
  s_add_u32 s51, s4, 0
  ds_read_b64_tr_b16 v[98:99], v31 offset:22528
  ds_read_b128 v[116:119], v39 offset:49152
  v_mfma_f32_16x16x32_bf16 v[140:143], v[64:67], v[92:95], v[140:143]
  buffer_load_dwordx4 v18, s[20:23], s51 offen lds
  v_mfma_f32_16x16x32_bf16 v[144:147], v[68:71], v[80:83], v[144:147]
  ds_read_b64_tr_b16 v[100:101], v32 offset:20480
  ds_read_b128 v[120:123], v40 offset:8192
  v_mfma_f32_16x16x32_bf16 v[148:151], v[68:71], v[84:87], v[148:151]
  buffer_load_dwordx4 v19, s[20:23], s51 offen offset:1024 lds
  v_mfma_f32_16x16x32_bf16 v[152:155], v[68:71], v[88:91], v[152:155]
  ds_read_b64_tr_b16 v[102:103], v32 offset:22528
  ds_read_b128 v[124:127], v40 offset:49152
  v_mfma_f32_16x16x32_bf16 v[156:159], v[68:71], v[92:95], v[156:159]
  v_mfma_f32_16x16x32_bf16 v[160:163], v[72:75], v[80:83], v[160:163]
  s_add_u32 m0, s46, 2048
  ds_read_b64_tr_b16 v[104:105], v33 offset:20480
  ds_read_b64_tr_b16 v[106:107], v33 offset:22528
  v_mfma_f32_16x16x32_bf16 v[164:167], v[72:75], v[84:87], v[164:167]
  buffer_load_dwordx4 v20, s[20:23], s51 offen lds
  v_mfma_f32_16x16x32_bf16 v[168:171], v[72:75], v[88:91], v[168:171]
  ds_read_b64_tr_b16 v[108:109], v34 offset:20480
  ds_read_b64_tr_b16 v[110:111], v34 offset:22528
  v_mfma_f32_16x16x32_bf16 v[172:175], v[72:75], v[92:95], v[172:175]
  v_mfma_f32_16x16x32_bf16 v[176:179], v[76:79], v[80:83], v[176:179]
  v_mfma_f32_16x16x32_bf16 v[180:183], v[76:79], v[84:87], v[180:183]
  buffer_load_dwordx4 v21, s[20:23], s51 offen offset:1024 lds
  v_mfma_f32_16x16x32_bf16 v[184:187], v[76:79], v[88:91], v[184:187]
  v_mfma_f32_16x16x32_bf16 v[188:191], v[76:79], v[92:95], v[188:191]
  s_waitcnt vmcnt(16) lgkmcnt(0)
  v_mfma_f32_16x16x32_bf16 v[128:131], v[96:99], v[112:115], v[128:131]
  s_add_u32 m0, s46, 4096
  s_add_u32 s51, s4, 16384
  ds_read_b64_tr_b16 v[64:65], v31 offset:24576
  ds_read_b128 v[80:83], v37 offset:10240
  v_mfma_f32_16x16x32_bf16 v[132:135], v[96:99], v[116:119], v[132:135]
  buffer_load_dwordx4 v18, s[20:23], s51 offen lds
  v_mfma_f32_16x16x32_bf16 v[136:139], v[96:99], v[120:123], v[136:139]
  ds_read_b64_tr_b16 v[66:67], v31 offset:26624
  ds_read_b128 v[84:87], v37 offset:51200
  v_mfma_f32_16x16x32_bf16 v[140:143], v[96:99], v[124:127], v[140:143]
  buffer_load_dwordx4 v19, s[20:23], s51 offen offset:1024 lds
  v_mfma_f32_16x16x32_bf16 v[144:147], v[100:103], v[112:115], v[144:147]
  s_add_u32 m0, s46, 6144
  ds_read_b64_tr_b16 v[68:69], v32 offset:24576
  ds_read_b128 v[88:91], v38 offset:10240
  v_mfma_f32_16x16x32_bf16 v[148:151], v[100:103], v[116:119], v[148:151]
  buffer_load_dwordx4 v20, s[20:23], s51 offen lds
  v_mfma_f32_16x16x32_bf16 v[152:155], v[100:103], v[120:123], v[152:155]
  ds_read_b64_tr_b16 v[70:71], v32 offset:26624
  ds_read_b128 v[92:95], v38 offset:51200
  v_mfma_f32_16x16x32_bf16 v[156:159], v[100:103], v[124:127], v[156:159]
  v_mfma_f32_16x16x32_bf16 v[160:163], v[104:107], v[112:115], v[160:163]
  ds_read_b64_tr_b16 v[72:73], v33 offset:24576
  ds_read_b64_tr_b16 v[74:75], v33 offset:26624
  v_mfma_f32_16x16x32_bf16 v[164:167], v[104:107], v[116:119], v[164:167]
  buffer_load_dwordx4 v21, s[20:23], s51 offen offset:1024 lds
  v_mfma_f32_16x16x32_bf16 v[168:171], v[104:107], v[120:123], v[168:171]
  ds_read_b64_tr_b16 v[76:77], v34 offset:24576
  ds_read_b64_tr_b16 v[78:79], v34 offset:26624
  v_mfma_f32_16x16x32_bf16 v[172:175], v[104:107], v[124:127], v[172:175]
  v_mfma_f32_16x16x32_bf16 v[176:179], v[108:111], v[112:115], v[176:179]
  v_mfma_f32_16x16x32_bf16 v[180:183], v[108:111], v[116:119], v[180:183]
  v_mfma_f32_16x16x32_bf16 v[184:187], v[108:111], v[120:123], v[184:187]
  v_mfma_f32_16x16x32_bf16 v[188:191], v[108:111], v[124:127], v[188:191]
  s_waitcnt vmcnt(16) lgkmcnt(0)
  v_mfma_f32_16x16x32_bf16 v[128:131], v[64:67], v[80:83], v[128:131]
  ds_read_b64_tr_b16 v[96:97], v31 offset:28672
  ds_read_b128 v[112:115], v39 offset:10240
  v_mfma_f32_16x16x32_bf16 v[132:135], v[64:67], v[84:87], v[132:135]
  v_mfma_f32_16x16x32_bf16 v[136:139], v[64:67], v[88:91], v[136:139]
  ds_read_b64_tr_b16 v[98:99], v31 offset:14336
  ds_read_b128 v[116:119], v39 offset:51200
  v_mfma_f32_16x16x32_bf16 v[140:143], v[64:67], v[92:95], v[140:143]
  v_mfma_f32_16x16x32_bf16 v[144:147], v[68:71], v[80:83], v[144:147]
  ds_read_b64_tr_b16 v[100:101], v32 offset:28672
  ds_read_b128 v[120:123], v40 offset:10240
  v_mfma_f32_16x16x32_bf16 v[148:151], v[68:71], v[84:87], v[148:151]
  v_mfma_f32_16x16x32_bf16 v[152:155], v[68:71], v[88:91], v[152:155]
  ds_read_b64_tr_b16 v[102:103], v32 offset:14336
  ds_read_b128 v[124:127], v40 offset:51200
  v_mfma_f32_16x16x32_bf16 v[156:159], v[68:71], v[92:95], v[156:159]
  v_mfma_f32_16x16x32_bf16 v[160:163], v[72:75], v[80:83], v[160:163]
  ds_read_b64_tr_b16 v[104:105], v33 offset:28672
  ds_read_b64_tr_b16 v[106:107], v33 offset:14336
  v_mfma_f32_16x16x32_bf16 v[164:167], v[72:75], v[84:87], v[164:167]
  v_mfma_f32_16x16x32_bf16 v[168:171], v[72:75], v[88:91], v[168:171]
  ds_read_b64_tr_b16 v[108:109], v34 offset:28672
  ds_read_b64_tr_b16 v[110:111], v34 offset:14336
  v_mfma_f32_16x16x32_bf16 v[172:175], v[72:75], v[92:95], v[172:175]
  v_mfma_f32_16x16x32_bf16 v[176:179], v[76:79], v[80:83], v[176:179]
  v_mfma_f32_16x16x32_bf16 v[180:183], v[76:79], v[84:87], v[180:183]
  v_mfma_f32_16x16x32_bf16 v[184:187], v[76:79], v[88:91], v[184:187]
  v_mfma_f32_16x16x32_bf16 v[188:191], v[76:79], v[92:95], v[188:191]
  s_waitcnt vmcnt(12) lgkmcnt(0)
  v_mfma_f32_16x16x32_bf16 v[128:131], v[96:99], v[112:115], v[128:131]
  ds_read_b64_tr_b16 v[64:65], v31 offset:32768
  ds_read_b128 v[80:83], v37 offset:12288
  v_mfma_f32_16x16x32_bf16 v[132:135], v[96:99], v[116:119], v[132:135]
  v_mfma_f32_16x16x32_bf16 v[136:139], v[96:99], v[120:123], v[136:139]
  ds_read_b64_tr_b16 v[66:67], v31 offset:34816
  ds_read_b128 v[84:87], v37 offset:53248
  v_mfma_f32_16x16x32_bf16 v[140:143], v[96:99], v[124:127], v[140:143]
  v_mfma_f32_16x16x32_bf16 v[144:147], v[100:103], v[112:115], v[144:147]
  ds_read_b64_tr_b16 v[68:69], v32 offset:32768
  ds_read_b128 v[88:91], v38 offset:12288
  v_mfma_f32_16x16x32_bf16 v[148:151], v[100:103], v[116:119], v[148:151]
  v_mfma_f32_16x16x32_bf16 v[152:155], v[100:103], v[120:123], v[152:155]
  ds_read_b64_tr_b16 v[70:71], v32 offset:34816
  ds_read_b128 v[92:95], v38 offset:53248
  v_mfma_f32_16x16x32_bf16 v[156:159], v[100:103], v[124:127], v[156:159]
  v_mfma_f32_16x16x32_bf16 v[160:163], v[104:107], v[112:115], v[160:163]
  ds_read_b64_tr_b16 v[72:73], v33 offset:32768
  ds_read_b64_tr_b16 v[74:75], v33 offset:34816
  v_mfma_f32_16x16x32_bf16 v[164:167], v[104:107], v[116:119], v[164:167]
  v_mfma_f32_16x16x32_bf16 v[168:171], v[104:107], v[120:123], v[168:171]
  ds_read_b64_tr_b16 v[76:77], v34 offset:32768
  ds_read_b64_tr_b16 v[78:79], v34 offset:34816
  v_mfma_f32_16x16x32_bf16 v[172:175], v[104:107], v[124:127], v[172:175]
  v_mfma_f32_16x16x32_bf16 v[176:179], v[108:111], v[112:115], v[176:179]
  v_mfma_f32_16x16x32_bf16 v[180:183], v[108:111], v[116:119], v[180:183]
  v_mfma_f32_16x16x32_bf16 v[184:187], v[108:111], v[120:123], v[184:187]
  v_mfma_f32_16x16x32_bf16 v[188:191], v[108:111], v[124:127], v[188:191]
  s_waitcnt vmcnt(8) lgkmcnt(0)
  v_mfma_f32_16x16x32_bf16 v[128:131], v[64:67], v[80:83], v[128:131]
  ds_read_b64_tr_b16 v[96:97], v31 offset:36864
  ds_read_b128 v[112:115], v39 offset:12288
  v_mfma_f32_16x16x32_bf16 v[132:135], v[64:67], v[84:87], v[132:135]
  v_mfma_f32_16x16x32_bf16 v[136:139], v[64:67], v[88:91], v[136:139]
  ds_read_b64_tr_b16 v[98:99], v31 offset:38912
  ds_read_b128 v[116:119], v39 offset:53248
  v_mfma_f32_16x16x32_bf16 v[140:143], v[64:67], v[92:95], v[140:143]
  v_mfma_f32_16x16x32_bf16 v[144:147], v[68:71], v[80:83], v[144:147]
  ds_read_b64_tr_b16 v[100:101], v32 offset:36864
  ds_read_b128 v[120:123], v40 offset:12288
  v_mfma_f32_16x16x32_bf16 v[148:151], v[68:71], v[84:87], v[148:151]
  v_mfma_f32_16x16x32_bf16 v[152:155], v[68:71], v[88:91], v[152:155]
  ds_read_b64_tr_b16 v[102:103], v32 offset:38912
  ds_read_b128 v[124:127], v40 offset:53248
  v_mfma_f32_16x16x32_bf16 v[156:159], v[68:71], v[92:95], v[156:159]
  v_mfma_f32_16x16x32_bf16 v[160:163], v[72:75], v[80:83], v[160:163]
  ds_read_b64_tr_b16 v[104:105], v33 offset:36864
  ds_read_b64_tr_b16 v[106:107], v33 offset:38912
  v_mfma_f32_16x16x32_bf16 v[164:167], v[72:75], v[84:87], v[164:167]
  v_mfma_f32_16x16x32_bf16 v[168:171], v[72:75], v[88:91], v[168:171]
  ds_read_b64_tr_b16 v[108:109], v34 offset:36864
  ds_read_b64_tr_b16 v[110:111], v34 offset:38912
  v_mfma_f32_16x16x32_bf16 v[172:175], v[72:75], v[92:95], v[172:175]
  v_mfma_f32_16x16x32_bf16 v[176:179], v[76:79], v[80:83], v[176:179]
  v_mfma_f32_16x16x32_bf16 v[180:183], v[76:79], v[84:87], v[180:183]
  v_mfma_f32_16x16x32_bf16 v[184:187], v[76:79], v[88:91], v[184:187]
  v_mfma_f32_16x16x32_bf16 v[188:191], v[76:79], v[92:95], v[188:191]
  s_waitcnt lgkmcnt(0)
  v_mfma_f32_16x16x32_bf16 v[128:131], v[96:99], v[112:115], v[128:131]
  v_mfma_f32_16x16x32_bf16 v[132:135], v[96:99], v[116:119], v[132:135]
  v_mfma_f32_16x16x32_bf16 v[136:139], v[96:99], v[120:123], v[136:139]
  v_mfma_f32_16x16x32_bf16 v[140:143], v[96:99], v[124:127], v[140:143]
  v_mfma_f32_16x16x32_bf16 v[144:147], v[100:103], v[112:115], v[144:147]
  v_mfma_f32_16x16x32_bf16 v[148:151], v[100:103], v[116:119], v[148:151]
  v_mfma_f32_16x16x32_bf16 v[152:155], v[100:103], v[120:123], v[152:155]
  v_cvt_pk_bf16_f32 v64, v128, v129
  v_cvt_pk_bf16_f32 v65, v130, v131
  v_mfma_f32_16x16x32_bf16 v[156:159], v[100:103], v[124:127], v[156:159]
  v_cvt_pk_bf16_f32 v66, v132, v133
  v_cvt_pk_bf16_f32 v67, v134, v135
  v_mfma_f32_16x16x32_bf16 v[160:163], v[104:107], v[112:115], v[160:163]
  v_cvt_pk_bf16_f32 v68, v136, v137
  v_cvt_pk_bf16_f32 v69, v138, v139
  v_mfma_f32_16x16x32_bf16 v[164:167], v[104:107], v[116:119], v[164:167]
  v_mfma_f32_16x16x32_bf16 v[168:171], v[104:107], v[120:123], v[168:171]
  v_cvt_pk_bf16_f32 v70, v140, v141
  v_cvt_pk_bf16_f32 v71, v142, v143
  v_mfma_f32_16x16x32_bf16 v[172:175], v[104:107], v[124:127], v[172:175]
  v_cvt_pk_bf16_f32 v72, v144, v145
  v_cvt_pk_bf16_f32 v73, v146, v147
  v_mfma_f32_16x16x32_bf16 v[176:179], v[108:111], v[112:115], v[176:179]
  v_cvt_pk_bf16_f32 v74, v148, v149
  v_cvt_pk_bf16_f32 v75, v150, v151
  v_mfma_f32_16x16x32_bf16 v[180:183], v[108:111], v[116:119], v[180:183]
  v_mfma_f32_16x16x32_bf16 v[184:187], v[108:111], v[120:123], v[184:187]
  s_add_u32 m0, s46, 16384
  s_add_u32 s51, s5, 0
  v_cvt_pk_bf16_f32 v76, v152, v153
  v_cvt_pk_bf16_f32 v77, v154, v155
  v_mfma_f32_16x16x32_bf16 v[188:191], v[108:111], v[124:127], v[188:191]
  v_cvt_pk_bf16_f32 v78, v156, v157
  v_cvt_pk_bf16_f32 v79, v158, v159
  ds_write_b64 v45, v[64:65] offset:32768
  ds_write_b64 v45, v[66:67] offset:33792
  ds_write_b64 v45, v[68:69] offset:34816
  ds_write_b64 v45, v[70:71] offset:35840
  ds_write_b64 v45, v[72:73] offset:33280
  ds_write_b64 v45, v[74:75] offset:34304
  ds_write_b64 v45, v[76:77] offset:35328
  ds_write_b64 v45, v[78:79] offset:36352
  v_cvt_pk_bf16_f32 v80, v160, v161
  v_cvt_pk_bf16_f32 v81, v162, v163
  ds_write_b64 v45, v[80:81] offset:36864
  v_cvt_pk_bf16_f32 v82, v164, v165
  v_cvt_pk_bf16_f32 v83, v166, v167
  ds_write_b64 v45, v[82:83] offset:37888
  v_cvt_pk_bf16_f32 v84, v168, v169
  v_cvt_pk_bf16_f32 v85, v170, v171
  ds_write_b64 v45, v[84:85] offset:38912
  v_cvt_pk_bf16_f32 v86, v172, v173
  v_cvt_pk_bf16_f32 v87, v174, v175
  ds_write_b64 v45, v[86:87] offset:39936
  v_cvt_pk_bf16_f32 v88, v176, v177
  v_cvt_pk_bf16_f32 v89, v178, v179
  ds_write_b64 v45, v[88:89] offset:37376
  v_cvt_pk_bf16_f32 v90, v180, v181
  v_cvt_pk_bf16_f32 v91, v182, v183
  ds_write_b64 v45, v[90:91] offset:38400
  v_cvt_pk_bf16_f32 v92, v184, v185
  v_cvt_pk_bf16_f32 v93, v186, v187
  ds_write_b64 v45, v[92:93] offset:39424
  v_cvt_pk_bf16_f32 v94, v188, v189
  v_cvt_pk_bf16_f32 v95, v190, v191
  ds_write_b64 v45, v[94:95] offset:40448
  buffer_load_dwordx4 v18, s[20:23], s51 offen lds
  buffer_load_dwordx4 v19, s[20:23], s51 offen offset:1024 lds
  s_add_u32 m0, s46, 18432
  s_nop 0
  buffer_load_dwordx4 v20, s[20:23], s51 offen lds
  buffer_load_dwordx4 v21, s[20:23], s51 offen offset:1024 lds
  s_add_u32 m0, s46, 20480
  s_add_u32 s51, s5, 16384
  buffer_load_dwordx4 v18, s[20:23], s51 offen lds
  buffer_load_dwordx4 v19, s[20:23], s51 offen offset:1024 lds
  s_waitcnt lgkmcnt(0)
  s_waitcnt vmcnt(6)
  ds_read_b128 v[64:67], v35 offset:0
  ds_read_b128 a[0:3], v41 offset:32768
  ds_read_b128 a[4:7], v41 offset:33792
  ds_read_b128 a[8:11], v41 offset:34816
  ds_read_b128 a[12:15], v41 offset:35840
  ds_read_b128 v[68:71], v35 offset:2048
  ds_read_b128 v[72:75], v35 offset:4096
  ds_read_b128 v[76:79], v35 offset:6144
  s_add_u32 m0, s46, 22528
  s_nop 0
  buffer_load_dwordx4 v20, s[20:23], s51 offen lds
  buffer_load_dwordx4 v21, s[20:23], s51 offen offset:1024 lds
  s_waitcnt lgkmcnt(0)
  v_mfma_f32_16x16x32_bf16 v[128:131], v[64:67], a[0:3], 0
  s_add_u32 m0, s46, 24576
  s_add_u32 s51, s7, 0
  ds_read_b128 v[96:99], v36 offset:0
  ds_read_b128 a[16:19], v41 offset:36864
  v_mfma_f32_16x16x32_bf16 v[132:135], v[64:67], a[4:7], 0
  buffer_load_dwordx4 v18, s[20:23], s51 offen lds
  v_mfma_f32_16x16x32_bf16 v[136:139], v[64:67], a[8:11], 0
  ds_read_b128 a[20:23], v41 offset:37888
  v_mfma_f32_16x16x32_bf16 v[140:143], v[64:67], a[12:15], 0
  buffer_load_dwordx4 v19, s[20:23], s51 offen offset:1024 lds
  v_mfma_f32_16x16x32_bf16 v[144:147], v[68:71], a[0:3], 0
  s_add_u32 m0, s46, 26624
  ds_read_b128 a[24:27], v41 offset:38912
  ds_read_b128 a[28:31], v41 offset:39936
  v_mfma_f32_16x16x32_bf16 v[148:151], v[68:71], a[4:7], 0
  buffer_load_dwordx4 v20, s[20:23], s51 offen lds
  v_mfma_f32_16x16x32_bf16 v[152:155], v[68:71], a[8:11], 0
  ds_read_b128 v[100:103], v36 offset:2048
  v_mfma_f32_16x16x32_bf16 v[156:159], v[68:71], a[12:15], 0
  v_mfma_f32_16x16x32_bf16 v[160:163], v[72:75], a[0:3], 0
  ds_read_b128 v[104:107], v36 offset:4096
  v_mfma_f32_16x16x32_bf16 v[164:167], v[72:75], a[4:7], 0
  buffer_load_dwordx4 v21, s[20:23], s51 offen offset:1024 lds
  v_mfma_f32_16x16x32_bf16 v[168:171], v[72:75], a[8:11], 0
  s_add_u32 m0, s46, 28672
  s_add_u32 s51, s7, 16384
  ds_read_b128 v[108:111], v36 offset:6144
  v_mfma_f32_16x16x32_bf16 v[172:175], v[72:75], a[12:15], 0
  buffer_load_dwordx4 v18, s[20:23], s51 offen lds
  v_mfma_f32_16x16x32_bf16 v[176:179], v[76:79], a[0:3], 0
  v_mfma_f32_16x16x32_bf16 v[180:183], v[76:79], a[4:7], 0
  buffer_load_dwordx4 v19, s[20:23], s51 offen offset:1024 lds
  v_mfma_f32_16x16x32_bf16 v[184:187], v[76:79], a[8:11], 0
  v_mfma_f32_16x16x32_bf16 v[188:191], v[76:79], a[12:15], 0
  s_waitcnt vmcnt(6) lgkmcnt(0)
  s_barrier
  v_mfma_f32_16x16x32_bf16 v[128:131], v[96:99], a[16:19], v[128:131]
  s_add_u32 m0, s46, 14336
  ds_read_b128 v[64:67], v35 offset:16384
  ds_read_b128 a[32:35], v42 offset:32768
  v_mfma_f32_16x16x32_bf16 v[132:135], v[96:99], a[20:23], v[132:135]
  buffer_load_dwordx4 v20, s[20:23], s51 offen lds
  v_mfma_f32_16x16x32_bf16 v[136:139], v[96:99], a[24:27], v[136:139]
  ds_read_b128 a[36:39], v42 offset:33792
  v_mfma_f32_16x16x32_bf16 v[140:143], v[96:99], a[28:31], v[140:143]
  buffer_load_dwordx4 v21, s[20:23], s51 offen offset:1024 lds
  v_mfma_f32_16x16x32_bf16 v[144:147], v[100:103], a[16:19], v[144:147]
  s_add_u32 m0, s46, 8192
  s_add_u32 s51, s6, 0
  ds_read_b128 a[40:43], v42 offset:34816
  ds_read_b128 a[44:47], v42 offset:35840
  v_mfma_f32_16x16x32_bf16 v[148:151], v[100:103], a[20:23], v[148:151]
  buffer_load_dwordx4 v18, s[20:23], s51 offen lds
  v_mfma_f32_16x16x32_bf16 v[152:155], v[100:103], a[24:27], v[152:155]
  ds_read_b128 v[68:71], v35 offset:18432
  v_mfma_f32_16x16x32_bf16 v[156:159], v[100:103], a[28:31], v[156:159]
  v_mfma_f32_16x16x32_bf16 v[160:163], v[104:107], a[16:19], v[160:163]
  ds_read_b128 v[72:75], v35 offset:20480
  v_mfma_f32_16x16x32_bf16 v[164:167], v[104:107], a[20:23], v[164:167]
  buffer_load_dwordx4 v19, s[20:23], s51 offen offset:1024 lds
  v_mfma_f32_16x16x32_bf16 v[168:171], v[104:107], a[24:27], v[168:171]
  s_add_u32 m0, s46, 10240
  ds_read_b128 v[76:79], v35 offset:22528
  v_mfma_f32_16x16x32_bf16 v[172:175], v[104:107], a[28:31], v[172:175]
  buffer_load_dwordx4 v20, s[20:23], s51 offen lds
  v_mfma_f32_16x16x32_bf16 v[176:179], v[108:111], a[16:19], v[176:179]
  v_mfma_f32_16x16x32_bf16 v[180:183], v[108:111], a[20:23], v[180:183]
  buffer_load_dwordx4 v21, s[20:23], s51 offen offset:1024 lds
  v_mfma_f32_16x16x32_bf16 v[184:187], v[108:111], a[24:27], v[184:187]
  v_mfma_f32_16x16x32_bf16 v[188:191], v[108:111], a[28:31], v[188:191]
  s_waitcnt lgkmcnt(0)
  v_mfma_f32_16x16x32_bf16 v[128:131], v[64:67], a[32:35], v[128:131]
  s_add_u32 m0, s46, 12288
  s_add_u32 s51, s6, 16384
  ds_read_b128 v[96:99], v36 offset:16384
  ds_read_b128 a[48:51], v42 offset:36864
  v_mfma_f32_16x16x32_bf16 v[132:135], v[64:67], a[36:39], v[132:135]
  buffer_load_dwordx4 v18, s[20:23], s51 offen lds
  v_mfma_f32_16x16x32_bf16 v[136:139], v[64:67], a[40:43], v[136:139]
  ds_read_b128 a[52:55], v42 offset:37888
  v_mfma_f32_16x16x32_bf16 v[140:143], v[64:67], a[44:47], v[140:143]
  buffer_load_dwordx4 v19, s[20:23], s51 offen offset:1024 lds
  v_mfma_f32_16x16x32_bf16 v[144:147], v[68:71], a[32:35], v[144:147]
  s_add_u32 m0, s46, 0
  ds_read_b128 a[56:59], v42 offset:38912
  ds_read_b128 a[60:63], v42 offset:39936
  v_mfma_f32_16x16x32_bf16 v[148:151], v[68:71], a[36:39], v[148:151]
  buffer_load_dwordx4 v20, s[20:23], s51 offen lds
  v_mfma_f32_16x16x32_bf16 v[152:155], v[68:71], a[40:43], v[152:155]
  ds_read_b128 v[100:103], v36 offset:18432
  v_mfma_f32_16x16x32_bf16 v[156:159], v[68:71], a[44:47], v[156:159]
  v_mfma_f32_16x16x32_bf16 v[160:163], v[72:75], a[32:35], v[160:163]
  ds_read_b128 v[104:107], v36 offset:20480
  v_mfma_f32_16x16x32_bf16 v[164:167], v[72:75], a[36:39], v[164:167]
  buffer_load_dwordx4 v21, s[20:23], s51 offen offset:1024 lds
  v_mfma_f32_16x16x32_bf16 v[168:171], v[72:75], a[40:43], v[168:171]
  s_add_u32 m0, s46, 2048
  s_add_u32 s51, s4, 32768
  ds_read_b128 v[108:111], v36 offset:22528
  v_mfma_f32_16x16x32_bf16 v[172:175], v[72:75], a[44:47], v[172:175]
  buffer_load_dwordx4 v18, s[20:23], s51 offen lds
  v_mfma_f32_16x16x32_bf16 v[176:179], v[76:79], a[32:35], v[176:179]
  v_mfma_f32_16x16x32_bf16 v[180:183], v[76:79], a[36:39], v[180:183]
  buffer_load_dwordx4 v19, s[20:23], s51 offen offset:1024 lds
  v_mfma_f32_16x16x32_bf16 v[184:187], v[76:79], a[40:43], v[184:187]
  v_mfma_f32_16x16x32_bf16 v[188:191], v[76:79], a[44:47], v[188:191]
  s_waitcnt vmcnt(10) lgkmcnt(0)
  v_mfma_f32_16x16x32_bf16 v[128:131], v[96:99], a[48:51], v[128:131]
  s_add_u32 m0, s46, 4096
  ds_read_b128 v[64:67], v35 offset:24576
  ds_read_b128 a[64:67], v44 offset:32768
  v_mfma_f32_16x16x32_bf16 v[132:135], v[96:99], a[52:55], v[132:135]
  buffer_load_dwordx4 v20, s[20:23], s51 offen lds
  v_mfma_f32_16x16x32_bf16 v[136:139], v[96:99], a[56:59], v[136:139]
  ds_read_b128 a[68:71], v44 offset:33792
  v_mfma_f32_16x16x32_bf16 v[140:143], v[96:99], a[60:63], v[140:143]
  buffer_load_dwordx4 v21, s[20:23], s51 offen offset:1024 lds
  v_mfma_f32_16x16x32_bf16 v[144:147], v[100:103], a[48:51], v[144:147]
  s_add_u32 m0, s46, 6144
  s_add_u32 s51, s4, 49152
  ds_read_b128 a[72:75], v44 offset:34816
  ds_read_b128 a[76:79], v44 offset:35840
  v_mfma_f32_16x16x32_bf16 v[148:151], v[100:103], a[52:55], v[148:151]
  buffer_load_dwordx4 v18, s[20:23], s51 offen lds
  v_mfma_f32_16x16x32_bf16 v[152:155], v[100:103], a[56:59], v[152:155]
  ds_read_b128 v[68:71], v35 offset:26624
  v_mfma_f32_16x16x32_bf16 v[156:159], v[100:103], a[60:63], v[156:159]
  v_mfma_f32_16x16x32_bf16 v[160:163], v[104:107], a[48:51], v[160:163]
  ds_read_b128 v[72:75], v35 offset:28672
  v_mfma_f32_16x16x32_bf16 v[164:167], v[104:107], a[52:55], v[164:167]
  buffer_load_dwordx4 v19, s[20:23], s51 offen offset:1024 lds
  v_mfma_f32_16x16x32_bf16 v[168:171], v[104:107], a[56:59], v[168:171]
  s_add_u32 m0, s46, 16384
  ds_read_b128 v[76:79], v35 offset:14336
  v_mfma_f32_16x16x32_bf16 v[172:175], v[104:107], a[60:63], v[172:175]
  buffer_load_dwordx4 v20, s[20:23], s51 offen lds
  v_mfma_f32_16x16x32_bf16 v[176:179], v[108:111], a[48:51], v[176:179]
  v_mfma_f32_16x16x32_bf16 v[180:183], v[108:111], a[52:55], v[180:183]
  buffer_load_dwordx4 v21, s[20:23], s51 offen offset:1024 lds
  v_mfma_f32_16x16x32_bf16 v[184:187], v[108:111], a[56:59], v[184:187]
  v_mfma_f32_16x16x32_bf16 v[188:191], v[108:111], a[60:63], v[188:191]
  s_waitcnt lgkmcnt(0)
  v_mfma_f32_16x16x32_bf16 v[128:131], v[64:67], a[64:67], v[128:131]
  s_add_u32 m0, s46, 18432
  s_add_u32 s51, s5, 32768
  ds_read_b128 v[96:99], v36 offset:24576
  ds_read_b128 a[80:83], v44 offset:36864
  v_mfma_f32_16x16x32_bf16 v[132:135], v[64:67], a[68:71], v[132:135]
  buffer_load_dwordx4 v18, s[20:23], s51 offen lds
  v_mfma_f32_16x16x32_bf16 v[136:139], v[64:67], a[72:75], v[136:139]
  ds_read_b128 a[84:87], v44 offset:37888
  v_mfma_f32_16x16x32_bf16 v[140:143], v[64:67], a[76:79], v[140:143]
  buffer_load_dwordx4 v19, s[20:23], s51 offen offset:1024 lds
  v_mfma_f32_16x16x32_bf16 v[144:147], v[68:71], a[64:67], v[144:147]
  s_add_u32 m0, s46, 20480
  ds_read_b128 a[88:91], v44 offset:38912
  ds_read_b128 a[92:95], v44 offset:39936
  v_mfma_f32_16x16x32_bf16 v[148:151], v[68:71], a[68:71], v[148:151]
  buffer_load_dwordx4 v20, s[20:23], s51 offen lds
  v_mfma_f32_16x16x32_bf16 v[152:155], v[68:71], a[72:75], v[152:155]
  ds_read_b128 v[100:103], v36 offset:26624
  v_mfma_f32_16x16x32_bf16 v[156:159], v[68:71], a[76:79], v[156:159]
  v_mfma_f32_16x16x32_bf16 v[160:163], v[72:75], a[64:67], v[160:163]
  ds_read_b128 v[104:107], v36 offset:28672
  v_mfma_f32_16x16x32_bf16 v[164:167], v[72:75], a[68:71], v[164:167]
  buffer_load_dwordx4 v21, s[20:23], s51 offen offset:1024 lds
  v_mfma_f32_16x16x32_bf16 v[168:171], v[72:75], a[72:75], v[168:171]
  ds_read_b128 v[108:111], v36 offset:14336
  v_mfma_f32_16x16x32_bf16 v[172:175], v[72:75], a[76:79], v[172:175]
  v_mfma_f32_16x16x32_bf16 v[176:179], v[76:79], a[64:67], v[176:179]
  s_add_u32 m0, s46, 22528
  s_add_u32 s51, s5, 49152
  v_mfma_f32_16x16x32_bf16 v[180:183], v[76:79], a[68:71], v[180:183]
  buffer_load_dwordx4 v18, s[20:23], s51 offen lds
  v_mfma_f32_16x16x32_bf16 v[184:187], v[76:79], a[72:75], v[184:187]
  v_mfma_f32_16x16x32_bf16 v[188:191], v[76:79], a[76:79], v[188:191]
  s_waitcnt vmcnt(13) lgkmcnt(0)
  v_mfma_f32_16x16x32_bf16 v[128:131], v[96:99], a[80:83], v[128:131]
  ds_read_b128 v[64:67], v35 offset:8192
  ds_read_b128 a[96:99], v43 offset:32768
  v_mfma_f32_16x16x32_bf16 v[132:135], v[96:99], a[84:87], v[132:135]
  buffer_load_dwordx4 v19, s[20:23], s51 offen offset:1024 lds
  v_mfma_f32_16x16x32_bf16 v[136:139], v[96:99], a[88:91], v[136:139]
  s_add_u32 m0, s46, 24576
  ds_read_b128 a[100:103], v43 offset:33792
  v_mfma_f32_16x16x32_bf16 v[140:143], v[96:99], a[92:95], v[140:143]
  buffer_load_dwordx4 v20, s[20:23], s51 offen lds
  v_mfma_f32_16x16x32_bf16 v[144:147], v[100:103], a[80:83], v[144:147]
  ds_read_b128 a[104:107], v43 offset:34816
  ds_read_b128 a[108:111], v43 offset:35840
  v_mfma_f32_16x16x32_bf16 v[148:151], v[100:103], a[84:87], v[148:151]
  buffer_load_dwordx4 v21, s[20:23], s51 offen offset:1024 lds
  v_mfma_f32_16x16x32_bf16 v[152:155], v[100:103], a[88:91], v[152:155]
  ds_read_b128 v[68:71], v35 offset:10240
  v_mfma_f32_16x16x32_bf16 v[156:159], v[100:103], a[92:95], v[156:159]
  v_mfma_f32_16x16x32_bf16 v[160:163], v[104:107], a[80:83], v[160:163]
  s_add_u32 m0, s46, 26624
  s_add_u32 s51, s7, 32768
  ds_read_b128 v[72:75], v35 offset:12288
  v_mfma_f32_16x16x32_bf16 v[164:167], v[104:107], a[84:87], v[164:167]
  buffer_load_dwordx4 v18, s[20:23], s51 offen lds
  v_mfma_f32_16x16x32_bf16 v[168:171], v[104:107], a[88:91], v[168:171]
  ds_read_b128 v[76:79], v35 offset:0
  v_mfma_f32_16x16x32_bf16 v[172:175], v[104:107], a[92:95], v[172:175]
  buffer_load_dwordx4 v19, s[20:23], s51 offen offset:1024 lds
  v_mfma_f32_16x16x32_bf16 v[176:179], v[108:111], a[80:83], v[176:179]
  s_add_u32 m0, s46, 28672
  v_mfma_f32_16x16x32_bf16 v[180:183], v[108:111], a[84:87], v[180:183]
  buffer_load_dwordx4 v20, s[20:23], s51 offen lds
  v_mfma_f32_16x16x32_bf16 v[184:187], v[108:111], a[88:91], v[184:187]
  v_mfma_f32_16x16x32_bf16 v[188:191], v[108:111], a[92:95], v[188:191]
  s_waitcnt lgkmcnt(0)
  v_mfma_f32_16x16x32_bf16 v[128:131], v[64:67], a[96:99], v[128:131]
  ds_read_b128 v[96:99], v36 offset:8192
  ds_read_b128 a[112:115], v43 offset:36864
  v_mfma_f32_16x16x32_bf16 v[132:135], v[64:67], a[100:103], v[132:135]
  buffer_load_dwordx4 v21, s[20:23], s51 offen offset:1024 lds
  v_mfma_f32_16x16x32_bf16 v[136:139], v[64:67], a[104:107], v[136:139]
  ds_read_b128 a[116:119], v43 offset:37888
  v_mfma_f32_16x16x32_bf16 v[140:143], v[64:67], a[108:111], v[140:143]
  v_mfma_f32_16x16x32_bf16 v[144:147], v[68:71], a[96:99], v[144:147]
  s_add_u32 m0, s46, 14336
  s_add_u32 s51, s7, 49152
  ds_read_b128 a[120:123], v43 offset:38912
  ds_read_b128 a[124:127], v43 offset:39936
  v_mfma_f32_16x16x32_bf16 v[148:151], v[68:71], a[100:103], v[148:151]
  buffer_load_dwordx4 v18, s[20:23], s51 offen lds
  v_mfma_f32_16x16x32_bf16 v[152:155], v[68:71], a[104:107], v[152:155]
  ds_read_b128 v[100:103], v36 offset:10240
  v_mfma_f32_16x16x32_bf16 v[156:159], v[68:71], a[108:111], v[156:159]
  v_mfma_f32_16x16x32_bf16 v[160:163], v[72:75], a[96:99], v[160:163]
  ds_read_b128 v[104:107], v36 offset:12288
  v_mfma_f32_16x16x32_bf16 v[164:167], v[72:75], a[100:103], v[164:167]
  buffer_load_dwordx4 v19, s[20:23], s51 offen offset:1024 lds
  v_mfma_f32_16x16x32_bf16 v[168:171], v[72:75], a[104:107], v[168:171]
  ds_read_b128 v[108:111], v36 offset:0
  v_mfma_f32_16x16x32_bf16 v[172:175], v[72:75], a[108:111], v[172:175]
  v_mfma_f32_16x16x32_bf16 v[176:179], v[76:79], a[96:99], v[176:179]
  v_mfma_f32_16x16x32_bf16 v[180:183], v[76:79], a[100:103], v[180:183]
  v_mfma_f32_16x16x32_bf16 v[184:187], v[76:79], a[104:107], v[184:187]
  v_mfma_f32_16x16x32_bf16 v[188:191], v[76:79], a[108:111], v[188:191]
  s_waitcnt vmcnt(14) lgkmcnt(0)
  s_barrier
  v_mfma_f32_16x16x32_bf16 v[128:131], v[96:99], a[112:115], v[128:131]
  s_add_u32 m0, s46, 8192
  ds_read_b128 v[64:67], v35 offset:2048
  v_mfma_f32_16x16x32_bf16 v[132:135], v[96:99], a[116:119], v[132:135]
  buffer_load_dwordx4 v20, s[20:23], s51 offen lds
  v_mfma_f32_16x16x32_bf16 v[136:139], v[96:99], a[120:123], v[136:139]
  ds_read_b128 v[68:71], v35 offset:4096
  v_mfma_f32_16x16x32_bf16 v[140:143], v[96:99], a[124:127], v[140:143]
  buffer_load_dwordx4 v21, s[20:23], s51 offen offset:1024 lds
  v_mfma_f32_16x16x32_bf16 v[144:147], v[100:103], a[112:115], v[144:147]
  s_add_u32 m0, s46, 10240
  s_add_u32 s51, s6, 32768
  ds_read_b128 v[72:75], v35 offset:6144
  v_mfma_f32_16x16x32_bf16 v[148:151], v[100:103], a[116:119], v[148:151]
  buffer_load_dwordx4 v18, s[20:23], s51 offen lds
  v_mfma_f32_16x16x32_bf16 v[152:155], v[100:103], a[120:123], v[152:155]
  ds_read_b128 v[76:79], v35 offset:16384
  v_mfma_f32_16x16x32_bf16 v[156:159], v[100:103], a[124:127], v[156:159]
  v_mfma_f32_16x16x32_bf16 v[160:163], v[104:107], a[112:115], v[160:163]
  v_mfma_f32_16x16x32_bf16 v[164:167], v[104:107], a[116:119], v[164:167]
  buffer_load_dwordx4 v19, s[20:23], s51 offen offset:1024 lds
  v_mfma_f32_16x16x32_bf16 v[168:171], v[104:107], a[120:123], v[168:171]
  v_mfma_f32_16x16x32_bf16 v[172:175], v[104:107], a[124:127], v[172:175]
  v_mfma_f32_16x16x32_bf16 v[176:179], v[108:111], a[112:115], v[176:179]
  s_add_u32 m0, s46, 12288
  v_mfma_f32_16x16x32_bf16 v[180:183], v[108:111], a[116:119], v[180:183]
  buffer_load_dwordx4 v20, s[20:23], s51 offen lds
  v_mfma_f32_16x16x32_bf16 v[184:187], v[108:111], a[120:123], v[184:187]
  v_mfma_f32_16x16x32_bf16 v[188:191], v[108:111], a[124:127], v[188:191]
  s_waitcnt lgkmcnt(0)
  v_mfma_f32_16x16x32_bf16 v[192:195], v[64:67], a[0:3], 0
  ds_read_b128 v[96:99], v36 offset:2048
  v_mfma_f32_16x16x32_bf16 v[196:199], v[64:67], a[4:7], 0
  buffer_load_dwordx4 v21, s[20:23], s51 offen offset:1024 lds
  v_mfma_f32_16x16x32_bf16 v[200:203], v[64:67], a[8:11], 0
  ds_read_b128 v[100:103], v36 offset:4096
  v_mfma_f32_16x16x32_bf16 v[204:207], v[64:67], a[12:15], 0
  v_mfma_f32_16x16x32_bf16 v[208:211], v[68:71], a[0:3], 0
  s_add_u32 m0, s46, 0
  s_add_u32 s51, s6, 49152
  ds_read_b128 v[104:107], v36 offset:6144
  v_mfma_f32_16x16x32_bf16 v[212:215], v[68:71], a[4:7], 0
  buffer_load_dwordx4 v18, s[20:23], s51 offen lds
  v_mfma_f32_16x16x32_bf16 v[216:219], v[68:71], a[8:11], 0
  ds_read_b128 v[108:111], v36 offset:16384
  v_mfma_f32_16x16x32_bf16 v[220:223], v[68:71], a[12:15], 0
  v_mfma_f32_16x16x32_bf16 v[224:227], v[72:75], a[0:3], 0
  v_mfma_f32_16x16x32_bf16 v[228:231], v[72:75], a[4:7], 0
  buffer_load_dwordx4 v19, s[20:23], s51 offen offset:1024 lds
  v_mfma_f32_16x16x32_bf16 v[232:235], v[72:75], a[8:11], 0
  v_mfma_f32_16x16x32_bf16 v[236:239], v[72:75], a[12:15], 0
  v_mfma_f32_16x16x32_bf16 v[240:243], v[76:79], a[0:3], 0
  v_mfma_f32_16x16x32_bf16 v[244:247], v[76:79], a[4:7], 0
  v_mfma_f32_16x16x32_bf16 v[248:251], v[76:79], a[8:11], 0
  v_mfma_f32_16x16x32_bf16 v[252:255], v[76:79], a[12:15], 0
  s_waitcnt vmcnt(14) lgkmcnt(0)
  v_mfma_f32_16x16x32_bf16 v[192:195], v[96:99], a[16:19], v[192:195]
  s_add_u32 m0, s46, 2048
  ds_read_b128 v[64:67], v35 offset:18432
  v_mfma_f32_16x16x32_bf16 v[196:199], v[96:99], a[20:23], v[196:199]
  buffer_load_dwordx4 v20, s[20:23], s51 offen lds
  v_mfma_f32_16x16x32_bf16 v[200:203], v[96:99], a[24:27], v[200:203]
  ds_read_b128 v[68:71], v35 offset:20480
  v_mfma_f32_16x16x32_bf16 v[204:207], v[96:99], a[28:31], v[204:207]
  buffer_load_dwordx4 v21, s[20:23], s51 offen offset:1024 lds
  v_mfma_f32_16x16x32_bf16 v[208:211], v[100:103], a[16:19], v[208:211]
  s_add_u32 m0, s46, 32768
  ds_read_b128 v[72:75], v35 offset:22528
  v_mfma_f32_16x16x32_bf16 v[212:215], v[100:103], a[20:23], v[212:215]
  buffer_load_dwordx4 v14, s[24:27], s57 offen lds
  v_mfma_f32_16x16x32_bf16 v[216:219], v[100:103], a[24:27], v[216:219]
  ds_read_b128 v[76:79], v35 offset:24576
  v_mfma_f32_16x16x32_bf16 v[220:223], v[100:103], a[28:31], v[220:223]
  v_mfma_f32_16x16x32_bf16 v[224:227], v[104:107], a[16:19], v[224:227]
  v_max_f32 v56, v128, v129
  v_max_f32 v57, v132, v133
  v_mfma_f32_16x16x32_bf16 v[228:231], v[104:107], a[20:23], v[228:231]
  buffer_load_dwordx4 v15, s[24:27], s57 offen offset:1024 lds
  v_mfma_f32_16x16x32_bf16 v[232:235], v[104:107], a[24:27], v[232:235]
  v_max_f32 v58, v136, v137
  v_max_f32 v59, v140, v141
  v_mfma_f32_16x16x32_bf16 v[236:239], v[104:107], a[28:31], v[236:239]
  v_mfma_f32_16x16x32_bf16 v[240:243], v[108:111], a[16:19], v[240:243]
  s_add_u32 m0, s46, 34816
  v_max3_f32 v56, v130, v131, v56
  v_max3_f32 v57, v134, v135, v57
  v_mfma_f32_16x16x32_bf16 v[244:247], v[108:111], a[20:23], v[244:247]
  buffer_load_dwordx4 v16, s[24:27], s57 offen lds
  v_mfma_f32_16x16x32_bf16 v[248:251], v[108:111], a[24:27], v[248:251]
  v_mfma_f32_16x16x32_bf16 v[252:255], v[108:111], a[28:31], v[252:255]
  v_max3_f32 v58, v138, v139, v58
  v_max3_f32 v59, v142, v143, v59
  s_waitcnt lgkmcnt(0)
  v_mfma_f32_16x16x32_bf16 v[192:195], v[64:67], a[32:35], v[192:195]
  ds_read_b128 v[96:99], v36 offset:18432
  v_mfma_f32_16x16x32_bf16 v[196:199], v[64:67], a[36:39], v[196:199]
  buffer_load_dwordx4 v17, s[24:27], s57 offen offset:1024 lds
  v_mfma_f32_16x16x32_bf16 v[200:203], v[64:67], a[40:43], v[200:203]
  ds_read_b128 v[100:103], v36 offset:20480
  v_mfma_f32_16x16x32_bf16 v[204:207], v[64:67], a[44:47], v[204:207]
  v_mfma_f32_16x16x32_bf16 v[208:211], v[68:71], a[32:35], v[208:211]
  s_add_u32 m0, s46, 36864
  s_add_u32 s57, s57, 16384
  ds_read_b128 v[104:107], v36 offset:22528
  v_mfma_f32_16x16x32_bf16 v[212:215], v[68:71], a[36:39], v[212:215]
  buffer_load_dwordx4 v14, s[24:27], s57 offen lds
  v_mfma_f32_16x16x32_bf16 v[216:219], v[68:71], a[40:43], v[216:219]
  ds_read_b128 v[108:111], v36 offset:24576
  v_mfma_f32_16x16x32_bf16 v[220:223], v[68:71], a[44:47], v[220:223]
  v_mfma_f32_16x16x32_bf16 v[224:227], v[72:75], a[32:35], v[224:227]
  v_max3_f32 v56, v144, v145, v56
  v_max3_f32 v57, v148, v149, v57
  v_mfma_f32_16x16x32_bf16 v[228:231], v[72:75], a[36:39], v[228:231]
  buffer_load_dwordx4 v15, s[24:27], s57 offen offset:1024 lds
  v_mfma_f32_16x16x32_bf16 v[232:235], v[72:75], a[40:43], v[232:235]
  v_max3_f32 v58, v152, v153, v58
  v_max3_f32 v59, v156, v157, v59
  v_mfma_f32_16x16x32_bf16 v[236:239], v[72:75], a[44:47], v[236:239]
  v_mfma_f32_16x16x32_bf16 v[240:243], v[76:79], a[32:35], v[240:243]
  s_add_u32 m0, s46, 38912
  v_max3_f32 v56, v146, v147, v56
  v_max3_f32 v57, v150, v151, v57
  v_mfma_f32_16x16x32_bf16 v[244:247], v[76:79], a[36:39], v[244:247]
  buffer_load_dwordx4 v16, s[24:27], s57 offen lds
  v_mfma_f32_16x16x32_bf16 v[248:251], v[76:79], a[40:43], v[248:251]
  v_mfma_f32_16x16x32_bf16 v[252:255], v[76:79], a[44:47], v[252:255]
  v_max3_f32 v58, v154, v155, v58
  v_max3_f32 v59, v158, v159, v59
  s_waitcnt vmcnt(15) lgkmcnt(0)
  v_mfma_f32_16x16x32_bf16 v[192:195], v[96:99], a[48:51], v[192:195]
  ds_read_b128 v[64:67], v35 offset:26624
  v_mfma_f32_16x16x32_bf16 v[196:199], v[96:99], a[52:55], v[196:199]
  buffer_load_dwordx4 v17, s[24:27], s57 offen offset:1024 lds
  v_mfma_f32_16x16x32_bf16 v[200:203], v[96:99], a[56:59], v[200:203]
  ds_read_b128 v[68:71], v35 offset:28672
  v_mfma_f32_16x16x32_bf16 v[204:207], v[96:99], a[60:63], v[204:207]
  v_mfma_f32_16x16x32_bf16 v[208:211], v[100:103], a[48:51], v[208:211]
  ds_read_b128 v[72:75], v35 offset:14336
  v_mfma_f32_16x16x32_bf16 v[212:215], v[100:103], a[52:55], v[212:215]
  v_mfma_f32_16x16x32_bf16 v[216:219], v[100:103], a[56:59], v[216:219]
  ds_read_b128 v[76:79], v35 offset:8192
  v_mfma_f32_16x16x32_bf16 v[220:223], v[100:103], a[60:63], v[220:223]
  v_mfma_f32_16x16x32_bf16 v[224:227], v[104:107], a[48:51], v[224:227]
  v_max3_f32 v56, v160, v161, v56
  v_max3_f32 v57, v164, v165, v57
  v_mfma_f32_16x16x32_bf16 v[228:231], v[104:107], a[52:55], v[228:231]
  v_mfma_f32_16x16x32_bf16 v[232:235], v[104:107], a[56:59], v[232:235]
  v_max3_f32 v58, v168, v169, v58
  v_max3_f32 v59, v172, v173, v59
  v_mfma_f32_16x16x32_bf16 v[236:239], v[104:107], a[60:63], v[236:239]
  v_mfma_f32_16x16x32_bf16 v[240:243], v[108:111], a[48:51], v[240:243]
  v_max3_f32 v56, v162, v163, v56
  v_max3_f32 v57, v166, v167, v57
  v_mfma_f32_16x16x32_bf16 v[244:247], v[108:111], a[52:55], v[244:247]
  v_mfma_f32_16x16x32_bf16 v[248:251], v[108:111], a[56:59], v[248:251]
  v_mfma_f32_16x16x32_bf16 v[252:255], v[108:111], a[60:63], v[252:255]
  v_max3_f32 v58, v170, v171, v58
  v_max3_f32 v59, v174, v175, v59
  s_waitcnt lgkmcnt(0)
  v_mfma_f32_16x16x32_bf16 v[192:195], v[64:67], a[64:67], v[192:195]
  ds_read_b128 v[96:99], v36 offset:26624
  v_mfma_f32_16x16x32_bf16 v[196:199], v[64:67], a[68:71], v[196:199]
  v_mfma_f32_16x16x32_bf16 v[200:203], v[64:67], a[72:75], v[200:203]
  ds_read_b128 v[100:103], v36 offset:28672
  v_mfma_f32_16x16x32_bf16 v[204:207], v[64:67], a[76:79], v[204:207]
  v_mfma_f32_16x16x32_bf16 v[208:211], v[68:71], a[64:67], v[208:211]
  ds_read_b128 v[104:107], v36 offset:14336
  v_mfma_f32_16x16x32_bf16 v[212:215], v[68:71], a[68:71], v[212:215]
  v_mfma_f32_16x16x32_bf16 v[216:219], v[68:71], a[72:75], v[216:219]
  ds_read_b128 v[108:111], v36 offset:8192
  v_mfma_f32_16x16x32_bf16 v[220:223], v[68:71], a[76:79], v[220:223]
  v_mfma_f32_16x16x32_bf16 v[224:227], v[72:75], a[64:67], v[224:227]
  v_max3_f32 v56, v176, v177, v56
  v_max3_f32 v57, v180, v181, v57
  v_mfma_f32_16x16x32_bf16 v[228:231], v[72:75], a[68:71], v[228:231]
  v_mfma_f32_16x16x32_bf16 v[232:235], v[72:75], a[72:75], v[232:235]
  v_max3_f32 v58, v184, v185, v58
  v_max3_f32 v59, v188, v189, v59
  v_mfma_f32_16x16x32_bf16 v[236:239], v[72:75], a[76:79], v[236:239]
  v_mfma_f32_16x16x32_bf16 v[240:243], v[76:79], a[64:67], v[240:243]
  v_max3_f32 v56, v178, v179, v56
  v_max3_f32 v57, v182, v183, v57
  v_mfma_f32_16x16x32_bf16 v[244:247], v[76:79], a[68:71], v[244:247]
  v_mfma_f32_16x16x32_bf16 v[248:251], v[76:79], a[72:75], v[248:251]
  v_mfma_f32_16x16x32_bf16 v[252:255], v[76:79], a[76:79], v[252:255]
  v_max3_f32 v58, v186, v187, v58
  v_max3_f32 v59, v190, v191, v59
  s_waitcnt vmcnt(8) lgkmcnt(0)
  v_mfma_f32_16x16x32_bf16 v[192:195], v[96:99], a[80:83], v[192:195]
  ds_read_b128 v[64:67], v35 offset:10240
  v_mfma_f32_16x16x32_bf16 v[196:199], v[96:99], a[84:87], v[196:199]
  v_mfma_f32_16x16x32_bf16 v[200:203], v[96:99], a[88:91], v[200:203]
  ds_read_b128 v[68:71], v35 offset:12288
  v_mfma_f32_16x16x32_bf16 v[204:207], v[96:99], a[92:95], v[204:207]
  v_mfma_f32_16x16x32_bf16 v[208:211], v[100:103], a[80:83], v[208:211]
  ds_read_b128 v[72:75], v35 offset:0
  v_mfma_f32_16x16x32_bf16 v[212:215], v[100:103], a[84:87], v[212:215]
  v_mfma_f32_16x16x32_bf16 v[216:219], v[100:103], a[88:91], v[216:219]
  ds_read_b128 v[76:79], v35 offset:2048
  v_mfma_f32_16x16x32_bf16 v[220:223], v[100:103], a[92:95], v[220:223]
  v_mfma_f32_16x16x32_bf16 v[224:227], v[104:107], a[80:83], v[224:227]
  v_mfma_f32_16x16x32_bf16 v[228:231], v[104:107], a[84:87], v[228:231]
  v_mfma_f32_16x16x32_bf16 v[232:235], v[104:107], a[88:91], v[232:235]
  v_mfma_f32_16x16x32_bf16 v[236:239], v[104:107], a[92:95], v[236:239]
  v_mfma_f32_16x16x32_bf16 v[240:243], v[108:111], a[80:83], v[240:243]
  v_mfma_f32_16x16x32_bf16 v[244:247], v[108:111], a[84:87], v[244:247]
  v_mfma_f32_16x16x32_bf16 v[248:251], v[108:111], a[88:91], v[248:251]
  v_mfma_f32_16x16x32_bf16 v[252:255], v[108:111], a[92:95], v[252:255]
  s_waitcnt lgkmcnt(0)
  v_mfma_f32_16x16x32_bf16 v[192:195], v[64:67], a[96:99], v[192:195]
  ds_read_b128 v[96:99], v36 offset:10240
  v_mfma_f32_16x16x32_bf16 v[196:199], v[64:67], a[100:103], v[196:199]
  v_mfma_f32_16x16x32_bf16 v[200:203], v[64:67], a[104:107], v[200:203]
  ds_read_b128 v[100:103], v36 offset:12288
  v_mfma_f32_16x16x32_bf16 v[204:207], v[64:67], a[108:111], v[204:207]
  v_mfma_f32_16x16x32_bf16 v[208:211], v[68:71], a[96:99], v[208:211]
  ds_read_b128 v[104:107], v36 offset:0
  v_mfma_f32_16x16x32_bf16 v[212:215], v[68:71], a[100:103], v[212:215]
  v_mfma_f32_16x16x32_bf16 v[216:219], v[68:71], a[104:107], v[216:219]
  ds_read_b128 v[108:111], v36 offset:2048
  v_mfma_f32_16x16x32_bf16 v[220:223], v[68:71], a[108:111], v[220:223]
  v_mfma_f32_16x16x32_bf16 v[224:227], v[72:75], a[96:99], v[224:227]
  v_mfma_f32_16x16x32_bf16 v[228:231], v[72:75], a[100:103], v[228:231]
  v_mfma_f32_16x16x32_bf16 v[232:235], v[72:75], a[104:107], v[232:235]
  v_mfma_f32_16x16x32_bf16 v[236:239], v[72:75], a[108:111], v[236:239]
  v_mfma_f32_16x16x32_bf16 v[240:243], v[76:79], a[96:99], v[240:243]
  v_mfma_f32_16x16x32_bf16 v[244:247], v[76:79], a[100:103], v[244:247]
  v_mfma_f32_16x16x32_bf16 v[248:251], v[76:79], a[104:107], v[248:251]
  v_mfma_f32_16x16x32_bf16 v[252:255], v[76:79], a[108:111], v[252:255]
  s_waitcnt lgkmcnt(0)
  v_mfma_f32_16x16x32_bf16 v[192:195], v[96:99], a[112:115], v[192:195]
  v_mfma_f32_16x16x32_bf16 v[196:199], v[96:99], a[116:119], v[196:199]
  v_mfma_f32_16x16x32_bf16 v[200:203], v[96:99], a[120:123], v[200:203]
  v_mfma_f32_16x16x32_bf16 v[204:207], v[96:99], a[124:127], v[204:207]
  v_mfma_f32_16x16x32_bf16 v[208:211], v[100:103], a[112:115], v[208:211]
  v_mfma_f32_16x16x32_bf16 v[212:215], v[100:103], a[116:119], v[212:215]
  v_mfma_f32_16x16x32_bf16 v[216:219], v[100:103], a[120:123], v[216:219]
  v_mfma_f32_16x16x32_bf16 v[220:223], v[100:103], a[124:127], v[220:223]
  v_max3_f32 v56, v192, v193, v56
  v_max3_f32 v57, v196, v197, v57
  v_mfma_f32_16x16x32_bf16 v[224:227], v[104:107], a[112:115], v[224:227]
  v_max3_f32 v58, v200, v201, v58
  v_max3_f32 v59, v204, v205, v59
  v_mfma_f32_16x16x32_bf16 v[228:231], v[104:107], a[116:119], v[228:231]
  v_mfma_f32_16x16x32_bf16 v[232:235], v[104:107], a[120:123], v[232:235]
  v_max3_f32 v56, v194, v195, v56
  v_max3_f32 v57, v198, v199, v57
  v_mfma_f32_16x16x32_bf16 v[236:239], v[104:107], a[124:127], v[236:239]
  v_max3_f32 v58, v202, v203, v58
  v_max3_f32 v59, v206, v207, v59
  v_mfma_f32_16x16x32_bf16 v[240:243], v[108:111], a[112:115], v[240:243]
  v_max3_f32 v56, v208, v209, v56
  v_max3_f32 v57, v212, v213, v57
  v_mfma_f32_16x16x32_bf16 v[244:247], v[108:111], a[116:119], v[244:247]
  v_mfma_f32_16x16x32_bf16 v[248:251], v[108:111], a[120:123], v[248:251]
  s_add_u32 m0, s46, 16384
  s_add_u32 s57, s57, 16384
  v_max3_f32 v58, v216, v217, v58
  v_max3_f32 v59, v220, v221, v59
  v_mfma_f32_16x16x32_bf16 v[252:255], v[108:111], a[124:127], v[252:255]
  v_max3_f32 v56, v210, v211, v56
  v_max3_f32 v57, v214, v215, v57
  v_max3_f32 v58, v218, v219, v58
  v_max3_f32 v59, v222, v223, v59
  v_max3_f32 v56, v224, v225, v56
  v_max3_f32 v57, v228, v229, v57
  v_max3_f32 v58, v232, v233, v58
  v_max3_f32 v59, v236, v237, v59
  v_max3_f32 v56, v226, v227, v56
  v_max3_f32 v57, v230, v231, v57
  v_max3_f32 v58, v234, v235, v58
  v_max3_f32 v59, v238, v239, v59
  v_max3_f32 v56, v240, v241, v56
  v_max3_f32 v57, v244, v245, v57
  v_max3_f32 v58, v248, v249, v58
  v_max3_f32 v59, v252, v253, v59
  v_max3_f32 v56, v242, v243, v56
  v_max3_f32 v57, v246, v247, v57
  v_max3_f32 v58, v250, v251, v58
  v_max3_f32 v59, v254, v255, v59
  s_nop 1
  v_permlane32_swap_b32 v56, v57
  v_permlane32_swap_b32 v58, v59
  s_nop 1
  v_max_f32 v56, v56, v57
  v_max_f32 v58, v58, v59
  s_nop 1
  v_permlane16_swap_b32 v56, v58
  s_nop 1
  v_max_f32 v56, v56, v58
  ds_write_b32 v47, v56 offset:30720
  s_waitcnt lgkmcnt(0)
  s_barrier
  ds_read_b128 v[64:67], v48 offset:30720
  ds_read_b128 v[68:71], v48 offset:30976
  ds_read_b128 v[72:75], v48 offset:31232
  ds_read_b128 v[76:79], v48 offset:31488
  s_waitcnt lgkmcnt(0)
  v_max3_f32 v64, v64, v65, v66
  v_max3_f32 v68, v68, v69, v70
  v_max3_f32 v72, v72, v73, v74
  v_max3_f32 v76, v76, v77, v78
  v_max_f32 v64, v64, v67
  v_max_f32 v68, v68, v71
  v_max_f32 v72, v72, v75
  v_max_f32 v76, v76, v79
  v_mul_f32 v112, s54, v64
  v_mul_f32 v114, s54, v68
  v_mul_f32 v116, s54, v72
  v_mul_f32 v118, s54, v76
  v_pk_fma_f32 v[128:129], v[128:129], s[54:55], v[112:113] op_sel_hi:[1,1,0] neg_lo:[0,0,1] neg_hi:[0,0,1]
  v_pk_fma_f32 v[130:131], v[130:131], s[54:55], v[112:113] op_sel_hi:[1,1,0] neg_lo:[0,0,1] neg_hi:[0,0,1]
  v_pk_fma_f32 v[144:145], v[144:145], s[54:55], v[112:113] op_sel_hi:[1,1,0] neg_lo:[0,0,1] neg_hi:[0,0,1]
  v_pk_fma_f32 v[146:147], v[146:147], s[54:55], v[112:113] op_sel_hi:[1,1,0] neg_lo:[0,0,1] neg_hi:[0,0,1]
  v_exp_f32 v128, v128
  v_exp_f32 v129, v129
  v_exp_f32 v130, v130
  v_exp_f32 v131, v131
  v_exp_f32 v144, v144
  v_exp_f32 v145, v145
  v_exp_f32 v146, v146
  v_exp_f32 v147, v147
  v_cvt_pk_bf16_f32 v64, v128, v129
  v_cvt_pk_bf16_f32 v65, v130, v131
  v_cvt_pk_bf16_f32 v66, v144, v145
  v_cvt_pk_bf16_f32 v67, v146, v147
  ds_write_b128 v41, v[64:67] offset:0
  v_pk_add_f32 v[128:129], v[128:129], v[130:131]
  v_pk_add_f32 v[144:145], v[144:145], v[146:147]
  v_pk_add_f32 v[120:121], v[128:129], v[144:145]
  v_pk_fma_f32 v[132:133], v[132:133], s[54:55], v[114:115] op_sel_hi:[1,1,0] neg_lo:[0,0,1] neg_hi:[0,0,1]
  v_pk_fma_f32 v[134:135], v[134:135], s[54:55], v[114:115] op_sel_hi:[1,1,0] neg_lo:[0,0,1] neg_hi:[0,0,1]
  v_pk_fma_f32 v[148:149], v[148:149], s[54:55], v[114:115] op_sel_hi:[1,1,0] neg_lo:[0,0,1] neg_hi:[0,0,1]
  v_pk_fma_f32 v[150:151], v[150:151], s[54:55], v[114:115] op_sel_hi:[1,1,0] neg_lo:[0,0,1] neg_hi:[0,0,1]
  v_exp_f32 v132, v132
  v_exp_f32 v133, v133
  v_exp_f32 v134, v134
  v_exp_f32 v135, v135
  v_exp_f32 v148, v148
  v_exp_f32 v149, v149
  v_exp_f32 v150, v150
  v_exp_f32 v151, v151
  v_cvt_pk_bf16_f32 v68, v132, v133
  v_cvt_pk_bf16_f32 v69, v134, v135
  v_cvt_pk_bf16_f32 v70, v148, v149
  v_cvt_pk_bf16_f32 v71, v150, v151
  ds_write_b128 v41, v[68:71] offset:1024
  v_pk_add_f32 v[132:133], v[132:133], v[134:135]
  v_pk_add_f32 v[148:149], v[148:149], v[150:151]
  v_pk_add_f32 v[122:123], v[132:133], v[148:149]
  v_pk_fma_f32 v[136:137], v[136:137], s[54:55], v[116:117] op_sel_hi:[1,1,0] neg_lo:[0,0,1] neg_hi:[0,0,1]
  v_pk_fma_f32 v[138:139], v[138:139], s[54:55], v[116:117] op_sel_hi:[1,1,0] neg_lo:[0,0,1] neg_hi:[0,0,1]
  v_pk_fma_f32 v[152:153], v[152:153], s[54:55], v[116:117] op_sel_hi:[1,1,0] neg_lo:[0,0,1] neg_hi:[0,0,1]
  v_pk_fma_f32 v[154:155], v[154:155], s[54:55], v[116:117] op_sel_hi:[1,1,0] neg_lo:[0,0,1] neg_hi:[0,0,1]
  v_exp_f32 v136, v136
  v_exp_f32 v137, v137
  v_exp_f32 v138, v138
  v_exp_f32 v139, v139
  v_exp_f32 v152, v152
  v_exp_f32 v153, v153
  v_exp_f32 v154, v154
  v_exp_f32 v155, v155
  v_cvt_pk_bf16_f32 v72, v136, v137
  v_cvt_pk_bf16_f32 v73, v138, v139
  v_cvt_pk_bf16_f32 v74, v152, v153
  v_cvt_pk_bf16_f32 v75, v154, v155
  ds_write_b128 v41, v[72:75] offset:2048
  v_pk_add_f32 v[136:137], v[136:137], v[138:139]
  v_pk_add_f32 v[152:153], v[152:153], v[154:155]
  v_pk_add_f32 v[124:125], v[136:137], v[152:153]
  buffer_load_dwordx4 v14, s[24:27], s57 offen lds
  v_pk_fma_f32 v[140:141], v[140:141], s[54:55], v[118:119] op_sel_hi:[1,1,0] neg_lo:[0,0,1] neg_hi:[0,0,1]
  v_pk_fma_f32 v[142:143], v[142:143], s[54:55], v[118:119] op_sel_hi:[1,1,0] neg_lo:[0,0,1] neg_hi:[0,0,1]
  v_pk_fma_f32 v[156:157], v[156:157], s[54:55], v[118:119] op_sel_hi:[1,1,0] neg_lo:[0,0,1] neg_hi:[0,0,1]
  v_pk_fma_f32 v[158:159], v[158:159], s[54:55], v[118:119] op_sel_hi:[1,1,0] neg_lo:[0,0,1] neg_hi:[0,0,1]
  v_exp_f32 v140, v140
  v_exp_f32 v141, v141
  v_exp_f32 v142, v142
  v_exp_f32 v143, v143
  v_exp_f32 v156, v156
  v_exp_f32 v157, v157
  v_exp_f32 v158, v158
  v_exp_f32 v159, v159
  v_cvt_pk_bf16_f32 v76, v140, v141
  v_cvt_pk_bf16_f32 v77, v142, v143
  v_cvt_pk_bf16_f32 v78, v156, v157
  v_cvt_pk_bf16_f32 v79, v158, v159
  ds_write_b128 v41, v[76:79] offset:3072
  v_pk_add_f32 v[140:141], v[140:141], v[142:143]
  v_pk_add_f32 v[156:157], v[156:157], v[158:159]
  v_pk_add_f32 v[126:127], v[140:141], v[156:157]
  buffer_load_dwordx4 v15, s[24:27], s57 offen offset:1024 lds
  v_pk_fma_f32 v[160:161], v[160:161], s[54:55], v[112:113] op_sel_hi:[1,1,0] neg_lo:[0,0,1] neg_hi:[0,0,1]
  v_pk_fma_f32 v[162:163], v[162:163], s[54:55], v[112:113] op_sel_hi:[1,1,0] neg_lo:[0,0,1] neg_hi:[0,0,1]
  v_pk_fma_f32 v[176:177], v[176:177], s[54:55], v[112:113] op_sel_hi:[1,1,0] neg_lo:[0,0,1] neg_hi:[0,0,1]
  v_pk_fma_f32 v[178:179], v[178:179], s[54:55], v[112:113] op_sel_hi:[1,1,0] neg_lo:[0,0,1] neg_hi:[0,0,1]
  v_exp_f32 v160, v160
  v_exp_f32 v161, v161
  v_exp_f32 v162, v162
  v_exp_f32 v163, v163
  v_exp_f32 v176, v176
  v_exp_f32 v177, v177
  v_exp_f32 v178, v178
  v_exp_f32 v179, v179
  v_cvt_pk_bf16_f32 v80, v160, v161
  v_cvt_pk_bf16_f32 v81, v162, v163
  v_cvt_pk_bf16_f32 v82, v176, v177
  v_cvt_pk_bf16_f32 v83, v178, v179
  ds_write_b128 v41, v[80:83] offset:4096
  v_pk_add_f32 v[160:161], v[160:161], v[162:163]
  v_pk_add_f32 v[176:177], v[176:177], v[178:179]
  v_pk_add_f32 v[160:161], v[160:161], v[176:177]
  v_pk_add_f32 v[120:121], v[120:121], v[160:161]
  s_add_u32 m0, s46, 18432
  s_nop 0
  buffer_load_dwordx4 v16, s[24:27], s57 offen lds
  v_pk_fma_f32 v[164:165], v[164:165], s[54:55], v[114:115] op_sel_hi:[1,1,0] neg_lo:[0,0,1] neg_hi:[0,0,1]
  v_pk_fma_f32 v[166:167], v[166:167], s[54:55], v[114:115] op_sel_hi:[1,1,0] neg_lo:[0,0,1] neg_hi:[0,0,1]
  v_pk_fma_f32 v[180:181], v[180:181], s[54:55], v[114:115] op_sel_hi:[1,1,0] neg_lo:[0,0,1] neg_hi:[0,0,1]
  v_pk_fma_f32 v[182:183], v[182:183], s[54:55], v[114:115] op_sel_hi:[1,1,0] neg_lo:[0,0,1] neg_hi:[0,0,1]
  v_exp_f32 v164, v164
  v_exp_f32 v165, v165
  v_exp_f32 v166, v166
  v_exp_f32 v167, v167
  v_exp_f32 v180, v180
  v_exp_f32 v181, v181
  v_exp_f32 v182, v182
  v_exp_f32 v183, v183
  v_cvt_pk_bf16_f32 v84, v164, v165
  v_cvt_pk_bf16_f32 v85, v166, v167
  v_cvt_pk_bf16_f32 v86, v180, v181
  v_cvt_pk_bf16_f32 v87, v182, v183
  ds_write_b128 v41, v[84:87] offset:5120
  v_pk_add_f32 v[164:165], v[164:165], v[166:167]
  v_pk_add_f32 v[180:181], v[180:181], v[182:183]
  v_pk_add_f32 v[164:165], v[164:165], v[180:181]
  v_pk_add_f32 v[122:123], v[122:123], v[164:165]
  buffer_load_dwordx4 v17, s[24:27], s57 offen offset:1024 lds
  v_pk_fma_f32 v[168:169], v[168:169], s[54:55], v[116:117] op_sel_hi:[1,1,0] neg_lo:[0,0,1] neg_hi:[0,0,1]
  v_pk_fma_f32 v[170:171], v[170:171], s[54:55], v[116:117] op_sel_hi:[1,1,0] neg_lo:[0,0,1] neg_hi:[0,0,1]
  v_pk_fma_f32 v[184:185], v[184:185], s[54:55], v[116:117] op_sel_hi:[1,1,0] neg_lo:[0,0,1] neg_hi:[0,0,1]
  v_pk_fma_f32 v[186:187], v[186:187], s[54:55], v[116:117] op_sel_hi:[1,1,0] neg_lo:[0,0,1] neg_hi:[0,0,1]
  v_exp_f32 v168, v168
  v_exp_f32 v169, v169
  v_exp_f32 v170, v170
  v_exp_f32 v171, v171
  v_exp_f32 v184, v184
  v_exp_f32 v185, v185
  v_exp_f32 v186, v186
  v_exp_f32 v187, v187
  v_cvt_pk_bf16_f32 v88, v168, v169
  v_cvt_pk_bf16_f32 v89, v170, v171
  v_cvt_pk_bf16_f32 v90, v184, v185
  v_cvt_pk_bf16_f32 v91, v186, v187
  ds_write_b128 v41, v[88:91] offset:6144
  v_pk_add_f32 v[168:169], v[168:169], v[170:171]
  v_pk_add_f32 v[184:185], v[184:185], v[186:187]
  v_pk_add_f32 v[168:169], v[168:169], v[184:185]
  v_pk_add_f32 v[124:125], v[124:125], v[168:169]
  s_add_u32 m0, s46, 20480
  s_add_u32 s57, s57, 16384
  buffer_load_dwordx4 v14, s[24:27], s57 offen lds
  v_pk_fma_f32 v[172:173], v[172:173], s[54:55], v[118:119] op_sel_hi:[1,1,0] neg_lo:[0,0,1] neg_hi:[0,0,1]
  v_pk_fma_f32 v[174:175], v[174:175], s[54:55], v[118:119] op_sel_hi:[1,1,0] neg_lo:[0,0,1] neg_hi:[0,0,1]
  v_pk_fma_f32 v[188:189], v[188:189], s[54:55], v[118:119] op_sel_hi:[1,1,0] neg_lo:[0,0,1] neg_hi:[0,0,1]
  v_pk_fma_f32 v[190:191], v[190:191], s[54:55], v[118:119] op_sel_hi:[1,1,0] neg_lo:[0,0,1] neg_hi:[0,0,1]
  v_exp_f32 v172, v172
  v_exp_f32 v173, v173
  v_exp_f32 v174, v174
  v_exp_f32 v175, v175
  v_exp_f32 v188, v188
  v_exp_f32 v189, v189
  v_exp_f32 v190, v190
  v_exp_f32 v191, v191
  v_cvt_pk_bf16_f32 v92, v172, v173
  v_cvt_pk_bf16_f32 v93, v174, v175
  v_cvt_pk_bf16_f32 v94, v188, v189
  v_cvt_pk_bf16_f32 v95, v190, v191
  ds_write_b128 v41, v[92:95] offset:7168
  v_pk_add_f32 v[172:173], v[172:173], v[174:175]
  v_pk_add_f32 v[188:189], v[188:189], v[190:191]
  v_pk_add_f32 v[172:173], v[172:173], v[188:189]
  v_pk_add_f32 v[126:127], v[126:127], v[172:173]
  buffer_load_dwordx4 v15, s[24:27], s57 offen offset:1024 lds
  v_pk_fma_f32 v[192:193], v[192:193], s[54:55], v[112:113] op_sel_hi:[1,1,0] neg_lo:[0,0,1] neg_hi:[0,0,1]
  v_pk_fma_f32 v[194:195], v[194:195], s[54:55], v[112:113] op_sel_hi:[1,1,0] neg_lo:[0,0,1] neg_hi:[0,0,1]
  v_pk_fma_f32 v[208:209], v[208:209], s[54:55], v[112:113] op_sel_hi:[1,1,0] neg_lo:[0,0,1] neg_hi:[0,0,1]
  v_pk_fma_f32 v[210:211], v[210:211], s[54:55], v[112:113] op_sel_hi:[1,1,0] neg_lo:[0,0,1] neg_hi:[0,0,1]
  v_exp_f32 v192, v192
  v_exp_f32 v193, v193
  v_exp_f32 v194, v194
  v_exp_f32 v195, v195
  v_exp_f32 v208, v208
  v_exp_f32 v209, v209
  v_exp_f32 v210, v210
  v_exp_f32 v211, v211
  v_cvt_pk_bf16_f32 v64, v192, v193
  v_cvt_pk_bf16_f32 v65, v194, v195
  v_cvt_pk_bf16_f32 v66, v208, v209
  v_cvt_pk_bf16_f32 v67, v210, v211
  ds_write_b128 v41, v[64:67] offset:8192
  v_pk_add_f32 v[192:193], v[192:193], v[194:195]
  v_pk_add_f32 v[208:209], v[208:209], v[210:211]
  v_pk_add_f32 v[192:193], v[192:193], v[208:209]
  v_pk_add_f32 v[120:121], v[120:121], v[192:193]
  s_add_u32 m0, s46, 22528
  s_nop 0
  buffer_load_dwordx4 v16, s[24:27], s57 offen lds
  v_pk_fma_f32 v[196:197], v[196:197], s[54:55], v[114:115] op_sel_hi:[1,1,0] neg_lo:[0,0,1] neg_hi:[0,0,1]
  v_pk_fma_f32 v[198:199], v[198:199], s[54:55], v[114:115] op_sel_hi:[1,1,0] neg_lo:[0,0,1] neg_hi:[0,0,1]
  v_pk_fma_f32 v[212:213], v[212:213], s[54:55], v[114:115] op_sel_hi:[1,1,0] neg_lo:[0,0,1] neg_hi:[0,0,1]
  v_pk_fma_f32 v[214:215], v[214:215], s[54:55], v[114:115] op_sel_hi:[1,1,0] neg_lo:[0,0,1] neg_hi:[0,0,1]
  v_exp_f32 v196, v196
  v_exp_f32 v197, v197
  v_exp_f32 v198, v198
  v_exp_f32 v199, v199
  v_exp_f32 v212, v212
  v_exp_f32 v213, v213
  v_exp_f32 v214, v214
  v_exp_f32 v215, v215
  v_cvt_pk_bf16_f32 v68, v196, v197
  v_cvt_pk_bf16_f32 v69, v198, v199
  v_cvt_pk_bf16_f32 v70, v212, v213
  v_cvt_pk_bf16_f32 v71, v214, v215
  ds_write_b128 v41, v[68:71] offset:9216
  v_pk_add_f32 v[196:197], v[196:197], v[198:199]
  v_pk_add_f32 v[212:213], v[212:213], v[214:215]
  v_pk_add_f32 v[196:197], v[196:197], v[212:213]
  v_pk_add_f32 v[122:123], v[122:123], v[196:197]
  buffer_load_dwordx4 v17, s[24:27], s57 offen offset:1024 lds
  v_pk_fma_f32 v[200:201], v[200:201], s[54:55], v[116:117] op_sel_hi:[1,1,0] neg_lo:[0,0,1] neg_hi:[0,0,1]
  v_pk_fma_f32 v[202:203], v[202:203], s[54:55], v[116:117] op_sel_hi:[1,1,0] neg_lo:[0,0,1] neg_hi:[0,0,1]
  v_pk_fma_f32 v[216:217], v[216:217], s[54:55], v[116:117] op_sel_hi:[1,1,0] neg_lo:[0,0,1] neg_hi:[0,0,1]
  v_pk_fma_f32 v[218:219], v[218:219], s[54:55], v[116:117] op_sel_hi:[1,1,0] neg_lo:[0,0,1] neg_hi:[0,0,1]
  v_exp_f32 v200, v200
  v_exp_f32 v201, v201
  v_exp_f32 v202, v202
  v_exp_f32 v203, v203
  v_exp_f32 v216, v216
  v_exp_f32 v217, v217
  v_exp_f32 v218, v218
  v_exp_f32 v219, v219
  v_cvt_pk_bf16_f32 v72, v200, v201
  v_cvt_pk_bf16_f32 v73, v202, v203
  v_cvt_pk_bf16_f32 v74, v216, v217
  v_cvt_pk_bf16_f32 v75, v218, v219
  ds_write_b128 v41, v[72:75] offset:10240
  v_pk_add_f32 v[200:201], v[200:201], v[202:203]
  v_pk_add_f32 v[216:217], v[216:217], v[218:219]
  v_pk_add_f32 v[200:201], v[200:201], v[216:217]
  v_pk_add_f32 v[124:125], v[124:125], v[200:201]
  buffer_load_dwordx4 a[140:143], v29, s[32:35], s13 offen offset:0
  v_pk_fma_f32 v[204:205], v[204:205], s[54:55], v[118:119] op_sel_hi:[1,1,0] neg_lo:[0,0,1] neg_hi:[0,0,1]
  v_pk_fma_f32 v[206:207], v[206:207], s[54:55], v[118:119] op_sel_hi:[1,1,0] neg_lo:[0,0,1] neg_hi:[0,0,1]
  v_pk_fma_f32 v[220:221], v[220:221], s[54:55], v[118:119] op_sel_hi:[1,1,0] neg_lo:[0,0,1] neg_hi:[0,0,1]
  v_pk_fma_f32 v[222:223], v[222:223], s[54:55], v[118:119] op_sel_hi:[1,1,0] neg_lo:[0,0,1] neg_hi:[0,0,1]
  v_exp_f32 v204, v204
  v_exp_f32 v205, v205
  v_exp_f32 v206, v206
  v_exp_f32 v207, v207
  v_exp_f32 v220, v220
  v_exp_f32 v221, v221
  v_exp_f32 v222, v222
  v_exp_f32 v223, v223
  v_cvt_pk_bf16_f32 v76, v204, v205
  v_cvt_pk_bf16_f32 v77, v206, v207
  v_cvt_pk_bf16_f32 v78, v220, v221
  v_cvt_pk_bf16_f32 v79, v222, v223
  ds_write_b128 v41, v[76:79] offset:11264
  v_pk_add_f32 v[204:205], v[204:205], v[206:207]
  v_pk_add_f32 v[220:221], v[220:221], v[222:223]
  v_pk_add_f32 v[204:205], v[204:205], v[220:221]
  v_pk_add_f32 v[126:127], v[126:127], v[204:205]
  buffer_load_dwordx4 a[136:139], v29, s[32:35], s13 offen offset:1024
  v_pk_fma_f32 v[224:225], v[224:225], s[54:55], v[112:113] op_sel_hi:[1,1,0] neg_lo:[0,0,1] neg_hi:[0,0,1]
  v_pk_fma_f32 v[226:227], v[226:227], s[54:55], v[112:113] op_sel_hi:[1,1,0] neg_lo:[0,0,1] neg_hi:[0,0,1]
  v_pk_fma_f32 v[240:241], v[240:241], s[54:55], v[112:113] op_sel_hi:[1,1,0] neg_lo:[0,0,1] neg_hi:[0,0,1]
  v_pk_fma_f32 v[242:243], v[242:243], s[54:55], v[112:113] op_sel_hi:[1,1,0] neg_lo:[0,0,1] neg_hi:[0,0,1]
  v_exp_f32 v224, v224
  v_exp_f32 v225, v225
  v_exp_f32 v226, v226
  v_exp_f32 v227, v227
  v_exp_f32 v240, v240
  v_exp_f32 v241, v241
  v_exp_f32 v242, v242
  v_exp_f32 v243, v243
  v_cvt_pk_bf16_f32 v80, v224, v225
  v_cvt_pk_bf16_f32 v81, v226, v227
  v_cvt_pk_bf16_f32 v82, v240, v241
  v_cvt_pk_bf16_f32 v83, v242, v243
  ds_write_b128 v41, v[80:83] offset:12288
  v_pk_add_f32 v[224:225], v[224:225], v[226:227]
  v_pk_add_f32 v[240:241], v[240:241], v[242:243]
  v_pk_add_f32 v[224:225], v[224:225], v[240:241]
  v_pk_add_f32 v[120:121], v[120:121], v[224:225]
  buffer_load_dwordx4 a[132:135], v29, s[32:35], s13 offen offset:2048
  v_pk_fma_f32 v[228:229], v[228:229], s[54:55], v[114:115] op_sel_hi:[1,1,0] neg_lo:[0,0,1] neg_hi:[0,0,1]
  v_pk_fma_f32 v[230:231], v[230:231], s[54:55], v[114:115] op_sel_hi:[1,1,0] neg_lo:[0,0,1] neg_hi:[0,0,1]
  v_pk_fma_f32 v[244:245], v[244:245], s[54:55], v[114:115] op_sel_hi:[1,1,0] neg_lo:[0,0,1] neg_hi:[0,0,1]
  v_pk_fma_f32 v[246:247], v[246:247], s[54:55], v[114:115] op_sel_hi:[1,1,0] neg_lo:[0,0,1] neg_hi:[0,0,1]
  v_exp_f32 v228, v228
  v_exp_f32 v229, v229
  v_exp_f32 v230, v230
  v_exp_f32 v231, v231
  v_exp_f32 v244, v244
  v_exp_f32 v245, v245
  v_exp_f32 v246, v246
  v_exp_f32 v247, v247
  v_cvt_pk_bf16_f32 v84, v228, v229
  v_cvt_pk_bf16_f32 v85, v230, v231
  v_cvt_pk_bf16_f32 v86, v244, v245
  v_cvt_pk_bf16_f32 v87, v246, v247
  ds_write_b128 v41, v[84:87] offset:13312
  v_pk_add_f32 v[228:229], v[228:229], v[230:231]
  v_pk_add_f32 v[244:245], v[244:245], v[246:247]
  v_pk_add_f32 v[228:229], v[228:229], v[244:245]
  v_pk_add_f32 v[122:123], v[122:123], v[228:229]
  buffer_load_dwordx4 a[128:131], v29, s[32:35], s13 offen offset:2560
  v_pk_fma_f32 v[232:233], v[232:233], s[54:55], v[116:117] op_sel_hi:[1,1,0] neg_lo:[0,0,1] neg_hi:[0,0,1]
  v_pk_fma_f32 v[234:235], v[234:235], s[54:55], v[116:117] op_sel_hi:[1,1,0] neg_lo:[0,0,1] neg_hi:[0,0,1]
  v_pk_fma_f32 v[248:249], v[248:249], s[54:55], v[116:117] op_sel_hi:[1,1,0] neg_lo:[0,0,1] neg_hi:[0,0,1]
  v_pk_fma_f32 v[250:251], v[250:251], s[54:55], v[116:117] op_sel_hi:[1,1,0] neg_lo:[0,0,1] neg_hi:[0,0,1]
  v_exp_f32 v232, v232
  v_exp_f32 v233, v233
  v_exp_f32 v234, v234
  v_exp_f32 v235, v235
  v_exp_f32 v248, v248
  v_exp_f32 v249, v249
  v_exp_f32 v250, v250
  v_exp_f32 v251, v251
  v_cvt_pk_bf16_f32 v88, v232, v233
  v_cvt_pk_bf16_f32 v89, v234, v235
  v_cvt_pk_bf16_f32 v90, v248, v249
  v_cvt_pk_bf16_f32 v91, v250, v251
  ds_write_b128 v41, v[88:91] offset:14336
  v_pk_add_f32 v[232:233], v[232:233], v[234:235]
  v_pk_add_f32 v[248:249], v[248:249], v[250:251]
  v_pk_add_f32 v[232:233], v[232:233], v[248:249]
  v_pk_add_f32 v[124:125], v[124:125], v[232:233]
  s_add_u32 m0, s46, 24576
  s_add_u32 s57, s57, 16384
  s_and_b32 s57, s57, 0x3ffff
  buffer_load_dwordx4 v14, s[24:27], s57 offen lds
  v_pk_fma_f32 v[236:237], v[236:237], s[54:55], v[118:119] op_sel_hi:[1,1,0] neg_lo:[0,0,1] neg_hi:[0,0,1]
  v_pk_fma_f32 v[238:239], v[238:239], s[54:55], v[118:119] op_sel_hi:[1,1,0] neg_lo:[0,0,1] neg_hi:[0,0,1]
  v_pk_fma_f32 v[252:253], v[252:253], s[54:55], v[118:119] op_sel_hi:[1,1,0] neg_lo:[0,0,1] neg_hi:[0,0,1]
  v_pk_fma_f32 v[254:255], v[254:255], s[54:55], v[118:119] op_sel_hi:[1,1,0] neg_lo:[0,0,1] neg_hi:[0,0,1]
  v_exp_f32 v236, v236
  v_exp_f32 v237, v237
  v_exp_f32 v238, v238
  v_exp_f32 v239, v239
  v_exp_f32 v252, v252
  v_exp_f32 v253, v253
  v_exp_f32 v254, v254
  v_exp_f32 v255, v255
  v_cvt_pk_bf16_f32 v92, v236, v237
  v_cvt_pk_bf16_f32 v93, v238, v239
  v_cvt_pk_bf16_f32 v94, v252, v253
  v_cvt_pk_bf16_f32 v95, v254, v255
  ds_write_b128 v41, v[92:95] offset:15360
  v_pk_add_f32 v[236:237], v[236:237], v[238:239]
  v_pk_add_f32 v[252:253], v[252:253], v[254:255]
  v_pk_add_f32 v[236:237], v[236:237], v[252:253]
  v_pk_add_f32 v[126:127], v[126:127], v[236:237]
  buffer_load_dwordx4 v15, s[24:27], s57 offen offset:1024 lds
  buffer_load_dwordx2 v[4:5], v8, s[80:83], 0 offen sc1
  s_waitcnt lgkmcnt(0)
  s_waitcnt vmcnt(19)
  ds_read_b64_tr_b16 v[64:65], v31 offset:32768
  ds_read_b128 v[80:83], v41 offset:0
  ds_read_b64_tr_b16 v[66:67], v31 offset:34816
  ds_read_b128 v[84:87], v41 offset:1024
  ds_read_b64_tr_b16 v[68:69], v32 offset:32768
  ds_read_b128 v[88:91], v41 offset:2048
  ds_read_b64_tr_b16 v[70:71], v32 offset:34816
  ds_read_b128 v[92:95], v41 offset:3072
  ds_read_b64_tr_b16 v[72:73], v33 offset:32768
  ds_read_b64_tr_b16 v[74:75], v33 offset:34816
  ds_read_b64_tr_b16 v[76:77], v34 offset:32768
  ds_read_b64_tr_b16 v[78:79], v34 offset:34816
  v_add_f32 v60, v120, v121
  v_add_f32 v61, v122, v123
  v_add_f32 v62, v124, v125
  v_add_f32 v63, v126, v127
  s_nop 1
  v_permlane32_swap_b32 v60, v61
  v_permlane32_swap_b32 v62, v63
  s_nop 1
  v_add_f32 v60, v60, v61
  v_add_f32 v62, v62, v63
  s_nop 1
  v_permlane16_swap_b32 v60, v62
  s_nop 1
  v_add_f32 v60, v60, v62
  ds_write_b32 v47, v60 offset:31744
  s_waitcnt vmcnt(15) lgkmcnt(1)
  v_mfma_f32_16x16x32_bf16 v[128:131], v[64:67], v[80:83], 0
  s_add_u32 m0, s46, 26624
  ds_read_b64_tr_b16 v[96:97], v31 offset:36864
  ds_read_b128 v[112:115], v41 offset:4096
  v_mfma_f32_16x16x32_bf16 v[132:135], v[64:67], v[84:87], 0
  buffer_load_dwordx4 v16, s[24:27], s57 offen lds
  v_mfma_f32_16x16x32_bf16 v[136:139], v[64:67], v[88:91], 0
  ds_read_b64_tr_b16 v[98:99], v31 offset:38912
  ds_read_b128 v[116:119], v41 offset:5120
  v_mfma_f32_16x16x32_bf16 v[140:143], v[64:67], v[92:95], 0
  buffer_load_dwordx4 v17, s[24:27], s57 offen offset:1024 lds
  v_mfma_f32_16x16x32_bf16 v[144:147], v[68:71], v[80:83], 0
  s_add_u32 m0, s46, 28672
  s_add_u32 s57, s57, 16384
  ds_read_b64_tr_b16 v[100:101], v32 offset:36864
  ds_read_b128 v[120:123], v41 offset:6144
  v_mfma_f32_16x16x32_bf16 v[148:151], v[68:71], v[84:87], 0
  buffer_load_dwordx4 v14, s[24:27], s57 offen lds
  v_mfma_f32_16x16x32_bf16 v[152:155], v[68:71], v[88:91], 0
  ds_read_b64_tr_b16 v[102:103], v32 offset:38912
  ds_read_b128 v[124:127], v41 offset:7168
  v_mfma_f32_16x16x32_bf16 v[156:159], v[68:71], v[92:95], 0
  v_mfma_f32_16x16x32_bf16 v[160:163], v[72:75], v[80:83], 0
  ds_read_b64_tr_b16 v[104:105], v33 offset:36864
  ds_read_b64_tr_b16 v[106:107], v33 offset:38912
  v_mfma_f32_16x16x32_bf16 v[164:167], v[72:75], v[84:87], 0
  buffer_load_dwordx4 v15, s[24:27], s57 offen offset:1024 lds
  v_mfma_f32_16x16x32_bf16 v[168:171], v[72:75], v[88:91], 0
  ds_read_b64_tr_b16 v[108:109], v34 offset:36864
  ds_read_b64_tr_b16 v[110:111], v34 offset:38912
  v_mfma_f32_16x16x32_bf16 v[172:175], v[72:75], v[92:95], 0
  v_mfma_f32_16x16x32_bf16 v[176:179], v[76:79], v[80:83], 0
  s_add_u32 m0, s46, 32768
  v_mfma_f32_16x16x32_bf16 v[180:183], v[76:79], v[84:87], 0
  buffer_load_dwordx4 v16, s[24:27], s57 offen lds
  v_mfma_f32_16x16x32_bf16 v[184:187], v[76:79], v[88:91], 0
  v_mfma_f32_16x16x32_bf16 v[188:191], v[76:79], v[92:95], 0
  s_waitcnt vmcnt(16) lgkmcnt(0)
  v_mfma_f32_16x16x32_bf16 v[128:131], v[96:99], v[112:115], v[128:131]
  ds_read_b64_tr_b16 v[64:65], v31 offset:16384
  ds_read_b128 v[80:83], v41 offset:8192
  v_mfma_f32_16x16x32_bf16 v[132:135], v[96:99], v[116:119], v[132:135]
  buffer_load_dwordx4 v17, s[24:27], s57 offen offset:1024 lds
  v_mfma_f32_16x16x32_bf16 v[136:139], v[96:99], v[120:123], v[136:139]
  s_add_u32 m0, s46, 34816
  s_add_u32 s57, s57, 16384
  ds_read_b64_tr_b16 v[66:67], v31 offset:18432
  ds_read_b128 v[84:87], v41 offset:9216
  v_mfma_f32_16x16x32_bf16 v[140:143], v[96:99], v[124:127], v[140:143]
  buffer_load_dwordx4 v14, s[24:27], s57 offen lds
  v_mfma_f32_16x16x32_bf16 v[144:147], v[100:103], v[112:115], v[144:147]
  ds_read_b64_tr_b16 v[68:69], v32 offset:16384
  ds_read_b128 v[88:91], v41 offset:10240
  v_mfma_f32_16x16x32_bf16 v[148:151], v[100:103], v[116:119], v[148:151]
  buffer_load_dwordx4 v15, s[24:27], s57 offen offset:1024 lds
  v_mfma_f32_16x16x32_bf16 v[152:155], v[100:103], v[120:123], v[152:155]
  ds_read_b64_tr_b16 v[70:71], v32 offset:18432
  ds_read_b128 v[92:95], v41 offset:11264
  v_mfma_f32_16x16x32_bf16 v[156:159], v[100:103], v[124:127], v[156:159]
  v_mfma_f32_16x16x32_bf16 v[160:163], v[104:107], v[112:115], v[160:163]
  s_add_u32 m0, s46, 36864
  ds_read_b64_tr_b16 v[72:73], v33 offset:16384
  ds_read_b64_tr_b16 v[74:75], v33 offset:18432
  v_mfma_f32_16x16x32_bf16 v[164:167], v[104:107], v[116:119], v[164:167]
  buffer_load_dwordx4 v16, s[24:27], s57 offen lds
  v_mfma_f32_16x16x32_bf16 v[168:171], v[104:107], v[120:123], v[168:171]
  ds_read_b64_tr_b16 v[76:77], v34 offset:16384
  ds_read_b64_tr_b16 v[78:79], v34 offset:18432
  v_mfma_f32_16x16x32_bf16 v[172:175], v[104:107], v[124:127], v[172:175]
  v_mfma_f32_16x16x32_bf16 v[176:179], v[108:111], v[112:115], v[176:179]
  v_mfma_f32_16x16x32_bf16 v[180:183], v[108:111], v[116:119], v[180:183]
  buffer_load_dwordx4 v17, s[24:27], s57 offen offset:1024 lds
  v_mfma_f32_16x16x32_bf16 v[184:187], v[108:111], v[120:123], v[184:187]
  v_mfma_f32_16x16x32_bf16 v[188:191], v[108:111], v[124:127], v[188:191]
  s_waitcnt vmcnt(17) lgkmcnt(0)
  v_mfma_f32_16x16x32_bf16 v[128:131], v[64:67], v[80:83], v[128:131]
  s_add_u32 m0, s46, 38912
  s_add_u32 s57, s57, 16384
  ds_read_b64_tr_b16 v[96:97], v31 offset:20480
  ds_read_b128 v[112:115], v41 offset:12288
  v_mfma_f32_16x16x32_bf16 v[132:135], v[64:67], v[84:87], v[132:135]
  buffer_load_dwordx4 v14, s[24:27], s57 offen lds
  v_mfma_f32_16x16x32_bf16 v[136:139], v[64:67], v[88:91], v[136:139]
  ds_read_b64_tr_b16 v[98:99], v31 offset:22528
  ds_read_b128 v[116:119], v41 offset:13312
  v_mfma_f32_16x16x32_bf16 v[140:143], v[64:67], v[92:95], v[140:143]
  v_mfma_f32_16x16x32_bf16 v[144:147], v[68:71], v[80:83], v[144:147]
  ds_read_b64_tr_b16 v[100:101], v32 offset:20480
  ds_read_b128 v[120:123], v41 offset:14336
  v_mfma_f32_16x16x32_bf16 v[148:151], v[68:71], v[84:87], v[148:151]
  buffer_load_dwordx4 v15, s[24:27], s57 offen offset:1024 lds
  v_mfma_f32_16x16x32_bf16 v[152:155], v[68:71], v[88:91], v[152:155]
  ds_read_b64_tr_b16 v[102:103], v32 offset:22528
  ds_read_b128 v[124:127], v41 offset:15360
  v_mfma_f32_16x16x32_bf16 v[156:159], v[68:71], v[92:95], v[156:159]
  v_mfma_f32_16x16x32_bf16 v[160:163], v[72:75], v[80:83], v[160:163]
  s_add_u32 m0, s46, 16384
  ds_read_b64_tr_b16 v[104:105], v33 offset:20480
  ds_read_b64_tr_b16 v[106:107], v33 offset:22528
  v_mfma_f32_16x16x32_bf16 v[164:167], v[72:75], v[84:87], v[164:167]
  buffer_load_dwordx4 v16, s[24:27], s57 offen lds
  v_mfma_f32_16x16x32_bf16 v[168:171], v[72:75], v[88:91], v[168:171]
  ds_read_b64_tr_b16 v[108:109], v34 offset:20480
  ds_read_b64_tr_b16 v[110:111], v34 offset:22528
  v_mfma_f32_16x16x32_bf16 v[172:175], v[72:75], v[92:95], v[172:175]
  v_mfma_f32_16x16x32_bf16 v[176:179], v[76:79], v[80:83], v[176:179]
  v_mfma_f32_16x16x32_bf16 v[180:183], v[76:79], v[84:87], v[180:183]
  buffer_load_dwordx4 v17, s[24:27], s57 offen offset:1024 lds
  v_mfma_f32_16x16x32_bf16 v[184:187], v[76:79], v[88:91], v[184:187]
  v_mfma_f32_16x16x32_bf16 v[188:191], v[76:79], v[92:95], v[188:191]
  s_waitcnt vmcnt(12) lgkmcnt(0)
  s_barrier
  v_mfma_f32_16x16x32_bf16 v[128:131], v[96:99], v[112:115], v[128:131]
  s_add_u32 m0, s46, 18432
  s_add_u32 s57, s57, 81920
  s_and_b32 s57, s57, 0x3ffff
  ds_read_b64_tr_b16 v[64:65], v31 offset:24576
  ds_read_b128 v[80:83], v42 offset:0
  v_mfma_f32_16x16x32_bf16 v[132:135], v[96:99], v[116:119], v[132:135]
  buffer_load_dwordx4 v14, s[24:27], s57 offen lds
  v_mfma_f32_16x16x32_bf16 v[136:139], v[96:99], v[120:123], v[136:139]
  ds_read_b64_tr_b16 v[66:67], v31 offset:26624
  ds_read_b128 v[84:87], v42 offset:1024
  v_mfma_f32_16x16x32_bf16 v[140:143], v[96:99], v[124:127], v[140:143]
  buffer_load_dwordx4 v15, s[24:27], s57 offen offset:1024 lds
  v_mfma_f32_16x16x32_bf16 v[144:147], v[100:103], v[112:115], v[144:147]
  s_add_u32 m0, s46, 20480
  ds_read_b64_tr_b16 v[68:69], v32 offset:24576
  ds_read_b128 v[88:91], v42 offset:2048
  v_mfma_f32_16x16x32_bf16 v[148:151], v[100:103], v[116:119], v[148:151]
  buffer_load_dwordx4 v16, s[24:27], s57 offen lds
  v_mfma_f32_16x16x32_bf16 v[152:155], v[100:103], v[120:123], v[152:155]
  ds_read_b64_tr_b16 v[70:71], v32 offset:26624
  ds_read_b128 v[92:95], v42 offset:3072
  v_mfma_f32_16x16x32_bf16 v[156:159], v[100:103], v[124:127], v[156:159]
  v_mfma_f32_16x16x32_bf16 v[160:163], v[104:107], v[112:115], v[160:163]
  ds_read_b64_tr_b16 v[72:73], v33 offset:24576
  ds_read_b64_tr_b16 v[74:75], v33 offset:26624
  v_mfma_f32_16x16x32_bf16 v[164:167], v[104:107], v[116:119], v[164:167]
  buffer_load_dwordx4 v17, s[24:27], s57 offen offset:1024 lds
  v_mfma_f32_16x16x32_bf16 v[168:171], v[104:107], v[120:123], v[168:171]
  s_add_u32 m0, s46, 22528
  s_add_u32 s57, s57, 16384
  ds_read_b64_tr_b16 v[76:77], v34 offset:24576
  ds_read_b64_tr_b16 v[78:79], v34 offset:26624
  v_mfma_f32_16x16x32_bf16 v[172:175], v[104:107], v[124:127], v[172:175]
  buffer_load_dwordx4 v14, s[24:27], s57 offen lds
  v_mfma_f32_16x16x32_bf16 v[176:179], v[108:111], v[112:115], v[176:179]
  v_mfma_f32_16x16x32_bf16 v[180:183], v[108:111], v[116:119], v[180:183]
  buffer_load_dwordx4 v15, s[24:27], s57 offen offset:1024 lds
  v_mfma_f32_16x16x32_bf16 v[184:187], v[108:111], v[120:123], v[184:187]
  v_mfma_f32_16x16x32_bf16 v[188:191], v[108:111], v[124:127], v[188:191]
  s_waitcnt vmcnt(14) lgkmcnt(0)
  v_mfma_f32_16x16x32_bf16 v[128:131], v[64:67], v[80:83], v[128:131]
  s_add_u32 m0, s46, 24576
  ds_read_b64_tr_b16 v[96:97], v31 offset:28672
  ds_read_b128 v[112:115], v42 offset:4096
  v_mfma_f32_16x16x32_bf16 v[132:135], v[64:67], v[84:87], v[132:135]
  buffer_load_dwordx4 v16, s[24:27], s57 offen lds
  v_mfma_f32_16x16x32_bf16 v[136:139], v[64:67], v[88:91], v[136:139]
  ds_read_b64_tr_b16 v[98:99], v31 offset:32768
  ds_read_b128 v[116:119], v42 offset:5120
  v_mfma_f32_16x16x32_bf16 v[140:143], v[64:67], v[92:95], v[140:143]
  buffer_load_dwordx4 v17, s[24:27], s57 offen offset:1024 lds
  v_mfma_f32_16x16x32_bf16 v[144:147], v[68:71], v[80:83], v[144:147]
  s_add_u32 m0, s46, 26624
  s_add_u32 s57, s57, 16384
  ds_read_b64_tr_b16 v[100:101], v32 offset:28672
  ds_read_b128 v[120:123], v42 offset:6144
  v_mfma_f32_16x16x32_bf16 v[148:151], v[68:71], v[84:87], v[148:151]
  buffer_load_dwordx4 v14, s[24:27], s57 offen lds
  v_mfma_f32_16x16x32_bf16 v[152:155], v[68:71], v[88:91], v[152:155]
  ds_read_b64_tr_b16 v[102:103], v32 offset:32768
  ds_read_b128 v[124:127], v42 offset:7168
  v_mfma_f32_16x16x32_bf16 v[156:159], v[68:71], v[92:95], v[156:159]
  v_mfma_f32_16x16x32_bf16 v[160:163], v[72:75], v[80:83], v[160:163]
  ds_read_b64_tr_b16 v[104:105], v33 offset:28672
  ds_read_b64_tr_b16 v[106:107], v33 offset:32768
  v_mfma_f32_16x16x32_bf16 v[164:167], v[72:75], v[84:87], v[164:167]
  buffer_load_dwordx4 v15, s[24:27], s57 offen offset:1024 lds
  v_mfma_f32_16x16x32_bf16 v[168:171], v[72:75], v[88:91], v[168:171]
  ds_read_b64_tr_b16 v[108:109], v34 offset:28672
  ds_read_b64_tr_b16 v[110:111], v34 offset:32768
  v_mfma_f32_16x16x32_bf16 v[172:175], v[72:75], v[92:95], v[172:175]
  v_mfma_f32_16x16x32_bf16 v[176:179], v[76:79], v[80:83], v[176:179]
  v_mfma_f32_16x16x32_bf16 v[180:183], v[76:79], v[84:87], v[180:183]
  v_mfma_f32_16x16x32_bf16 v[184:187], v[76:79], v[88:91], v[184:187]
  v_mfma_f32_16x16x32_bf16 v[188:191], v[76:79], v[92:95], v[188:191]
  s_waitcnt vmcnt(14) lgkmcnt(0)
  v_mfma_f32_16x16x32_bf16 v[128:131], v[96:99], v[112:115], v[128:131]
  s_add_u32 m0, s46, 28672
  ds_read_b64_tr_b16 v[64:65], v31 offset:34816
  ds_read_b128 v[80:83], v42 offset:8192
  v_mfma_f32_16x16x32_bf16 v[132:135], v[96:99], v[116:119], v[132:135]
  buffer_load_dwordx4 v16, s[24:27], s57 offen lds
  v_mfma_f32_16x16x32_bf16 v[136:139], v[96:99], v[120:123], v[136:139]
  ds_read_b64_tr_b16 v[66:67], v31 offset:36864
  ds_read_b128 v[84:87], v42 offset:9216
  v_mfma_f32_16x16x32_bf16 v[140:143], v[96:99], v[124:127], v[140:143]
  buffer_load_dwordx4 v17, s[24:27], s57 offen offset:1024 lds
  v_mfma_f32_16x16x32_bf16 v[144:147], v[100:103], v[112:115], v[144:147]
  s_add_u32 m0, s46, 32768
  s_add_u32 s57, s57, 16384
  ds_read_b64_tr_b16 v[68:69], v32 offset:34816
  ds_read_b128 v[88:91], v42 offset:10240
  v_mfma_f32_16x16x32_bf16 v[148:151], v[100:103], v[116:119], v[148:151]
  buffer_load_dwordx4 v14, s[24:27], s57 offen lds
  v_mfma_f32_16x16x32_bf16 v[152:155], v[100:103], v[120:123], v[152:155]
  ds_read_b64_tr_b16 v[70:71], v32 offset:36864
  ds_read_b128 v[92:95], v42 offset:11264
  v_mfma_f32_16x16x32_bf16 v[156:159], v[100:103], v[124:127], v[156:159]
  v_mfma_f32_16x16x32_bf16 v[160:163], v[104:107], v[112:115], v[160:163]
  ds_read_b64_tr_b16 v[72:73], v33 offset:34816
  ds_read_b64_tr_b16 v[74:75], v33 offset:36864
  v_mfma_f32_16x16x32_bf16 v[164:167], v[104:107], v[116:119], v[164:167]
  buffer_load_dwordx4 v15, s[24:27], s57 offen offset:1024 lds
  v_mfma_f32_16x16x32_bf16 v[168:171], v[104:107], v[120:123], v[168:171]
  ds_read_b64_tr_b16 v[76:77], v34 offset:34816
  ds_read_b64_tr_b16 v[78:79], v34 offset:36864
  v_mfma_f32_16x16x32_bf16 v[172:175], v[104:107], v[124:127], v[172:175]
  v_mfma_f32_16x16x32_bf16 v[176:179], v[108:111], v[112:115], v[176:179]
  ds_read_b128 v[192:195], v48 offset:31744
  ds_read_b128 v[196:199], v48 offset:32000
  ds_read_b128 v[200:203], v48 offset:32256
  ds_read_b128 v[204:207], v48 offset:32512
  v_mfma_f32_16x16x32_bf16 v[180:183], v[108:111], v[116:119], v[180:183]
  v_mfma_f32_16x16x32_bf16 v[184:187], v[108:111], v[120:123], v[184:187]
  v_mfma_f32_16x16x32_bf16 v[188:191], v[108:111], v[124:127], v[188:191]
  s_waitcnt vmcnt(14) lgkmcnt(0)
  v_mfma_f32_16x16x32_bf16 v[128:131], v[64:67], v[80:83], v[128:131]
  s_add_u32 m0, s46, 34816
  ds_read_b64_tr_b16 v[96:97], v31 offset:38912
  ds_read_b128 v[112:115], v42 offset:12288
  v_mfma_f32_16x16x32_bf16 v[132:135], v[64:67], v[84:87], v[132:135]
  buffer_load_dwordx4 v16, s[24:27], s57 offen lds
  v_mfma_f32_16x16x32_bf16 v[136:139], v[64:67], v[88:91], v[136:139]
  ds_read_b64_tr_b16 v[98:99], v31 offset:16384
  ds_read_b128 v[116:119], v42 offset:13312
  v_mfma_f32_16x16x32_bf16 v[140:143], v[64:67], v[92:95], v[140:143]
  buffer_load_dwordx4 v17, s[24:27], s57 offen offset:1024 lds
  v_mfma_f32_16x16x32_bf16 v[144:147], v[68:71], v[80:83], v[144:147]
  s_add_u32 m0, s46, 36864
  s_add_u32 s57, s57, 147456
  s_and_b32 s57, s57, 0x3ffff
  ds_read_b64_tr_b16 v[100:101], v32 offset:38912
  ds_read_b128 v[120:123], v42 offset:14336
  v_mfma_f32_16x16x32_bf16 v[148:151], v[68:71], v[84:87], v[148:151]
  buffer_load_dwordx4 v14, s[24:27], s57 offen lds
  v_mfma_f32_16x16x32_bf16 v[152:155], v[68:71], v[88:91], v[152:155]
  ds_read_b64_tr_b16 v[102:103], v32 offset:16384
  ds_read_b128 v[124:127], v42 offset:15360
  v_mfma_f32_16x16x32_bf16 v[156:159], v[68:71], v[92:95], v[156:159]
  v_add_f32 v192, v192, v193
  v_add_f32 v194, v194, v195
  v_mfma_f32_16x16x32_bf16 v[160:163], v[72:75], v[80:83], v[160:163]
  ds_read_b64_tr_b16 v[104:105], v33 offset:38912
  ds_read_b64_tr_b16 v[106:107], v33 offset:16384
  v_mfma_f32_16x16x32_bf16 v[164:167], v[72:75], v[84:87], v[164:167]
  buffer_load_dwordx4 v15, s[24:27], s57 offen offset:1024 lds
  v_mfma_f32_16x16x32_bf16 v[168:171], v[72:75], v[88:91], v[168:171]
  ds_read_b64_tr_b16 v[108:109], v34 offset:38912
  ds_read_b64_tr_b16 v[110:111], v34 offset:16384
  v_mfma_f32_16x16x32_bf16 v[172:175], v[72:75], v[92:95], v[172:175]
  v_mfma_f32_16x16x32_bf16 v[176:179], v[76:79], v[80:83], v[176:179]
  v_add_f32 v196, v196, v197
  v_add_f32 v198, v198, v199
  v_mfma_f32_16x16x32_bf16 v[180:183], v[76:79], v[84:87], v[180:183]
  v_mfma_f32_16x16x32_bf16 v[184:187], v[76:79], v[88:91], v[184:187]
  v_add_f32 v200, v200, v201
  v_add_f32 v202, v202, v203
  v_mfma_f32_16x16x32_bf16 v[188:191], v[76:79], v[92:95], v[188:191]
  v_add_f32 v204, v204, v205
  v_add_f32 v206, v206, v207
  s_waitcnt vmcnt(14) lgkmcnt(0)
  v_mfma_f32_16x16x32_bf16 v[128:131], v[96:99], v[112:115], v[128:131]
  s_add_u32 m0, s46, 38912
  ds_read_b64_tr_b16 v[64:65], v31 offset:18432
  ds_read_b128 v[80:83], v44 offset:0
  v_mfma_f32_16x16x32_bf16 v[132:135], v[96:99], v[116:119], v[132:135]
  buffer_load_dwordx4 v16, s[24:27], s57 offen lds
  v_mfma_f32_16x16x32_bf16 v[136:139], v[96:99], v[120:123], v[136:139]
  ds_read_b64_tr_b16 v[66:67], v31 offset:20480
  ds_read_b128 v[84:87], v44 offset:1024
  v_mfma_f32_16x16x32_bf16 v[140:143], v[96:99], v[124:127], v[140:143]
  buffer_load_dwordx4 v17, s[24:27], s57 offen offset:1024 lds
  v_mfma_f32_16x16x32_bf16 v[144:147], v[100:103], v[112:115], v[144:147]
  s_add_u32 m0, s46, 16384
  s_add_u32 s57, s57, 16384
  ds_read_b64_tr_b16 v[68:69], v32 offset:18432
  ds_read_b128 v[88:91], v44 offset:2048
  v_mfma_f32_16x16x32_bf16 v[148:151], v[100:103], v[116:119], v[148:151]
  buffer_load_dwordx4 v14, s[24:27], s57 offen lds
  v_mfma_f32_16x16x32_bf16 v[152:155], v[100:103], v[120:123], v[152:155]
  ds_read_b64_tr_b16 v[70:71], v32 offset:20480
  ds_read_b128 v[92:95], v44 offset:3072
  v_mfma_f32_16x16x32_bf16 v[156:159], v[100:103], v[124:127], v[156:159]
  v_add_f32 v192, v192, v194
  v_add_f32 v196, v196, v198
  v_mfma_f32_16x16x32_bf16 v[160:163], v[104:107], v[112:115], v[160:163]
  ds_read_b64_tr_b16 v[72:73], v33 offset:18432
  ds_read_b64_tr_b16 v[74:75], v33 offset:20480
  v_mfma_f32_16x16x32_bf16 v[164:167], v[104:107], v[116:119], v[164:167]
  buffer_load_dwordx4 v15, s[24:27], s57 offen offset:1024 lds
  v_mfma_f32_16x16x32_bf16 v[168:171], v[104:107], v[120:123], v[168:171]
  ds_read_b64_tr_b16 v[76:77], v34 offset:18432
  ds_read_b64_tr_b16 v[78:79], v34 offset:20480
  v_mfma_f32_16x16x32_bf16 v[172:175], v[104:107], v[124:127], v[172:175]
  v_mfma_f32_16x16x32_bf16 v[176:179], v[108:111], v[112:115], v[176:179]
  v_add_f32 v200, v200, v202
  v_add_f32 v204, v204, v206
  v_mfma_f32_16x16x32_bf16 v[180:183], v[108:111], v[116:119], v[180:183]
  v_mfma_f32_16x16x32_bf16 v[184:187], v[108:111], v[120:123], v[184:187]
  v_mfma_f32_16x16x32_bf16 v[188:191], v[108:111], v[124:127], v[188:191]
  s_waitcnt vmcnt(14) lgkmcnt(0)
  v_mfma_f32_16x16x32_bf16 v[128:131], v[64:67], v[80:83], v[128:131]
  s_add_u32 m0, s46, 18432
  ds_read_b64_tr_b16 v[96:97], v31 offset:22528
  ds_read_b128 v[112:115], v44 offset:4096
  v_mfma_f32_16x16x32_bf16 v[132:135], v[64:67], v[84:87], v[132:135]
  buffer_load_dwordx4 v16, s[24:27], s57 offen lds
  v_mfma_f32_16x16x32_bf16 v[136:139], v[64:67], v[88:91], v[136:139]
  ds_read_b64_tr_b16 v[98:99], v31 offset:24576
  ds_read_b128 v[116:119], v44 offset:5120
  v_mfma_f32_16x16x32_bf16 v[140:143], v[64:67], v[92:95], v[140:143]
  buffer_load_dwordx4 v17, s[24:27], s57 offen offset:1024 lds
  v_mfma_f32_16x16x32_bf16 v[144:147], v[68:71], v[80:83], v[144:147]
  s_add_u32 m0, s46, 20480
  s_add_u32 s57, s57, 16384
  ds_read_b64_tr_b16 v[100:101], v32 offset:22528
  ds_read_b128 v[120:123], v44 offset:6144
  v_mfma_f32_16x16x32_bf16 v[148:151], v[68:71], v[84:87], v[148:151]
  buffer_load_dwordx4 v14, s[24:27], s57 offen lds
  v_mfma_f32_16x16x32_bf16 v[152:155], v[68:71], v[88:91], v[152:155]
  ds_read_b64_tr_b16 v[102:103], v32 offset:24576
  ds_read_b128 v[124:127], v44 offset:7168
  v_mfma_f32_16x16x32_bf16 v[156:159], v[68:71], v[92:95], v[156:159]
  v_rcp_f32 v60, v192
  v_mfma_f32_16x16x32_bf16 v[160:163], v[72:75], v[80:83], v[160:163]
  ds_read_b64_tr_b16 v[104:105], v33 offset:22528
  ds_read_b64_tr_b16 v[106:107], v33 offset:24576
  v_mfma_f32_16x16x32_bf16 v[164:167], v[72:75], v[84:87], v[164:167]
  buffer_load_dwordx4 v15, s[24:27], s57 offen offset:1024 lds
  v_mfma_f32_16x16x32_bf16 v[168:171], v[72:75], v[88:91], v[168:171]
  ds_read_b64_tr_b16 v[108:109], v34 offset:22528
  ds_read_b64_tr_b16 v[110:111], v34 offset:24576
  v_mfma_f32_16x16x32_bf16 v[172:175], v[72:75], v[92:95], v[172:175]
  v_mfma_f32_16x16x32_bf16 v[176:179], v[76:79], v[80:83], v[176:179]
  v_rcp_f32 v61, v196
  v_mfma_f32_16x16x32_bf16 v[180:183], v[76:79], v[84:87], v[180:183]
  v_mfma_f32_16x16x32_bf16 v[184:187], v[76:79], v[88:91], v[184:187]
  v_rcp_f32 v62, v200
  v_mfma_f32_16x16x32_bf16 v[188:191], v[76:79], v[92:95], v[188:191]
  v_rcp_f32 v63, v204
  s_waitcnt vmcnt(14) lgkmcnt(0)
  v_mfma_f32_16x16x32_bf16 v[128:131], v[96:99], v[112:115], v[128:131]
  s_add_u32 m0, s46, 22528
  ds_read_b64_tr_b16 v[64:65], v31 offset:26624
  ds_read_b128 v[80:83], v44 offset:8192
  v_mfma_f32_16x16x32_bf16 v[132:135], v[96:99], v[116:119], v[132:135]
  buffer_load_dwordx4 v16, s[24:27], s57 offen lds
  v_mfma_f32_16x16x32_bf16 v[136:139], v[96:99], v[120:123], v[136:139]
  ds_read_b64_tr_b16 v[66:67], v31 offset:28672
  ds_read_b128 v[84:87], v44 offset:9216
  v_mfma_f32_16x16x32_bf16 v[140:143], v[96:99], v[124:127], v[140:143]
  buffer_load_dwordx4 v17, s[24:27], s57 offen offset:1024 lds
  v_mfma_f32_16x16x32_bf16 v[144:147], v[100:103], v[112:115], v[144:147]
  s_add_u32 m0, s46, 24576
  s_add_u32 s57, s57, 16384
  ds_read_b64_tr_b16 v[68:69], v32 offset:26624
  ds_read_b128 v[88:91], v44 offset:10240
  v_mfma_f32_16x16x32_bf16 v[148:151], v[100:103], v[116:119], v[148:151]
  buffer_load_dwordx4 v14, s[24:27], s57 offen lds
  v_mfma_f32_16x16x32_bf16 v[152:155], v[100:103], v[120:123], v[152:155]
  ds_read_b64_tr_b16 v[70:71], v32 offset:28672
  ds_read_b128 v[92:95], v44 offset:11264
  v_mfma_f32_16x16x32_bf16 v[156:159], v[100:103], v[124:127], v[156:159]
  v_mfma_f32_16x16x32_bf16 v[160:163], v[104:107], v[112:115], v[160:163]
  ds_read_b64_tr_b16 v[72:73], v33 offset:26624
  ds_read_b64_tr_b16 v[74:75], v33 offset:28672
  v_mfma_f32_16x16x32_bf16 v[164:167], v[104:107], v[116:119], v[164:167]
  buffer_load_dwordx4 v15, s[24:27], s57 offen offset:1024 lds
  v_mfma_f32_16x16x32_bf16 v[168:171], v[104:107], v[120:123], v[168:171]
  ds_read_b64_tr_b16 v[76:77], v34 offset:26624
  ds_read_b64_tr_b16 v[78:79], v34 offset:28672
  v_mfma_f32_16x16x32_bf16 v[172:175], v[104:107], v[124:127], v[172:175]
  v_mfma_f32_16x16x32_bf16 v[176:179], v[108:111], v[112:115], v[176:179]
  v_mfma_f32_16x16x32_bf16 v[180:183], v[108:111], v[116:119], v[180:183]
  v_mfma_f32_16x16x32_bf16 v[184:187], v[108:111], v[120:123], v[184:187]
  v_mfma_f32_16x16x32_bf16 v[188:191], v[108:111], v[124:127], v[188:191]
  s_waitcnt vmcnt(14) lgkmcnt(0)
  v_mfma_f32_16x16x32_bf16 v[128:131], v[64:67], v[80:83], v[128:131]
  s_add_u32 m0, s46, 26624
  ds_read_b64_tr_b16 v[96:97], v31 offset:32768
  ds_read_b128 v[112:115], v44 offset:12288
  v_mfma_f32_16x16x32_bf16 v[132:135], v[64:67], v[84:87], v[132:135]
  buffer_load_dwordx4 v16, s[24:27], s57 offen lds
  v_mfma_f32_16x16x32_bf16 v[136:139], v[64:67], v[88:91], v[136:139]
  ds_read_b64_tr_b16 v[98:99], v31 offset:34816
  ds_read_b128 v[116:119], v44 offset:13312
  v_mfma_f32_16x16x32_bf16 v[140:143], v[64:67], v[92:95], v[140:143]
  buffer_load_dwordx4 v17, s[24:27], s57 offen offset:1024 lds
  v_mfma_f32_16x16x32_bf16 v[144:147], v[68:71], v[80:83], v[144:147]
  s_add_u32 m0, s46, 28672
  s_add_u32 s51, s12, 0
  ds_read_b64_tr_b16 v[100:101], v32 offset:32768
  ds_read_b128 v[120:123], v44 offset:14336
  v_mfma_f32_16x16x32_bf16 v[148:151], v[68:71], v[84:87], v[148:151]
  buffer_load_dwordx4 v24, s[32:35], s51 offen lds
  v_mfma_f32_16x16x32_bf16 v[152:155], v[68:71], v[88:91], v[152:155]
  ds_read_b64_tr_b16 v[102:103], v32 offset:34816
  ds_read_b128 v[124:127], v44 offset:15360
  v_mfma_f32_16x16x32_bf16 v[156:159], v[68:71], v[92:95], v[156:159]
  v_mfma_f32_16x16x32_bf16 v[160:163], v[72:75], v[80:83], v[160:163]
  ds_read_b64_tr_b16 v[104:105], v33 offset:32768
  ds_read_b64_tr_b16 v[106:107], v33 offset:34816
  v_mfma_f32_16x16x32_bf16 v[164:167], v[72:75], v[84:87], v[164:167]
  buffer_load_dwordx4 v25, s[32:35], s51 offen offset:1024 lds
  v_mfma_f32_16x16x32_bf16 v[168:171], v[72:75], v[88:91], v[168:171]
  ds_read_b64_tr_b16 v[108:109], v34 offset:32768
  ds_read_b64_tr_b16 v[110:111], v34 offset:34816
  v_mfma_f32_16x16x32_bf16 v[172:175], v[72:75], v[92:95], v[172:175]
  v_mfma_f32_16x16x32_bf16 v[176:179], v[76:79], v[80:83], v[176:179]
  v_mfma_f32_16x16x32_bf16 v[180:183], v[76:79], v[84:87], v[180:183]
  v_mfma_f32_16x16x32_bf16 v[184:187], v[76:79], v[88:91], v[184:187]
  v_mfma_f32_16x16x32_bf16 v[188:191], v[76:79], v[92:95], v[188:191]
  s_waitcnt vmcnt(14) lgkmcnt(0)
  v_mfma_f32_16x16x32_bf16 v[128:131], v[96:99], v[112:115], v[128:131]
  s_add_u32 m0, s46, 32768
  ds_read_b64_tr_b16 v[64:65], v31 offset:36864
  ds_read_b128 v[80:83], v43 offset:0
  v_mfma_f32_16x16x32_bf16 v[132:135], v[96:99], v[116:119], v[132:135]
  buffer_load_dwordx4 v26, s[32:35], s51 offen lds
  v_mfma_f32_16x16x32_bf16 v[136:139], v[96:99], v[120:123], v[136:139]
  ds_read_b64_tr_b16 v[66:67], v31 offset:38912
  ds_read_b128 v[84:87], v43 offset:1024
  v_mfma_f32_16x16x32_bf16 v[140:143], v[96:99], v[124:127], v[140:143]
  buffer_load_dwordx4 v27, s[32:35], s51 offen offset:1024 lds
  v_mfma_f32_16x16x32_bf16 v[144:147], v[100:103], v[112:115], v[144:147]
  s_add_u32 m0, s46, 34816
  s_add_u32 s51, s12, 28672
  ds_read_b64_tr_b16 v[68:69], v32 offset:36864
  ds_read_b128 v[88:91], v43 offset:2048
  v_mfma_f32_16x16x32_bf16 v[148:151], v[100:103], v[116:119], v[148:151]
  buffer_load_dwordx4 v24, s[32:35], s51 offen lds
  v_mfma_f32_16x16x32_bf16 v[152:155], v[100:103], v[120:123], v[152:155]
  ds_read_b64_tr_b16 v[70:71], v32 offset:38912
  ds_read_b128 v[92:95], v43 offset:3072
  v_mfma_f32_16x16x32_bf16 v[156:159], v[100:103], v[124:127], v[156:159]
  v_mfma_f32_16x16x32_bf16 v[160:163], v[104:107], v[112:115], v[160:163]
  ds_read_b64_tr_b16 v[72:73], v33 offset:36864
  ds_read_b64_tr_b16 v[74:75], v33 offset:38912
  v_mfma_f32_16x16x32_bf16 v[164:167], v[104:107], v[116:119], v[164:167]
  buffer_load_dwordx4 v25, s[32:35], s51 offen offset:1024 lds
  v_mfma_f32_16x16x32_bf16 v[168:171], v[104:107], v[120:123], v[168:171]
  ds_read_b64_tr_b16 v[76:77], v34 offset:36864
  ds_read_b64_tr_b16 v[78:79], v34 offset:38912
  v_mfma_f32_16x16x32_bf16 v[172:175], v[104:107], v[124:127], v[172:175]
  v_mfma_f32_16x16x32_bf16 v[176:179], v[108:111], v[112:115], v[176:179]
  v_mfma_f32_16x16x32_bf16 v[180:183], v[108:111], v[116:119], v[180:183]
  v_mfma_f32_16x16x32_bf16 v[184:187], v[108:111], v[120:123], v[184:187]
  v_mfma_f32_16x16x32_bf16 v[188:191], v[108:111], v[124:127], v[188:191]
  s_waitcnt vmcnt(14) lgkmcnt(0)
  v_mfma_f32_16x16x32_bf16 v[128:131], v[64:67], v[80:83], v[128:131]
  s_add_u32 m0, s46, 36864
  ds_read_b64_tr_b16 v[96:97], v31 offset:16384
  ds_read_b128 v[112:115], v43 offset:4096
  v_mfma_f32_16x16x32_bf16 v[132:135], v[64:67], v[84:87], v[132:135]
  buffer_load_dwordx4 v26, s[32:35], s51 offen lds
  v_mfma_f32_16x16x32_bf16 v[136:139], v[64:67], v[88:91], v[136:139]
  ds_read_b64_tr_b16 v[98:99], v31 offset:18432
  ds_read_b128 v[116:119], v43 offset:5120
  v_mfma_f32_16x16x32_bf16 v[140:143], v[64:67], v[92:95], v[140:143]
  buffer_load_dwordx4 v27, s[32:35], s51 offen offset:1024 lds
  v_mfma_f32_16x16x32_bf16 v[144:147], v[68:71], v[80:83], v[144:147]
  s_add_u32 m0, s46, 38912
  s_add_u32 s51, s12, 128
  ds_read_b64_tr_b16 v[100:101], v32 offset:16384
  ds_read_b128 v[120:123], v43 offset:6144
  v_mfma_f32_16x16x32_bf16 v[148:151], v[68:71], v[84:87], v[148:151]
  buffer_load_dwordx4 v24, s[32:35], s51 offen lds
  v_mfma_f32_16x16x32_bf16 v[152:155], v[68:71], v[88:91], v[152:155]
  ds_read_b64_tr_b16 v[102:103], v32 offset:18432
  ds_read_b128 v[124:127], v43 offset:7168
  v_mfma_f32_16x16x32_bf16 v[156:159], v[68:71], v[92:95], v[156:159]
  v_mfma_f32_16x16x32_bf16 v[160:163], v[72:75], v[80:83], v[160:163]
  ds_read_b64_tr_b16 v[104:105], v33 offset:16384
  ds_read_b64_tr_b16 v[106:107], v33 offset:18432
  v_mfma_f32_16x16x32_bf16 v[164:167], v[72:75], v[84:87], v[164:167]
  buffer_load_dwordx4 v25, s[32:35], s51 offen offset:1024 lds
  v_mfma_f32_16x16x32_bf16 v[168:171], v[72:75], v[88:91], v[168:171]
  ds_read_b64_tr_b16 v[108:109], v34 offset:16384
  ds_read_b64_tr_b16 v[110:111], v34 offset:18432
  v_mfma_f32_16x16x32_bf16 v[172:175], v[72:75], v[92:95], v[172:175]
  v_mfma_f32_16x16x32_bf16 v[176:179], v[76:79], v[80:83], v[176:179]
  v_mfma_f32_16x16x32_bf16 v[180:183], v[76:79], v[84:87], v[180:183]
  v_mfma_f32_16x16x32_bf16 v[184:187], v[76:79], v[88:91], v[184:187]
  v_mfma_f32_16x16x32_bf16 v[188:191], v[76:79], v[92:95], v[188:191]
  s_waitcnt vmcnt(14) lgkmcnt(0)
  v_mfma_f32_16x16x32_bf16 v[128:131], v[96:99], v[112:115], v[128:131]
  s_add_u32 m0, s46, 16384
  ds_read_b64_tr_b16 v[64:65], v31 offset:20480
  ds_read_b128 v[80:83], v43 offset:8192
  v_mfma_f32_16x16x32_bf16 v[132:135], v[96:99], v[116:119], v[132:135]
  buffer_load_dwordx4 v26, s[32:35], s51 offen lds
  v_mfma_f32_16x16x32_bf16 v[136:139], v[96:99], v[120:123], v[136:139]
  ds_read_b64_tr_b16 v[66:67], v31 offset:22528
  ds_read_b128 v[84:87], v43 offset:9216
  v_mfma_f32_16x16x32_bf16 v[140:143], v[96:99], v[124:127], v[140:143]
  buffer_load_dwordx4 v27, s[32:35], s51 offen offset:1024 lds
  v_mfma_f32_16x16x32_bf16 v[144:147], v[100:103], v[112:115], v[144:147]
  s_add_u32 m0, s46, 18432
  s_add_u32 s51, s12, 28800
  ds_read_b64_tr_b16 v[68:69], v32 offset:20480
  ds_read_b128 v[88:91], v43 offset:10240
  v_mfma_f32_16x16x32_bf16 v[148:151], v[100:103], v[116:119], v[148:151]
  buffer_load_dwordx4 v24, s[32:35], s51 offen lds
  v_mfma_f32_16x16x32_bf16 v[152:155], v[100:103], v[120:123], v[152:155]
  ds_read_b64_tr_b16 v[70:71], v32 offset:22528
  ds_read_b128 v[92:95], v43 offset:11264
  v_mfma_f32_16x16x32_bf16 v[156:159], v[100:103], v[124:127], v[156:159]
  v_mfma_f32_16x16x32_bf16 v[160:163], v[104:107], v[112:115], v[160:163]
  ds_read_b64_tr_b16 v[72:73], v33 offset:20480
  ds_read_b64_tr_b16 v[74:75], v33 offset:22528
  v_mfma_f32_16x16x32_bf16 v[164:167], v[104:107], v[116:119], v[164:167]
  buffer_load_dwordx4 v25, s[32:35], s51 offen offset:1024 lds
  v_mfma_f32_16x16x32_bf16 v[168:171], v[104:107], v[120:123], v[168:171]
  ds_read_b64_tr_b16 v[76:77], v34 offset:20480
  ds_read_b64_tr_b16 v[78:79], v34 offset:22528
  v_mfma_f32_16x16x32_bf16 v[172:175], v[104:107], v[124:127], v[172:175]
  v_mfma_f32_16x16x32_bf16 v[176:179], v[108:111], v[112:115], v[176:179]
  v_mfma_f32_16x16x32_bf16 v[180:183], v[108:111], v[116:119], v[180:183]
  v_mfma_f32_16x16x32_bf16 v[184:187], v[108:111], v[120:123], v[184:187]
  v_mfma_f32_16x16x32_bf16 v[188:191], v[108:111], v[124:127], v[188:191]
  s_waitcnt vmcnt(14) lgkmcnt(0)
  v_mfma_f32_16x16x32_bf16 v[128:131], v[64:67], v[80:83], v[128:131]
  s_add_u32 m0, s46, 20480
  ds_read_b64_tr_b16 v[96:97], v31 offset:24576
  ds_read_b128 v[112:115], v43 offset:12288
  v_mfma_f32_16x16x32_bf16 v[132:135], v[64:67], v[84:87], v[132:135]
  buffer_load_dwordx4 v26, s[32:35], s51 offen lds
  v_mfma_f32_16x16x32_bf16 v[136:139], v[64:67], v[88:91], v[136:139]
  ds_read_b64_tr_b16 v[98:99], v31 offset:26624
  ds_read_b128 v[116:119], v43 offset:13312
  v_mfma_f32_16x16x32_bf16 v[140:143], v[64:67], v[92:95], v[140:143]
  buffer_load_dwordx4 v27, s[32:35], s51 offen offset:1024 lds
  v_mfma_f32_16x16x32_bf16 v[144:147], v[68:71], v[80:83], v[144:147]
  s_add_u32 m0, s46, 22528
  s_add_u32 s51, s12, 256
  ds_read_b64_tr_b16 v[100:101], v32 offset:24576
  ds_read_b128 v[120:123], v43 offset:14336
  v_mfma_f32_16x16x32_bf16 v[148:151], v[68:71], v[84:87], v[148:151]
  buffer_load_dwordx4 v24, s[32:35], s51 offen lds
  v_mfma_f32_16x16x32_bf16 v[152:155], v[68:71], v[88:91], v[152:155]
  ds_read_b64_tr_b16 v[102:103], v32 offset:26624
  ds_read_b128 v[124:127], v43 offset:15360
  v_mfma_f32_16x16x32_bf16 v[156:159], v[68:71], v[92:95], v[156:159]
  v_mfma_f32_16x16x32_bf16 v[160:163], v[72:75], v[80:83], v[160:163]
  ds_read_b64_tr_b16 v[104:105], v33 offset:24576
  ds_read_b64_tr_b16 v[106:107], v33 offset:26624
  v_mfma_f32_16x16x32_bf16 v[164:167], v[72:75], v[84:87], v[164:167]
  buffer_load_dwordx4 v25, s[32:35], s51 offen offset:1024 lds
  v_mfma_f32_16x16x32_bf16 v[168:171], v[72:75], v[88:91], v[168:171]
  ds_read_b64_tr_b16 v[108:109], v34 offset:24576
  ds_read_b64_tr_b16 v[110:111], v34 offset:26624
  v_mfma_f32_16x16x32_bf16 v[172:175], v[72:75], v[92:95], v[172:175]
  v_mfma_f32_16x16x32_bf16 v[176:179], v[76:79], v[80:83], v[176:179]
  v_mfma_f32_16x16x32_bf16 v[180:183], v[76:79], v[84:87], v[180:183]
  v_mfma_f32_16x16x32_bf16 v[184:187], v[76:79], v[88:91], v[184:187]
  v_mfma_f32_16x16x32_bf16 v[188:191], v[76:79], v[92:95], v[188:191]
  s_waitcnt vmcnt(10) lgkmcnt(0)
  v_readfirstlane_b32 s52, v5
  s_barrier
  s_cmp_eq_u32 s52, 1
  s_cbranch_scc0 L_noncea
L_havenoncea:
  v_mfma_f32_16x16x32_bf16 v[128:131], v[96:99], v[112:115], v[128:131]
  s_add_u32 m0, s46, 8192
  ds_read_b64_tr_b16 v[64:65], v49 offset:28672
  ds_read_b64_tr_b16 v[66:67], v49 offset:32768
  v_mfma_f32_16x16x32_bf16 v[144:147], v[100:103], v[112:115], v[144:147]
  buffer_load_dwordx4 v26, s[32:35], s51 offen lds
  v_mfma_f32_16x16x32_bf16 v[132:135], v[96:99], v[116:119], v[132:135]
  ds_read_b64_tr_b16 v[68:69], v49 offset:34816
  ds_read_b64_tr_b16 v[70:71], v49 offset:36864
  v_mfma_f32_16x16x32_bf16 v[148:151], v[100:103], v[116:119], v[148:151]
  ds_read_b64_tr_b16 v[72:73], v50 offset:28672
  ds_read_b64_tr_b16 v[74:75], v50 offset:32768
  v_mfma_f32_16x16x32_bf16 v[136:139], v[96:99], v[120:123], v[136:139]
  ds_read_b64_tr_b16 v[76:77], v50 offset:34816
  ds_read_b64_tr_b16 v[78:79], v50 offset:36864
  v_mfma_f32_16x16x32_bf16 v[152:155], v[100:103], v[120:123], v[152:155]
  buffer_load_dwordx4 v27, s[32:35], s51 offen offset:1024 lds
  v_mfma_f32_16x16x32_bf16 v[140:143], v[96:99], v[124:127], v[140:143]
  v_not_b32 v5, v4
  v_cvt_pk_bf16_f32 v192, v128, v129
  v_cvt_pk_bf16_f32 v193, v130, v131
  v_mfma_f32_16x16x32_bf16 v[156:159], v[100:103], v[124:127], v[156:159]
  v_cvt_pk_bf16_f32 v194, v144, v145
  v_cvt_pk_bf16_f32 v195, v146, v147
  ds_write_b128 v41, v[192:195] offset:0
  v_mfma_f32_16x16x32_bf16 v[160:163], v[104:107], v[112:115], v[160:163]
  s_add_u32 m0, s46, 10240
  s_add_u32 s51, s12, 28928
  v_cvt_pk_bf16_f32 v196, v132, v133
  v_cvt_pk_bf16_f32 v197, v134, v135
  v_cvt_pk_bf16_f32 v198, v148, v149
  v_mfma_f32_16x16x32_bf16 v[176:179], v[108:111], v[112:115], v[176:179]
  buffer_load_dwordx4 v24, s[32:35], s51 offen lds
  v_mfma_f32_16x16x32_bf16 v[164:167], v[104:107], v[116:119], v[164:167]
  v_cvt_pk_bf16_f32 v199, v150, v151
  ds_write_b128 v41, v[196:199] offset:1024
  v_cvt_pk_bf16_f32 v200, v136, v137
  v_mfma_f32_16x16x32_bf16 v[180:183], v[108:111], v[116:119], v[180:183]
  v_cvt_pk_bf16_f32 v201, v138, v139
  v_cvt_pk_bf16_f32 v202, v152, v153
  v_cvt_pk_bf16_f32 v203, v154, v155
  v_mfma_f32_16x16x32_bf16 v[168:171], v[104:107], v[120:123], v[168:171]
  ds_write_b128 v41, v[200:203] offset:2048
  v_cvt_pk_bf16_f32 v204, v140, v141
  v_cvt_pk_bf16_f32 v205, v142, v143
  v_mfma_f32_16x16x32_bf16 v[184:187], v[108:111], v[120:123], v[184:187]
  buffer_load_dwordx4 v25, s[32:35], s51 offen offset:1024 lds
  v_mfma_f32_16x16x32_bf16 v[172:175], v[104:107], v[124:127], v[172:175]
  s_add_u32 m0, s46, 12288
  v_cvt_pk_bf16_f32 v206, v156, v157
  v_cvt_pk_bf16_f32 v207, v158, v159
  ds_write_b128 v41, v[204:207] offset:3072
  v_mfma_f32_16x16x32_bf16 v[188:191], v[108:111], v[124:127], v[188:191]
  v_cvt_pk_bf16_f32 v208, v160, v161
  v_cvt_pk_bf16_f32 v209, v162, v163
  v_cvt_pk_bf16_f32 v210, v176, v177
  s_nop 3
  v_cvt_pk_bf16_f32 v211, v178, v179
  ds_write_b128 v41, v[208:211] offset:4096
  v_cvt_pk_bf16_f32 v212, v164, v165
  v_cvt_pk_bf16_f32 v213, v166, v167
  v_cvt_pk_bf16_f32 v214, v180, v181
  v_cvt_pk_bf16_f32 v215, v182, v183
  ds_write_b128 v41, v[212:215] offset:5120
  v_cvt_pk_bf16_f32 v216, v168, v169
  v_cvt_pk_bf16_f32 v217, v170, v171
  v_cvt_pk_bf16_f32 v218, v184, v185
  v_cvt_pk_bf16_f32 v219, v186, v187
  ds_write_b128 v41, v[216:219] offset:6144
  v_cvt_pk_bf16_f32 v220, v172, v173
  v_cvt_pk_bf16_f32 v221, v174, v175
  v_cvt_pk_bf16_f32 v222, v188, v189
  v_cvt_pk_bf16_f32 v223, v190, v191
  ds_write_b128 v41, v[220:223] offset:7168
  ds_read_b64_tr_b16 v[80:81], v51 offset:28672
  ds_read_b64_tr_b16 v[82:83], v51 offset:32768
  ds_read_b64_tr_b16 v[84:85], v51 offset:34816
  ds_read_b64_tr_b16 v[86:87], v51 offset:36864
  ds_read_b64_tr_b16 v[88:89], v52 offset:28672
  ds_read_b64_tr_b16 v[90:91], v52 offset:32768
  ds_read_b64_tr_b16 v[92:93], v52 offset:34816
  ds_read_b64_tr_b16 v[94:95], v52 offset:36864
  buffer_load_dwordx4 v26, s[32:35], s51 offen lds
  buffer_load_dwordx4 v27, s[32:35], s51 offen offset:1024 lds
  s_waitcnt lgkmcnt(8)
  s_barrier
  ds_read_b128 a[32:35], v42 offset:0
  ds_read_b128 a[36:39], v42 offset:1024
  ds_read_b128 a[40:43], v42 offset:2048
  ds_read_b128 a[44:47], v42 offset:3072
  ds_read_b128 a[48:51], v42 offset:4096
  ds_read_b128 a[52:55], v42 offset:5120
  ds_read_b128 a[56:59], v42 offset:6144
  ds_read_b128 a[60:63], v42 offset:7168
  v_mfma_f32_16x16x32_bf16 v[128:131], v[64:67], v[192:195], 0
  s_add_u32 m0, s46, 14336
  s_add_u32 s51, s12, 384
  ds_read_b128 a[64:67], v43 offset:0
  ds_read_b128 a[68:71], v43 offset:1024
  v_mfma_f32_16x16x32_bf16 v[132:135], v[64:67], v[196:199], 0
  buffer_load_dwordx4 v24, s[32:35], s51 offen lds
  v_mfma_f32_16x16x32_bf16 v[136:139], v[64:67], v[200:203], 0
  ds_read_b128 a[72:75], v43 offset:2048
  ds_read_b128 a[76:79], v43 offset:3072
  v_mfma_f32_16x16x32_bf16 v[140:143], v[64:67], v[204:207], 0
  buffer_load_dwordx4 v25, s[32:35], s51 offen offset:1024 lds
  v_mfma_f32_16x16x32_bf16 v[128:131], v[68:71], v[208:211], v[128:131]
  s_add_u32 m0, s46, 24576
  ds_read_b128 a[80:83], v43 offset:4096
  ds_read_b128 a[84:87], v43 offset:5120
  v_mfma_f32_16x16x32_bf16 v[132:135], v[68:71], v[212:215], v[132:135]
  buffer_load_dwordx4 v26, s[32:35], s51 offen lds
  v_mfma_f32_16x16x32_bf16 v[136:139], v[68:71], v[216:219], v[136:139]
  ds_read_b128 a[88:91], v43 offset:6144
  ds_read_b128 a[92:95], v43 offset:7168
  v_mfma_f32_16x16x32_bf16 v[140:143], v[68:71], v[220:223], v[140:143]
  buffer_load_dwordx4 v27, s[32:35], s51 offen offset:1024 lds
  s_waitcnt lgkmcnt(12)
  v_mfma_f32_16x16x32_bf16 v[128:131], v[72:75], a[32:35], v[128:131]
  s_add_u32 m0, s46, 26624
  s_add_u32 s51, s12, 29056
  ds_read_b128 a[96:99], v44 offset:0
  ds_read_b128 a[100:103], v44 offset:1024
  v_mfma_f32_16x16x32_bf16 v[132:135], v[72:75], a[36:39], v[132:135]
  buffer_load_dwordx4 v24, s[32:35], s51 offen lds
  v_mfma_f32_16x16x32_bf16 v[136:139], v[72:75], a[40:43], v[136:139]
  ds_read_b128 a[104:107], v44 offset:2048
  ds_read_b128 a[108:111], v44 offset:3072
  v_mfma_f32_16x16x32_bf16 v[140:143], v[72:75], a[44:47], v[140:143]
  buffer_load_dwordx4 v25, s[32:35], s51 offen offset:1024 lds
  s_waitcnt lgkmcnt(12)
  v_mfma_f32_16x16x32_bf16 v[128:131], v[76:79], a[48:51], v[128:131]
  ds_read_b128 a[112:115], v44 offset:4096
  ds_read_b128 a[116:119], v44 offset:5120
  v_mfma_f32_16x16x32_bf16 v[132:135], v[76:79], a[52:55], v[132:135]
  v_mfma_f32_16x16x32_bf16 v[136:139], v[76:79], a[56:59], v[136:139]
  ds_read_b128 a[120:123], v44 offset:6144
  ds_read_b128 a[124:127], v44 offset:7168
  v_mfma_f32_16x16x32_bf16 v[140:143], v[76:79], a[60:63], v[140:143]
  s_waitcnt lgkmcnt(12)
  s_waitcnt vmcnt(14)
  s_barrier
  v_mfma_f32_16x16x32_bf16 v[128:131], v[80:83], a[64:67], v[128:131]
  s_add_u32 m0, s46, 28672
  ds_read_b64_tr_b16 v[96:97], v49 offset:38912
  ds_read_b64_tr_b16 v[98:99], v49 offset:16384
  v_mfma_f32_16x16x32_bf16 v[132:135], v[80:83], a[68:71], v[132:135]
  buffer_load_dwordx4 v26, s[32:35], s51 offen lds
  v_mfma_f32_16x16x32_bf16 v[136:139], v[80:83], a[72:75], v[136:139]
  ds_read_b64_tr_b16 v[100:101], v49 offset:18432
  ds_read_b64_tr_b16 v[102:103], v49 offset:20480
  v_mfma_f32_16x16x32_bf16 v[140:143], v[80:83], a[76:79], v[140:143]
  buffer_load_dwordx4 v27, s[32:35], s51 offen offset:1024 lds
  s_waitcnt lgkmcnt(12)
  v_mfma_f32_16x16x32_bf16 v[128:131], v[84:87], a[80:83], v[128:131]
  s_add_u32 m0, s46, 32768
  s_add_u32 s51, s12, 512
  ds_read_b64_tr_b16 v[104:105], v50 offset:38912
  ds_read_b64_tr_b16 v[106:107], v50 offset:16384
  v_mfma_f32_16x16x32_bf16 v[132:135], v[84:87], a[84:87], v[132:135]
  buffer_load_dwordx4 v24, s[32:35], s51 offen lds
  v_mfma_f32_16x16x32_bf16 v[136:139], v[84:87], a[88:91], v[136:139]
  ds_read_b64_tr_b16 v[108:109], v50 offset:18432
  ds_read_b64_tr_b16 v[110:111], v50 offset:20480
  v_mfma_f32_16x16x32_bf16 v[140:143], v[84:87], a[92:95], v[140:143]
  buffer_load_dwordx4 v25, s[32:35], s51 offen offset:1024 lds
  s_waitcnt lgkmcnt(12)
  v_mfma_f32_16x16x32_bf16 v[128:131], v[88:91], a[96:99], v[128:131]
  s_add_u32 m0, s46, 34816
  ds_read_b64_tr_b16 v[112:113], v51 offset:38912
  ds_read_b64_tr_b16 v[114:115], v51 offset:16384
  v_mfma_f32_16x16x32_bf16 v[132:135], v[88:91], a[100:103], v[132:135]
  buffer_load_dwordx4 v26, s[32:35], s51 offen lds
  v_mfma_f32_16x16x32_bf16 v[136:139], v[88:91], a[104:107], v[136:139]
  ds_read_b64_tr_b16 v[116:117], v51 offset:18432
  ds_read_b64_tr_b16 v[118:119], v51 offset:20480
  v_mfma_f32_16x16x32_bf16 v[140:143], v[88:91], a[108:111], v[140:143]
  buffer_load_dwordx4 v27, s[32:35], s51 offen offset:1024 lds
  s_waitcnt lgkmcnt(12)
  v_mfma_f32_16x16x32_bf16 v[128:131], v[92:95], a[112:115], v[128:131]
  s_add_u32 m0, s46, 36864
  s_add_u32 s51, s12, 29184
  ds_read_b64_tr_b16 v[120:121], v52 offset:38912
  ds_read_b64_tr_b16 v[122:123], v52 offset:16384
  v_mfma_f32_16x16x32_bf16 v[132:135], v[92:95], a[116:119], v[132:135]
  buffer_load_dwordx4 v24, s[32:35], s51 offen lds
  v_mfma_f32_16x16x32_bf16 v[136:139], v[92:95], a[120:123], v[136:139]
  ds_read_b64_tr_b16 v[124:125], v52 offset:18432
  ds_read_b64_tr_b16 v[126:127], v52 offset:20480
  v_mfma_f32_16x16x32_bf16 v[140:143], v[92:95], a[124:127], v[140:143]
  buffer_load_dwordx4 v25, s[32:35], s51 offen offset:1024 lds
  s_waitcnt vmcnt(14) lgkmcnt(0)
  s_barrier
  v_mfma_f32_16x16x32_bf16 v[144:147], v[96:99], v[192:195], 0
  s_add_u32 m0, s46, 38912
  ds_read_b64_tr_b16 v[64:65], v49 offset:22528
  ds_read_b64_tr_b16 v[66:67], v49 offset:8192
  v_mfma_f32_16x16x32_bf16 v[148:151], v[96:99], v[196:199], 0
  buffer_load_dwordx4 v26, s[32:35], s51 offen lds
  v_mfma_f32_16x16x32_bf16 v[152:155], v[96:99], v[200:203], 0
  v_mul_f32 v128, v128, v60
  v_mul_f32 v129, v129, v60
  v_mfma_f32_16x16x32_bf16 v[156:159], v[96:99], v[204:207], 0
  ds_read_b64_tr_b16 v[68:69], v49 offset:10240
  ds_read_b64_tr_b16 v[70:71], v49 offset:12288
  v_mfma_f32_16x16x32_bf16 v[144:147], v[100:103], v[208:211], v[144:147]
  buffer_load_dwordx4 v27, s[32:35], s51 offen offset:1024 lds
  v_mfma_f32_16x16x32_bf16 v[148:151], v[100:103], v[212:215], v[148:151]
  v_mul_f32 v130, v130, v60
  v_mul_f32 v131, v131, v60
  v_mfma_f32_16x16x32_bf16 v[152:155], v[100:103], v[216:219], v[152:155]
  s_add_u32 m0, s46, 16384
  s_add_u32 s51, s12, 640
  ds_read_b64_tr_b16 v[72:73], v50 offset:22528
  ds_read_b64_tr_b16 v[74:75], v50 offset:8192
  v_mfma_f32_16x16x32_bf16 v[156:159], v[100:103], v[220:223], v[156:159]
  buffer_load_dwordx4 v24, s[32:35], s51 offen lds
  v_mfma_f32_16x16x32_bf16 v[144:147], v[104:107], a[32:35], v[144:147]
  v_mul_f32 v132, v132, v61
  v_mul_f32 v133, v133, v61
  v_mfma_f32_16x16x32_bf16 v[148:151], v[104:107], a[36:39], v[148:151]
  ds_read_b64_tr_b16 v[76:77], v50 offset:10240
  ds_read_b64_tr_b16 v[78:79], v50 offset:12288
  v_mfma_f32_16x16x32_bf16 v[152:155], v[104:107], a[40:43], v[152:155]
  buffer_load_dwordx4 v25, s[32:35], s51 offen offset:1024 lds
  v_mfma_f32_16x16x32_bf16 v[156:159], v[104:107], a[44:47], v[156:159]
  v_mul_f32 v134, v134, v61
  v_mul_f32 v135, v135, v61
  v_mfma_f32_16x16x32_bf16 v[144:147], v[108:111], a[48:51], v[144:147]
  s_add_u32 m0, s46, 18432
  ds_read_b64_tr_b16 v[80:81], v51 offset:22528
  ds_read_b64_tr_b16 v[82:83], v51 offset:8192
  v_mfma_f32_16x16x32_bf16 v[148:151], v[108:111], a[52:55], v[148:151]
  buffer_load_dwordx4 v26, s[32:35], s51 offen lds
  v_mfma_f32_16x16x32_bf16 v[152:155], v[108:111], a[56:59], v[152:155]
  v_cvt_pk_bf16_f32 v160, v128, v129
  v_cvt_pk_bf16_f32 v161, v130, v131
  v_mfma_f32_16x16x32_bf16 v[156:159], v[108:111], a[60:63], v[156:159]
  ds_read_b64_tr_b16 v[84:85], v51 offset:10240
  ds_read_b64_tr_b16 v[86:87], v51 offset:12288
  v_mfma_f32_16x16x32_bf16 v[144:147], v[112:115], a[64:67], v[144:147]
  buffer_load_dwordx4 v27, s[32:35], s51 offen offset:1024 lds
  v_mfma_f32_16x16x32_bf16 v[148:151], v[112:115], a[68:71], v[148:151]
  v_cvt_pk_bf16_f32 v162, v132, v133
  v_cvt_pk_bf16_f32 v163, v134, v135
  v_mfma_f32_16x16x32_bf16 v[152:155], v[112:115], a[72:75], v[152:155]
  ds_read_b64_tr_b16 v[88:89], v52 offset:22528
  ds_read_b64_tr_b16 v[90:91], v52 offset:8192
  v_mfma_f32_16x16x32_bf16 v[156:159], v[112:115], a[76:79], v[156:159]
  buffer_store_dwordx4 v[160:163], v28, s[36:39], s96 offen sc1
  s_add_u32 s96, s96, 16384
  v_mfma_f32_16x16x32_bf16 v[144:147], v[116:119], a[80:83], v[144:147]
  v_mul_f32 v136, v136, v62
  v_mul_f32 v137, v137, v62
  v_mfma_f32_16x16x32_bf16 v[148:151], v[116:119], a[84:87], v[148:151]
  s_add_u32 m0, s46, 20480
  s_add_u32 s51, s12, 29312
  ds_read_b64_tr_b16 v[92:93], v52 offset:10240
  ds_read_b64_tr_b16 v[94:95], v52 offset:12288
  v_mfma_f32_16x16x32_bf16 v[152:155], v[116:119], a[88:91], v[152:155]
  buffer_load_dwordx4 v24, s[32:35], s51 offen lds
  v_mfma_f32_16x16x32_bf16 v[156:159], v[116:119], a[92:95], v[156:159]
  v_mul_f32 v138, v138, v62
  v_mul_f32 v139, v139, v62
  v_mfma_f32_16x16x32_bf16 v[144:147], v[120:123], a[96:99], v[144:147]
  v_mul_f32 v140, v140, v63
  v_mul_f32 v141, v141, v63
  v_mfma_f32_16x16x32_bf16 v[148:151], v[120:123], a[100:103], v[148:151]
  buffer_load_dwordx4 v25, s[32:35], s51 offen offset:1024 lds
  v_mfma_f32_16x16x32_bf16 v[152:155], v[120:123], a[104:107], v[152:155]
  v_mul_f32 v142, v142, v63
  v_mul_f32 v143, v143, v63
  v_mfma_f32_16x16x32_bf16 v[156:159], v[120:123], a[108:111], v[156:159]
  s_add_u32 m0, s46, 0
  v_cvt_pk_bf16_f32 v164, v136, v137
  v_cvt_pk_bf16_f32 v165, v138, v139
  v_mfma_f32_16x16x32_bf16 v[144:147], v[124:127], a[112:115], v[144:147]
  buffer_load_dwordx4 v26, s[32:35], s51 offen lds
  v_mfma_f32_16x16x32_bf16 v[148:151], v[124:127], a[116:119], v[148:151]
  v_cvt_pk_bf16_f32 v166, v140, v141
  v_cvt_pk_bf16_f32 v167, v142, v143
  v_mfma_f32_16x16x32_bf16 v[152:155], v[124:127], a[120:123], v[152:155]
  buffer_store_dwordx4 v[164:167], v28, s[36:39], s96 offen sc1
  s_add_u32 s96, s96, 114688
  v_mfma_f32_16x16x32_bf16 v[156:159], v[124:127], a[124:127], v[156:159]
  s_waitcnt vmcnt(17) lgkmcnt(0)
  s_barrier
  v_mfma_f32_16x16x32_bf16 v[128:131], v[64:67], v[192:195], 0
  ds_read_b64_tr_b16 v[96:97], v49 offset:14336
  ds_read_b64_tr_b16 v[98:99], v49 offset:24576
  v_mfma_f32_16x16x32_bf16 v[132:135], v[64:67], v[196:199], 0
  buffer_load_dwordx4 v27, s[32:35], s51 offen offset:1024 lds
  v_mfma_f32_16x16x32_bf16 v[136:139], v[64:67], v[200:203], 0
  v_mul_f32 v144, v144, v60
  v_mul_f32 v145, v145, v60
  v_mfma_f32_16x16x32_bf16 v[140:143], v[64:67], v[204:207], 0
  s_add_u32 m0, s46, 2048
  s_add_u32 s51, s12, 768
  ds_read_b64_tr_b16 v[100:101], v49 offset:26624
  ds_read_b64_tr_b16 v[102:103], v49 offset:28672
  v_mfma_f32_16x16x32_bf16 v[128:131], v[68:71], v[208:211], v[128:131]
  buffer_load_dwordx4 v24, s[32:35], s51 offen lds
  v_mfma_f32_16x16x32_bf16 v[132:135], v[68:71], v[212:215], v[132:135]
  v_mul_f32 v146, v146, v60
  v_mul_f32 v147, v147, v60
  v_mfma_f32_16x16x32_bf16 v[136:139], v[68:71], v[216:219], v[136:139]
  ds_read_b64_tr_b16 v[104:105], v50 offset:14336
  ds_read_b64_tr_b16 v[106:107], v50 offset:24576
  v_mfma_f32_16x16x32_bf16 v[140:143], v[68:71], v[220:223], v[140:143]
  buffer_load_dwordx4 v25, s[32:35], s51 offen offset:1024 lds
  v_mfma_f32_16x16x32_bf16 v[128:131], v[72:75], a[32:35], v[128:131]
  v_mul_f32 v148, v148, v61
  v_mul_f32 v149, v149, v61
  v_mfma_f32_16x16x32_bf16 v[132:135], v[72:75], a[36:39], v[132:135]
  s_add_u32 m0, s46, 4096
  ds_read_b64_tr_b16 v[108:109], v50 offset:26624
  ds_read_b64_tr_b16 v[110:111], v50 offset:28672
  v_mfma_f32_16x16x32_bf16 v[136:139], v[72:75], a[40:43], v[136:139]
  buffer_load_dwordx4 v26, s[32:35], s51 offen lds
  v_mfma_f32_16x16x32_bf16 v[140:143], v[72:75], a[44:47], v[140:143]
  v_mul_f32 v150, v150, v61
  v_mul_f32 v151, v151, v61
  v_mfma_f32_16x16x32_bf16 v[128:131], v[76:79], a[48:51], v[128:131]
  ds_read_b64_tr_b16 v[112:113], v51 offset:14336
  ds_read_b64_tr_b16 v[114:115], v51 offset:24576
  v_mfma_f32_16x16x32_bf16 v[132:135], v[76:79], a[52:55], v[132:135]
  buffer_load_dwordx4 v27, s[32:35], s51 offen offset:1024 lds
  v_mfma_f32_16x16x32_bf16 v[136:139], v[76:79], a[56:59], v[136:139]
  v_cvt_pk_bf16_f32 v168, v144, v145
  v_cvt_pk_bf16_f32 v169, v146, v147
  v_mfma_f32_16x16x32_bf16 v[140:143], v[76:79], a[60:63], v[140:143]
  s_add_u32 m0, s46, 6144
  s_add_u32 s51, s12, 29440
  ds_read_b64_tr_b16 v[116:117], v51 offset:26624
  ds_read_b64_tr_b16 v[118:119], v51 offset:28672
  v_mfma_f32_16x16x32_bf16 v[128:131], v[80:83], a[64:67], v[128:131]
  buffer_load_dwordx4 v24, s[32:35], s51 offen lds
  v_mfma_f32_16x16x32_bf16 v[132:135], v[80:83], a[68:71], v[132:135]
  v_cvt_pk_bf16_f32 v170, v148, v149
  v_cvt_pk_bf16_f32 v171, v150, v151
  v_mfma_f32_16x16x32_bf16 v[136:139], v[80:83], a[72:75], v[136:139]
  ds_read_b64_tr_b16 v[120:121], v52 offset:14336
  ds_read_b64_tr_b16 v[122:123], v52 offset:24576
  v_mfma_f32_16x16x32_bf16 v[140:143], v[80:83], a[76:79], v[140:143]
  buffer_store_dwordx4 v[168:171], v28, s[36:39], s96 offen sc1
  s_add_u32 s96, s96, 16384
  v_mfma_f32_16x16x32_bf16 v[128:131], v[84:87], a[80:83], v[128:131]
  v_mul_f32 v152, v152, v62
  v_mul_f32 v153, v153, v62
  v_mfma_f32_16x16x32_bf16 v[132:135], v[84:87], a[84:87], v[132:135]
  ds_read_b64_tr_b16 v[124:125], v52 offset:26624
  ds_read_b64_tr_b16 v[126:127], v52 offset:28672
  v_mfma_f32_16x16x32_bf16 v[136:139], v[84:87], a[88:91], v[136:139]
  buffer_load_dwordx4 v25, s[32:35], s51 offen offset:1024 lds
  v_mfma_f32_16x16x32_bf16 v[140:143], v[84:87], a[92:95], v[140:143]
  v_mul_f32 v154, v154, v62
  v_mul_f32 v155, v155, v62
  v_mfma_f32_16x16x32_bf16 v[128:131], v[88:91], a[96:99], v[128:131]
  s_add_u32 m0, s46, 22528
  v_mul_f32 v156, v156, v63
  v_mul_f32 v157, v157, v63
  v_mfma_f32_16x16x32_bf16 v[132:135], v[88:91], a[100:103], v[132:135]
  buffer_load_dwordx4 v26, s[32:35], s51 offen lds
  v_mfma_f32_16x16x32_bf16 v[136:139], v[88:91], a[104:107], v[136:139]
  v_mul_f32 v158, v158, v63
  v_mul_f32 v159, v159, v63
  v_mfma_f32_16x16x32_bf16 v[140:143], v[88:91], a[108:111], v[140:143]
  v_cvt_pk_bf16_f32 v172, v152, v153
  v_cvt_pk_bf16_f32 v173, v154, v155
  v_mfma_f32_16x16x32_bf16 v[128:131], v[92:95], a[112:115], v[128:131]
  buffer_load_dwordx4 v27, s[32:35], s51 offen offset:1024 lds
  v_mfma_f32_16x16x32_bf16 v[132:135], v[92:95], a[116:119], v[132:135]
  v_cvt_pk_bf16_f32 v174, v156, v157
  v_cvt_pk_bf16_f32 v175, v158, v159
  v_mfma_f32_16x16x32_bf16 v[136:139], v[92:95], a[120:123], v[136:139]
  buffer_store_dwordx4 v[172:175], v28, s[36:39], s96 offen sc1
  s_add_u32 s96, s96, 114688
  v_mfma_f32_16x16x32_bf16 v[140:143], v[92:95], a[124:127], v[140:143]
  s_waitcnt vmcnt(20) lgkmcnt(0)
  s_barrier
  v_mfma_f32_16x16x32_bf16 v[144:147], v[96:99], v[192:195], 0
  ds_read_b64_tr_b16 v[64:65], v49 offset:32768
  ds_read_b64_tr_b16 v[66:67], v49 offset:34816
  v_mfma_f32_16x16x32_bf16 v[148:151], v[96:99], v[196:199], 0
  v_mul_f32 v128, v128, v60
  v_mul_f32 v129, v129, v60
  v_mfma_f32_16x16x32_bf16 v[152:155], v[96:99], v[200:203], 0
  v_mul_f32 v130, v130, v60
  v_mul_f32 v131, v131, v60
  v_mfma_f32_16x16x32_bf16 v[156:159], v[96:99], v[204:207], 0
  ds_read_b64_tr_b16 v[68:69], v49 offset:36864
  ds_read_b64_tr_b16 v[70:71], v49 offset:38912
  v_mfma_f32_16x16x32_bf16 v[144:147], v[100:103], v[208:211], v[144:147]
  v_mul_f32 v132, v132, v61
  v_mul_f32 v133, v133, v61
  v_mfma_f32_16x16x32_bf16 v[148:151], v[100:103], v[212:215], v[148:151]
  v_mul_f32 v134, v134, v61
  v_mul_f32 v135, v135, v61
  v_mfma_f32_16x16x32_bf16 v[152:155], v[100:103], v[216:219], v[152:155]
  ds_read_b64_tr_b16 v[72:73], v50 offset:32768
  ds_read_b64_tr_b16 v[74:75], v50 offset:34816
  v_mfma_f32_16x16x32_bf16 v[156:159], v[100:103], v[220:223], v[156:159]
  v_cvt_pk_bf16_f32 v176, v128, v129
  v_cvt_pk_bf16_f32 v177, v130, v131
  v_mfma_f32_16x16x32_bf16 v[144:147], v[104:107], a[32:35], v[144:147]
  v_cvt_pk_bf16_f32 v178, v132, v133
  v_cvt_pk_bf16_f32 v179, v134, v135
  v_mfma_f32_16x16x32_bf16 v[148:151], v[104:107], a[36:39], v[148:151]
  ds_read_b64_tr_b16 v[76:77], v50 offset:36864
  ds_read_b64_tr_b16 v[78:79], v50 offset:38912
  v_mfma_f32_16x16x32_bf16 v[152:155], v[104:107], a[40:43], v[152:155]
  buffer_store_dwordx4 v[176:179], v28, s[36:39], s96 offen sc1
  s_add_u32 s96, s96, 16384
  v_mfma_f32_16x16x32_bf16 v[156:159], v[104:107], a[44:47], v[156:159]
  v_mul_f32 v136, v136, v62
  v_mul_f32 v137, v137, v62
  v_mfma_f32_16x16x32_bf16 v[144:147], v[108:111], a[48:51], v[144:147]
  ds_read_b64_tr_b16 v[80:81], v51 offset:32768
  ds_read_b64_tr_b16 v[82:83], v51 offset:34816
  v_mfma_f32_16x16x32_bf16 v[148:151], v[108:111], a[52:55], v[148:151]
  v_mul_f32 v138, v138, v62
  v_mul_f32 v139, v139, v62
  v_mfma_f32_16x16x32_bf16 v[152:155], v[108:111], a[56:59], v[152:155]
  v_mul_f32 v140, v140, v63
  v_mul_f32 v141, v141, v63
  v_mfma_f32_16x16x32_bf16 v[156:159], v[108:111], a[60:63], v[156:159]
  ds_read_b64_tr_b16 v[84:85], v51 offset:36864
  ds_read_b64_tr_b16 v[86:87], v51 offset:38912
  v_mfma_f32_16x16x32_bf16 v[144:147], v[112:115], a[64:67], v[144:147]
  v_mul_f32 v142, v142, v63
  v_mul_f32 v143, v143, v63
  v_mfma_f32_16x16x32_bf16 v[148:151], v[112:115], a[68:71], v[148:151]
  v_cvt_pk_bf16_f32 v180, v136, v137
  v_cvt_pk_bf16_f32 v181, v138, v139
  v_mfma_f32_16x16x32_bf16 v[152:155], v[112:115], a[72:75], v[152:155]
  ds_read_b64_tr_b16 v[88:89], v52 offset:32768
  ds_read_b64_tr_b16 v[90:91], v52 offset:34816
  v_mfma_f32_16x16x32_bf16 v[156:159], v[112:115], a[76:79], v[156:159]
  v_cvt_pk_bf16_f32 v182, v140, v141
  v_cvt_pk_bf16_f32 v183, v142, v143
  v_mfma_f32_16x16x32_bf16 v[144:147], v[116:119], a[80:83], v[144:147]
  buffer_store_dwordx4 v[180:183], v28, s[36:39], s96 offen sc1
  s_add_u32 s96, s96, 114688
  v_mfma_f32_16x16x32_bf16 v[148:151], v[116:119], a[84:87], v[148:151]
  ds_read_b64_tr_b16 v[92:93], v52 offset:36864
  ds_read_b64_tr_b16 v[94:95], v52 offset:38912
  v_mfma_f32_16x16x32_bf16 v[152:155], v[116:119], a[88:91], v[152:155]
  v_mfma_f32_16x16x32_bf16 v[156:159], v[116:119], a[92:95], v[156:159]
  v_mfma_f32_16x16x32_bf16 v[144:147], v[120:123], a[96:99], v[144:147]
  v_mfma_f32_16x16x32_bf16 v[148:151], v[120:123], a[100:103], v[148:151]
  v_mfma_f32_16x16x32_bf16 v[152:155], v[120:123], a[104:107], v[152:155]
  v_mfma_f32_16x16x32_bf16 v[156:159], v[120:123], a[108:111], v[156:159]
  v_mfma_f32_16x16x32_bf16 v[144:147], v[124:127], a[112:115], v[144:147]
  v_mfma_f32_16x16x32_bf16 v[148:151], v[124:127], a[116:119], v[148:151]
  v_mfma_f32_16x16x32_bf16 v[152:155], v[124:127], a[120:123], v[152:155]
  v_mfma_f32_16x16x32_bf16 v[156:159], v[124:127], a[124:127], v[156:159]
  s_waitcnt vmcnt(3) lgkmcnt(0)
  s_barrier
  v_mfma_f32_16x16x32_bf16 v[128:131], v[64:67], v[192:195], 0
  ds_read_b64_tr_b16 v[96:97], v49 offset:16384
  ds_read_b64_tr_b16 v[98:99], v49 offset:18432
  v_mfma_f32_16x16x32_bf16 v[132:135], v[64:67], v[196:199], 0
  v_mul_f32 v144, v144, v60
  v_mul_f32 v145, v145, v60
  v_mfma_f32_16x16x32_bf16 v[136:139], v[64:67], v[200:203], 0
  v_mul_f32 v146, v146, v60
  v_mul_f32 v147, v147, v60
  v_mfma_f32_16x16x32_bf16 v[140:143], v[64:67], v[204:207], 0
  ds_read_b64_tr_b16 v[100:101], v49 offset:20480
  ds_read_b64_tr_b16 v[102:103], v49 offset:0
  v_mfma_f32_16x16x32_bf16 v[128:131], v[68:71], v[208:211], v[128:131]
  v_mul_f32 v148, v148, v61
  v_mul_f32 v149, v149, v61
  v_mfma_f32_16x16x32_bf16 v[132:135], v[68:71], v[212:215], v[132:135]
  v_mul_f32 v150, v150, v61
  v_mul_f32 v151, v151, v61
  v_mfma_f32_16x16x32_bf16 v[136:139], v[68:71], v[216:219], v[136:139]
  ds_read_b64_tr_b16 v[104:105], v50 offset:16384
  ds_read_b64_tr_b16 v[106:107], v50 offset:18432
  v_mfma_f32_16x16x32_bf16 v[140:143], v[68:71], v[220:223], v[140:143]
  v_cvt_pk_bf16_f32 v184, v144, v145
  v_cvt_pk_bf16_f32 v185, v146, v147
  v_mfma_f32_16x16x32_bf16 v[128:131], v[72:75], a[32:35], v[128:131]
  v_cvt_pk_bf16_f32 v186, v148, v149
  v_cvt_pk_bf16_f32 v187, v150, v151
  v_mfma_f32_16x16x32_bf16 v[132:135], v[72:75], a[36:39], v[132:135]
  ds_read_b64_tr_b16 v[108:109], v50 offset:20480
  ds_read_b64_tr_b16 v[110:111], v50 offset:0
  v_mfma_f32_16x16x32_bf16 v[136:139], v[72:75], a[40:43], v[136:139]
  buffer_store_dwordx4 v[184:187], v28, s[36:39], s96 offen sc1
  s_add_u32 s96, s96, 16384
  v_mfma_f32_16x16x32_bf16 v[140:143], v[72:75], a[44:47], v[140:143]
  v_mul_f32 v152, v152, v62
  v_mul_f32 v153, v153, v62
  v_mfma_f32_16x16x32_bf16 v[128:131], v[76:79], a[48:51], v[128:131]
  ds_read_b64_tr_b16 v[112:113], v51 offset:16384
  ds_read_b64_tr_b16 v[114:115], v51 offset:18432
  v_mfma_f32_16x16x32_bf16 v[132:135], v[76:79], a[52:55], v[132:135]
  v_mul_f32 v154, v154, v62
  v_mul_f32 v155, v155, v62
  v_mfma_f32_16x16x32_bf16 v[136:139], v[76:79], a[56:59], v[136:139]
  v_mul_f32 v156, v156, v63
  v_mul_f32 v157, v157, v63
  v_mfma_f32_16x16x32_bf16 v[140:143], v[76:79], a[60:63], v[140:143]
  ds_read_b64_tr_b16 v[116:117], v51 offset:20480
  ds_read_b64_tr_b16 v[118:119], v51 offset:0
  v_mfma_f32_16x16x32_bf16 v[128:131], v[80:83], a[64:67], v[128:131]
  v_mul_f32 v158, v158, v63
  v_mul_f32 v159, v159, v63
  v_mfma_f32_16x16x32_bf16 v[132:135], v[80:83], a[68:71], v[132:135]
  v_cvt_pk_bf16_f32 v188, v152, v153
  v_cvt_pk_bf16_f32 v189, v154, v155
  v_mfma_f32_16x16x32_bf16 v[136:139], v[80:83], a[72:75], v[136:139]
  ds_read_b64_tr_b16 v[120:121], v52 offset:16384
  ds_read_b64_tr_b16 v[122:123], v52 offset:18432
  v_mfma_f32_16x16x32_bf16 v[140:143], v[80:83], a[76:79], v[140:143]
  v_cvt_pk_bf16_f32 v190, v156, v157
  v_cvt_pk_bf16_f32 v191, v158, v159
  v_mfma_f32_16x16x32_bf16 v[128:131], v[84:87], a[80:83], v[128:131]
  buffer_store_dwordx4 v[188:191], v28, s[36:39], s96 offen sc1
  s_add_u32 s96, s96, 114688
  v_mfma_f32_16x16x32_bf16 v[132:135], v[84:87], a[84:87], v[132:135]
  ds_read_b64_tr_b16 v[124:125], v52 offset:20480
  ds_read_b64_tr_b16 v[126:127], v52 offset:0
  v_mfma_f32_16x16x32_bf16 v[136:139], v[84:87], a[88:91], v[136:139]
  v_mfma_f32_16x16x32_bf16 v[140:143], v[84:87], a[92:95], v[140:143]
  v_mfma_f32_16x16x32_bf16 v[128:131], v[88:91], a[96:99], v[128:131]
  v_mfma_f32_16x16x32_bf16 v[132:135], v[88:91], a[100:103], v[132:135]
  v_mfma_f32_16x16x32_bf16 v[136:139], v[88:91], a[104:107], v[136:139]
  v_mfma_f32_16x16x32_bf16 v[140:143], v[88:91], a[108:111], v[140:143]
  v_mfma_f32_16x16x32_bf16 v[128:131], v[92:95], a[112:115], v[128:131]
  v_mfma_f32_16x16x32_bf16 v[132:135], v[92:95], a[116:119], v[132:135]
  v_mfma_f32_16x16x32_bf16 v[136:139], v[92:95], a[120:123], v[136:139]
  v_mfma_f32_16x16x32_bf16 v[140:143], v[92:95], a[124:127], v[140:143]
  s_waitcnt lgkmcnt(0)
  v_mfma_f32_16x16x32_bf16 v[144:147], v[96:99], v[192:195], 0
  ds_read_b64_tr_b16 v[64:65], v49 offset:2048
  ds_read_b64_tr_b16 v[66:67], v49 offset:4096
  v_mfma_f32_16x16x32_bf16 v[148:151], v[96:99], v[196:199], 0
  v_mul_f32 v128, v128, v60
  v_mul_f32 v129, v129, v60
  v_mfma_f32_16x16x32_bf16 v[152:155], v[96:99], v[200:203], 0
  v_mul_f32 v130, v130, v60
  v_mul_f32 v131, v131, v60
  v_mfma_f32_16x16x32_bf16 v[156:159], v[96:99], v[204:207], 0
  ds_read_b64_tr_b16 v[68:69], v49 offset:6144
  ds_read_b64_tr_b16 v[70:71], v49 offset:22528
  v_mfma_f32_16x16x32_bf16 v[144:147], v[100:103], v[208:211], v[144:147]
  v_mul_f32 v132, v132, v61
  v_mul_f32 v133, v133, v61
  v_mfma_f32_16x16x32_bf16 v[148:151], v[100:103], v[212:215], v[148:151]
  v_mul_f32 v134, v134, v61
  v_mul_f32 v135, v135, v61
  v_mfma_f32_16x16x32_bf16 v[152:155], v[100:103], v[216:219], v[152:155]
  ds_read_b64_tr_b16 v[72:73], v50 offset:2048
  ds_read_b64_tr_b16 v[74:75], v50 offset:4096
  v_mfma_f32_16x16x32_bf16 v[156:159], v[100:103], v[220:223], v[156:159]
  v_cvt_pk_bf16_f32 v160, v128, v129
  v_cvt_pk_bf16_f32 v161, v130, v131
  v_mfma_f32_16x16x32_bf16 v[144:147], v[104:107], a[32:35], v[144:147]
  v_cvt_pk_bf16_f32 v162, v132, v133
  v_cvt_pk_bf16_f32 v163, v134, v135
  v_mfma_f32_16x16x32_bf16 v[148:151], v[104:107], a[36:39], v[148:151]
  ds_read_b64_tr_b16 v[76:77], v50 offset:6144
  ds_read_b64_tr_b16 v[78:79], v50 offset:22528
  v_mfma_f32_16x16x32_bf16 v[152:155], v[104:107], a[40:43], v[152:155]
  buffer_store_dwordx4 v[160:163], v28, s[36:39], s96 offen sc1
  s_add_u32 s96, s96, 16384
  v_mfma_f32_16x16x32_bf16 v[156:159], v[104:107], a[44:47], v[156:159]
  v_mul_f32 v136, v136, v62
  v_mul_f32 v137, v137, v62
  v_mfma_f32_16x16x32_bf16 v[144:147], v[108:111], a[48:51], v[144:147]
  ds_read_b64_tr_b16 v[80:81], v51 offset:2048
  ds_read_b64_tr_b16 v[82:83], v51 offset:4096
  v_mfma_f32_16x16x32_bf16 v[148:151], v[108:111], a[52:55], v[148:151]
  v_mul_f32 v138, v138, v62
  v_mul_f32 v139, v139, v62
  v_mfma_f32_16x16x32_bf16 v[152:155], v[108:111], a[56:59], v[152:155]
  v_mul_f32 v140, v140, v63
  v_mul_f32 v141, v141, v63
  v_mfma_f32_16x16x32_bf16 v[156:159], v[108:111], a[60:63], v[156:159]
  ds_read_b64_tr_b16 v[84:85], v51 offset:6144
  ds_read_b64_tr_b16 v[86:87], v51 offset:22528
  v_mfma_f32_16x16x32_bf16 v[144:147], v[112:115], a[64:67], v[144:147]
  v_mul_f32 v142, v142, v63
  v_mul_f32 v143, v143, v63
  v_mfma_f32_16x16x32_bf16 v[148:151], v[112:115], a[68:71], v[148:151]
  v_cvt_pk_bf16_f32 v164, v136, v137
  v_cvt_pk_bf16_f32 v165, v138, v139
  v_mfma_f32_16x16x32_bf16 v[152:155], v[112:115], a[72:75], v[152:155]
  ds_read_b64_tr_b16 v[88:89], v52 offset:2048
  ds_read_b64_tr_b16 v[90:91], v52 offset:4096
  v_mfma_f32_16x16x32_bf16 v[156:159], v[112:115], a[76:79], v[156:159]
  v_cvt_pk_bf16_f32 v166, v140, v141
  v_cvt_pk_bf16_f32 v167, v142, v143
  v_mfma_f32_16x16x32_bf16 v[144:147], v[116:119], a[80:83], v[144:147]
  buffer_store_dwordx4 v[164:167], v28, s[36:39], s96 offen sc1
  s_add_u32 s96, s96, 114688
  v_mfma_f32_16x16x32_bf16 v[148:151], v[116:119], a[84:87], v[148:151]
  ds_read_b64_tr_b16 v[92:93], v52 offset:6144
  ds_read_b64_tr_b16 v[94:95], v52 offset:22528
  v_mfma_f32_16x16x32_bf16 v[152:155], v[116:119], a[88:91], v[152:155]
  v_mfma_f32_16x16x32_bf16 v[156:159], v[116:119], a[92:95], v[156:159]
  v_mfma_f32_16x16x32_bf16 v[144:147], v[120:123], a[96:99], v[144:147]
  v_mfma_f32_16x16x32_bf16 v[148:151], v[120:123], a[100:103], v[148:151]
  v_mfma_f32_16x16x32_bf16 v[152:155], v[120:123], a[104:107], v[152:155]
  v_mfma_f32_16x16x32_bf16 v[156:159], v[120:123], a[108:111], v[156:159]
  v_mfma_f32_16x16x32_bf16 v[144:147], v[124:127], a[112:115], v[144:147]
  v_mfma_f32_16x16x32_bf16 v[148:151], v[124:127], a[116:119], v[148:151]
  v_mfma_f32_16x16x32_bf16 v[152:155], v[124:127], a[120:123], v[152:155]
  v_mfma_f32_16x16x32_bf16 v[156:159], v[124:127], a[124:127], v[156:159]
  s_waitcnt vmcnt(2) lgkmcnt(0)
  s_barrier
  v_mfma_f32_16x16x32_bf16 v[128:131], v[64:67], v[192:195], 0
  v_mfma_f32_16x16x32_bf16 v[132:135], v[64:67], v[196:199], 0
  s_mov_b64 exec, s[14:15]
  buffer_store_dwordx2 v[4:5], v9, s[36:39], s3 offen sc1
  s_mov_b64 exec, -1
  s_add_u32 s3, s3, 32768
  v_mfma_f32_16x16x32_bf16 v[136:139], v[64:67], v[200:203], 0
  v_mul_f32 v144, v144, v60
  v_mul_f32 v145, v145, v60
  v_mfma_f32_16x16x32_bf16 v[140:143], v[64:67], v[204:207], 0
  v_mul_f32 v146, v146, v60
  v_mul_f32 v147, v147, v60
  v_mfma_f32_16x16x32_bf16 v[128:131], v[68:71], v[208:211], v[128:131]
  v_mul_f32 v148, v148, v61
  v_mul_f32 v149, v149, v61
  v_mfma_f32_16x16x32_bf16 v[132:135], v[68:71], v[212:215], v[132:135]
  v_mul_f32 v150, v150, v61
  v_mul_f32 v151, v151, v61
  v_mfma_f32_16x16x32_bf16 v[136:139], v[68:71], v[216:219], v[136:139]
  v_cvt_pk_bf16_f32 v168, v144, v145
  v_cvt_pk_bf16_f32 v169, v146, v147
  v_mfma_f32_16x16x32_bf16 v[140:143], v[68:71], v[220:223], v[140:143]
  v_cvt_pk_bf16_f32 v170, v148, v149
  v_cvt_pk_bf16_f32 v171, v150, v151
  v_mfma_f32_16x16x32_bf16 v[128:131], v[72:75], a[32:35], v[128:131]
  buffer_store_dwordx4 v[168:171], v28, s[36:39], s96 offen sc1
  s_add_u32 s96, s96, 16384
  v_mfma_f32_16x16x32_bf16 v[132:135], v[72:75], a[36:39], v[132:135]
  v_mul_f32 v152, v152, v62
  v_mul_f32 v153, v153, v62
  v_mfma_f32_16x16x32_bf16 v[136:139], v[72:75], a[40:43], v[136:139]
  v_mul_f32 v154, v154, v62
  v_mul_f32 v155, v155, v62
  v_mfma_f32_16x16x32_bf16 v[140:143], v[72:75], a[44:47], v[140:143]
  v_mul_f32 v156, v156, v63
  v_mul_f32 v157, v157, v63
  v_mfma_f32_16x16x32_bf16 v[128:131], v[76:79], a[48:51], v[128:131]
  v_mul_f32 v158, v158, v63
  v_mul_f32 v159, v159, v63
  v_mfma_f32_16x16x32_bf16 v[132:135], v[76:79], a[52:55], v[132:135]
  v_cvt_pk_bf16_f32 v172, v152, v153
  v_cvt_pk_bf16_f32 v173, v154, v155
  v_mfma_f32_16x16x32_bf16 v[136:139], v[76:79], a[56:59], v[136:139]
  v_cvt_pk_bf16_f32 v174, v156, v157
  v_cvt_pk_bf16_f32 v175, v158, v159
  v_mfma_f32_16x16x32_bf16 v[140:143], v[76:79], a[60:63], v[140:143]
  buffer_store_dwordx4 v[172:175], v28, s[36:39], s96 offen sc1
  s_add_u32 s96, s96, 114688
  v_mfma_f32_16x16x32_bf16 v[128:131], v[80:83], a[64:67], v[128:131]
  v_mfma_f32_16x16x32_bf16 v[132:135], v[80:83], a[68:71], v[132:135]
  v_mfma_f32_16x16x32_bf16 v[136:139], v[80:83], a[72:75], v[136:139]
  v_mfma_f32_16x16x32_bf16 v[140:143], v[80:83], a[76:79], v[140:143]
  v_mfma_f32_16x16x32_bf16 v[128:131], v[84:87], a[80:83], v[128:131]
  v_mfma_f32_16x16x32_bf16 v[132:135], v[84:87], a[84:87], v[132:135]
  v_mfma_f32_16x16x32_bf16 v[136:139], v[84:87], a[88:91], v[136:139]
  v_mfma_f32_16x16x32_bf16 v[140:143], v[84:87], a[92:95], v[140:143]
  v_mfma_f32_16x16x32_bf16 v[128:131], v[88:91], a[96:99], v[128:131]
  v_mfma_f32_16x16x32_bf16 v[132:135], v[88:91], a[100:103], v[132:135]
  v_mfma_f32_16x16x32_bf16 v[136:139], v[88:91], a[104:107], v[136:139]
  v_mfma_f32_16x16x32_bf16 v[140:143], v[88:91], a[108:111], v[140:143]
  v_mfma_f32_16x16x32_bf16 v[128:131], v[92:95], a[112:115], v[128:131]
  v_mfma_f32_16x16x32_bf16 v[132:135], v[92:95], a[116:119], v[132:135]
  v_mfma_f32_16x16x32_bf16 v[136:139], v[92:95], a[120:123], v[136:139]
  v_mfma_f32_16x16x32_bf16 v[140:143], v[92:95], a[124:127], v[140:143]
  s_nop 5
  v_mul_f32 v128, v128, v60
  v_mul_f32 v129, v129, v60
  v_mul_f32 v130, v130, v60
  v_mul_f32 v131, v131, v60
  v_mul_f32 v132, v132, v61
  v_mul_f32 v133, v133, v61
  v_mul_f32 v134, v134, v61
  v_mul_f32 v135, v135, v61
  v_cvt_pk_bf16_f32 v176, v128, v129
  v_cvt_pk_bf16_f32 v177, v130, v131
  v_cvt_pk_bf16_f32 v178, v132, v133
  v_cvt_pk_bf16_f32 v179, v134, v135
  buffer_store_dwordx4 v[176:179], v28, s[36:39], s96 offen sc1
  s_add_u32 s96, s96, 16384
  v_mul_f32 v136, v136, v62
  v_mul_f32 v137, v137, v62
  v_mul_f32 v138, v138, v62
  v_mul_f32 v139, v139, v62
  v_mul_f32 v140, v140, v63
  v_mul_f32 v141, v141, v63
  v_mul_f32 v142, v142, v63
  v_mul_f32 v143, v143, v63
  v_cvt_pk_bf16_f32 v180, v136, v137
  v_cvt_pk_bf16_f32 v181, v138, v139
  v_cvt_pk_bf16_f32 v182, v140, v141
  v_cvt_pk_bf16_f32 v183, v142, v143
  buffer_store_dwordx4 v[180:183], v28, s[36:39], s96 offen sc1
  s_add_u32 s96, s96, 114688
  s_branch L_tail
L_body1:
  s_barrier
  ds_read_b64_tr_b16 v[64:65], v31 offset:32768
  ds_read_b64_tr_b16 v[66:67], v31 offset:34816
  ds_read_b128 v[80:83], v37 offset:0
  ds_read_b64_tr_b16 v[68:69], v32 offset:32768
  ds_read_b128 v[84:87], v37 offset:40960
  ds_read_b64_tr_b16 v[70:71], v32 offset:34816
  ds_read_b128 v[88:91], v38 offset:0
  ds_read_b64_tr_b16 v[72:73], v33 offset:32768
  ds_read_b64_tr_b16 v[74:75], v33 offset:34816
  ds_read_b64_tr_b16 v[76:77], v34 offset:32768
  ds_read_b64_tr_b16 v[78:79], v34 offset:34816
  s_waitcnt lgkmcnt(0)
  v_mfma_f32_16x16x32_bf16 v[128:131], v[64:67], v[80:83], 0
  s_add_u32 m0, s46, 22528
  ds_read_b64_tr_b16 v[96:97], v31 offset:36864
  ds_read_b64_tr_b16 v[98:99], v31 offset:38912
  ds_read_b128 v[112:115], v39 offset:0
  v_mfma_f32_16x16x32_bf16 v[132:135], v[64:67], v[84:87], 0
  buffer_load_dwordx4 v12, s[28:31], s51 offen lds
  v_mfma_f32_16x16x32_bf16 v[136:139], v[64:67], v[88:91], 0
  ds_read_b64_tr_b16 v[100:101], v32 offset:36864
  ds_read_b128 v[116:119], v39 offset:40960
  v_mfma_f32_16x16x32_bf16 v[144:147], v[68:71], v[80:83], 0
  buffer_load_dwordx4 v13, s[28:31], s51 offen offset:1024 lds
  v_mfma_f32_16x16x32_bf16 v[148:151], v[68:71], v[84:87], 0
  s_add_u32 m0, s46, 24576
  ds_read_b64_tr_b16 v[102:103], v32 offset:38912
  ds_read_b128 v[120:123], v40 offset:0
  v_mfma_f32_16x16x32_bf16 v[152:155], v[68:71], v[88:91], 0
  buffer_load_dwordx4 v10, s[28:31], s69 offen lds
  v_mfma_f32_16x16x32_bf16 v[160:163], v[72:75], v[80:83], 0
  ds_read_b64_tr_b16 v[104:105], v33 offset:36864
  ds_read_b64_tr_b16 v[106:107], v33 offset:38912
  v_mfma_f32_16x16x32_bf16 v[164:167], v[72:75], v[84:87], 0
  buffer_load_dwordx4 v11, s[28:31], s69 offen offset:1024 lds
  v_mfma_f32_16x16x32_bf16 v[168:171], v[72:75], v[88:91], 0
  s_add_u32 m0, s46, 26624
  ds_read_b64_tr_b16 v[108:109], v34 offset:36864
  ds_read_b64_tr_b16 v[110:111], v34 offset:38912
  v_mfma_f32_16x16x32_bf16 v[176:179], v[76:79], v[80:83], 0
  buffer_load_dwordx4 v12, s[28:31], s69 offen lds
  v_mfma_f32_16x16x32_bf16 v[180:183], v[76:79], v[84:87], 0
  v_mfma_f32_16x16x32_bf16 v[184:187], v[76:79], v[88:91], 0
  buffer_load_dwordx4 v13, s[28:31], s69 offen offset:1024 lds
  s_waitcnt vmcnt(8) lgkmcnt(0)
  v_mfma_f32_16x16x32_bf16 v[128:131], v[96:99], v[112:115], v[128:131]
  s_add_u32 m0, s46, 8192
  ds_read_b64_tr_b16 v[64:65], v31 offset:16384
  ds_read_b64_tr_b16 v[66:67], v31 offset:18432
  ds_read_b128 v[80:83], v37 offset:2048
  v_mfma_f32_16x16x32_bf16 v[132:135], v[96:99], v[116:119], v[132:135]
  buffer_load_dwordx4 v22, s[16:19], s64 offen lds
  v_mfma_f32_16x16x32_bf16 v[136:139], v[96:99], v[120:123], v[136:139]
  ds_read_b64_tr_b16 v[68:69], v32 offset:16384
  ds_read_b128 v[84:87], v37 offset:43008
  v_mfma_f32_16x16x32_bf16 v[144:147], v[100:103], v[112:115], v[144:147]
  buffer_load_dwordx4 v23, s[16:19], s64 offen offset:1024 lds
  v_mfma_f32_16x16x32_bf16 v[148:151], v[100:103], v[116:119], v[148:151]
  s_add_u32 m0, s46, 28672
  s_add_u32 s51, s69, 262144
  ds_read_b64_tr_b16 v[70:71], v32 offset:18432
  ds_read_b128 v[88:91], v38 offset:2048
  v_mfma_f32_16x16x32_bf16 v[152:155], v[100:103], v[120:123], v[152:155]
  buffer_load_dwordx4 v10, s[28:31], s51 offen lds
  v_mfma_f32_16x16x32_bf16 v[160:163], v[104:107], v[112:115], v[160:163]
  ds_read_b64_tr_b16 v[72:73], v33 offset:16384
  ds_read_b64_tr_b16 v[74:75], v33 offset:18432
  v_mfma_f32_16x16x32_bf16 v[164:167], v[104:107], v[116:119], v[164:167]
  buffer_load_dwordx4 v11, s[28:31], s51 offen offset:1024 lds
  v_mfma_f32_16x16x32_bf16 v[168:171], v[104:107], v[120:123], v[168:171]
  s_add_u32 m0, s46, 14336
  ds_read_b64_tr_b16 v[76:77], v34 offset:16384
  ds_read_b64_tr_b16 v[78:79], v34 offset:18432
  v_mfma_f32_16x16x32_bf16 v[176:179], v[108:111], v[112:115], v[176:179]
  buffer_load_dwordx4 v12, s[28:31], s51 offen lds
  v_mfma_f32_16x16x32_bf16 v[180:183], v[108:111], v[116:119], v[180:183]
  v_mfma_f32_16x16x32_bf16 v[184:187], v[108:111], v[120:123], v[184:187]
  buffer_load_dwordx4 v13, s[28:31], s51 offen offset:1024 lds
  s_waitcnt vmcnt(10) lgkmcnt(0)
  v_mfma_f32_16x16x32_bf16 v[128:131], v[64:67], v[80:83], v[128:131]
  s_add_u32 m0, s46, 10240
  ds_read_b64_tr_b16 v[96:97], v31 offset:20480
  ds_read_b64_tr_b16 v[98:99], v31 offset:22528
  ds_read_b128 v[112:115], v39 offset:2048
  v_mfma_f32_16x16x32_bf16 v[132:135], v[64:67], v[84:87], v[132:135]
  buffer_load_dwordx4 v22, s[16:19], s65 offen lds
  v_mfma_f32_16x16x32_bf16 v[136:139], v[64:67], v[88:91], v[136:139]
  ds_read_b64_tr_b16 v[100:101], v32 offset:20480
  ds_read_b128 v[116:119], v39 offset:43008
  v_mfma_f32_16x16x32_bf16 v[144:147], v[68:71], v[80:83], v[144:147]
  buffer_load_dwordx4 v23, s[16:19], s65 offen offset:1024 lds
  v_mfma_f32_16x16x32_bf16 v[148:151], v[68:71], v[84:87], v[148:151]
  s_add_u32 m0, s46, 32768
  ds_read_b64_tr_b16 v[102:103], v32 offset:22528
  ds_read_b128 v[120:123], v40 offset:2048
  v_mfma_f32_16x16x32_bf16 v[152:155], v[68:71], v[88:91], v[152:155]
  buffer_load_dwordx4 v10, s[28:31], s70 offen lds
  v_mfma_f32_16x16x32_bf16 v[160:163], v[72:75], v[80:83], v[160:163]
  ds_read_b64_tr_b16 v[104:105], v33 offset:20480
  ds_read_b64_tr_b16 v[106:107], v33 offset:22528
  v_mfma_f32_16x16x32_bf16 v[164:167], v[72:75], v[84:87], v[164:167]
  buffer_load_dwordx4 v11, s[28:31], s70 offen offset:1024 lds
  v_mfma_f32_16x16x32_bf16 v[168:171], v[72:75], v[88:91], v[168:171]
  s_add_u32 m0, s46, 34816
  ds_read_b64_tr_b16 v[108:109], v34 offset:20480
  ds_read_b64_tr_b16 v[110:111], v34 offset:22528
  v_mfma_f32_16x16x32_bf16 v[176:179], v[76:79], v[80:83], v[176:179]
  buffer_load_dwordx4 v12, s[28:31], s70 offen lds
  v_mfma_f32_16x16x32_bf16 v[180:183], v[76:79], v[84:87], v[180:183]
  v_mfma_f32_16x16x32_bf16 v[184:187], v[76:79], v[88:91], v[184:187]
  buffer_load_dwordx4 v13, s[28:31], s70 offen offset:1024 lds
  s_waitcnt vmcnt(12) lgkmcnt(0)
  s_barrier
  v_mfma_f32_16x16x32_bf16 v[128:131], v[96:99], v[112:115], v[128:131]
  s_add_u32 m0, s46, 12288
  ds_read_b64_tr_b16 v[64:65], v31 offset:24576
  ds_read_b64_tr_b16 v[66:67], v31 offset:26624
  ds_read_b128 v[80:83], v37 offset:4096
  v_mfma_f32_16x16x32_bf16 v[132:135], v[96:99], v[116:119], v[132:135]
  buffer_load_dwordx4 v22, s[16:19], s66 offen lds
  v_mfma_f32_16x16x32_bf16 v[136:139], v[96:99], v[120:123], v[136:139]
  ds_read_b64_tr_b16 v[68:69], v32 offset:24576
  ds_read_b128 v[84:87], v37 offset:45056
  v_mfma_f32_16x16x32_bf16 v[144:147], v[100:103], v[112:115], v[144:147]
  buffer_load_dwordx4 v23, s[16:19], s66 offen offset:1024 lds
  v_mfma_f32_16x16x32_bf16 v[148:151], v[100:103], v[116:119], v[148:151]
  s_add_u32 m0, s46, 36864
  s_add_u32 s51, s70, 262144
  ds_read_b64_tr_b16 v[70:71], v32 offset:26624
  ds_read_b128 v[88:91], v38 offset:4096
  v_mfma_f32_16x16x32_bf16 v[152:155], v[100:103], v[120:123], v[152:155]
  buffer_load_dwordx4 v10, s[28:31], s51 offen lds
  v_mfma_f32_16x16x32_bf16 v[160:163], v[104:107], v[112:115], v[160:163]
  ds_read_b64_tr_b16 v[72:73], v33 offset:24576
  ds_read_b64_tr_b16 v[74:75], v33 offset:26624
  v_mfma_f32_16x16x32_bf16 v[164:167], v[104:107], v[116:119], v[164:167]
  buffer_load_dwordx4 v11, s[28:31], s51 offen offset:1024 lds
  v_mfma_f32_16x16x32_bf16 v[168:171], v[104:107], v[120:123], v[168:171]
  s_add_u32 m0, s46, 38912
  ds_read_b64_tr_b16 v[76:77], v34 offset:24576
  ds_read_b64_tr_b16 v[78:79], v34 offset:26624
  v_mfma_f32_16x16x32_bf16 v[176:179], v[108:111], v[112:115], v[176:179]
  buffer_load_dwordx4 v12, s[28:31], s51 offen lds
  v_mfma_f32_16x16x32_bf16 v[180:183], v[108:111], v[116:119], v[180:183]
  v_mfma_f32_16x16x32_bf16 v[184:187], v[108:111], v[120:123], v[184:187]
  buffer_load_dwordx4 v13, s[28:31], s51 offen offset:1024 lds
  s_waitcnt vmcnt(12) lgkmcnt(0)
  v_mfma_f32_16x16x32_bf16 v[128:131], v[64:67], v[80:83], v[128:131]
  s_add_u32 m0, s46, 16384
  ds_read_b64_tr_b16 v[96:97], v31 offset:28672
  ds_read_b64_tr_b16 v[98:99], v31 offset:14336
  ds_read_b128 v[112:115], v39 offset:4096
  v_mfma_f32_16x16x32_bf16 v[132:135], v[64:67], v[84:87], v[132:135]
  buffer_load_dwordx4 v10, s[28:31], s71 offen lds
  v_mfma_f32_16x16x32_bf16 v[136:139], v[64:67], v[88:91], v[136:139]
  ds_read_b64_tr_b16 v[100:101], v32 offset:28672
  ds_read_b128 v[116:119], v39 offset:45056
  v_mfma_f32_16x16x32_bf16 v[144:147], v[68:71], v[80:83], v[144:147]
  buffer_load_dwordx4 v11, s[28:31], s71 offen offset:1024 lds
  v_mfma_f32_16x16x32_bf16 v[148:151], v[68:71], v[84:87], v[148:151]
  s_add_u32 m0, s46, 18432
  ds_read_b64_tr_b16 v[102:103], v32 offset:14336
  ds_read_b128 v[120:123], v40 offset:4096
  v_mfma_f32_16x16x32_bf16 v[152:155], v[68:71], v[88:91], v[152:155]
  buffer_load_dwordx4 v12, s[28:31], s71 offen lds
  v_mfma_f32_16x16x32_bf16 v[160:163], v[72:75], v[80:83], v[160:163]
  ds_read_b64_tr_b16 v[104:105], v33 offset:28672
  ds_read_b64_tr_b16 v[106:107], v33 offset:14336
  v_mfma_f32_16x16x32_bf16 v[164:167], v[72:75], v[84:87], v[164:167]
  buffer_load_dwordx4 v13, s[28:31], s71 offen offset:1024 lds
  v_mfma_f32_16x16x32_bf16 v[168:171], v[72:75], v[88:91], v[168:171]
  s_add_u32 m0, s46, 20480
  s_add_u32 s51, s71, 262144
  ds_read_b64_tr_b16 v[108:109], v34 offset:28672
  ds_read_b64_tr_b16 v[110:111], v34 offset:14336
  v_mfma_f32_16x16x32_bf16 v[176:179], v[76:79], v[80:83], v[176:179]
  buffer_load_dwordx4 v10, s[28:31], s51 offen lds
  v_mfma_f32_16x16x32_bf16 v[180:183], v[76:79], v[84:87], v[180:183]
  v_mfma_f32_16x16x32_bf16 v[184:187], v[76:79], v[88:91], v[184:187]
  buffer_load_dwordx4 v11, s[28:31], s51 offen offset:1024 lds
  s_waitcnt vmcnt(12) lgkmcnt(0)
  v_mfma_f32_16x16x32_bf16 v[128:131], v[96:99], v[112:115], v[128:131]
  s_add_u32 m0, s46, 22528
  ds_read_b64_tr_b16 v[64:65], v31 offset:32768
  ds_read_b64_tr_b16 v[66:67], v31 offset:34816
  ds_read_b128 v[80:83], v37 offset:6144
  v_mfma_f32_16x16x32_bf16 v[132:135], v[96:99], v[116:119], v[132:135]
  buffer_load_dwordx4 v12, s[28:31], s51 offen lds
  v_mfma_f32_16x16x32_bf16 v[136:139], v[96:99], v[120:123], v[136:139]
  ds_read_b64_tr_b16 v[68:69], v32 offset:32768
  ds_read_b128 v[84:87], v37 offset:47104
  v_mfma_f32_16x16x32_bf16 v[144:147], v[100:103], v[112:115], v[144:147]
  buffer_load_dwordx4 v13, s[28:31], s51 offen offset:1024 lds
  v_mfma_f32_16x16x32_bf16 v[148:151], v[100:103], v[116:119], v[148:151]
  s_add_u32 m0, s46, 24576
  ds_read_b64_tr_b16 v[70:71], v32 offset:34816
  ds_read_b128 v[88:91], v38 offset:6144
  v_mfma_f32_16x16x32_bf16 v[152:155], v[100:103], v[120:123], v[152:155]
  buffer_load_dwordx4 v10, s[28:31], s72 offen lds
  v_mfma_f32_16x16x32_bf16 v[160:163], v[104:107], v[112:115], v[160:163]
  ds_read_b64_tr_b16 v[72:73], v33 offset:32768
  ds_read_b64_tr_b16 v[74:75], v33 offset:34816
  v_mfma_f32_16x16x32_bf16 v[164:167], v[104:107], v[116:119], v[164:167]
  buffer_load_dwordx4 v11, s[28:31], s72 offen offset:1024 lds
  v_mfma_f32_16x16x32_bf16 v[168:171], v[104:107], v[120:123], v[168:171]
  s_add_u32 m0, s46, 26624
  ds_read_b64_tr_b16 v[76:77], v34 offset:32768
  ds_read_b64_tr_b16 v[78:79], v34 offset:34816
  v_mfma_f32_16x16x32_bf16 v[176:179], v[108:111], v[112:115], v[176:179]
  buffer_load_dwordx4 v12, s[28:31], s72 offen lds
  v_mfma_f32_16x16x32_bf16 v[180:183], v[108:111], v[116:119], v[180:183]
  v_mfma_f32_16x16x32_bf16 v[184:187], v[108:111], v[120:123], v[184:187]
  buffer_load_dwordx4 v13, s[28:31], s72 offen offset:1024 lds
  s_waitcnt vmcnt(12) lgkmcnt(0)
  v_mfma_f32_16x16x32_bf16 v[128:131], v[64:67], v[80:83], v[128:131]
  ds_read_b64_tr_b16 v[96:97], v31 offset:36864
  ds_read_b64_tr_b16 v[98:99], v31 offset:38912
  ds_read_b128 v[112:115], v39 offset:6144
  v_mfma_f32_16x16x32_bf16 v[132:135], v[64:67], v[84:87], v[132:135]
  v_mfma_f32_16x16x32_bf16 v[136:139], v[64:67], v[88:91], v[136:139]
  ds_read_b64_tr_b16 v[100:101], v32 offset:36864
  ds_read_b128 v[116:119], v39 offset:47104
  v_mfma_f32_16x16x32_bf16 v[144:147], v[68:71], v[80:83], v[144:147]
  v_mfma_f32_16x16x32_bf16 v[148:151], v[68:71], v[84:87], v[148:151]
  ds_read_b64_tr_b16 v[102:103], v32 offset:38912
  ds_read_b128 v[120:123], v40 offset:6144
  v_mfma_f32_16x16x32_bf16 v[152:155], v[68:71], v[88:91], v[152:155]
  v_mfma_f32_16x16x32_bf16 v[160:163], v[72:75], v[80:83], v[160:163]
  ds_read_b64_tr_b16 v[104:105], v33 offset:36864
  ds_read_b64_tr_b16 v[106:107], v33 offset:38912
  v_mfma_f32_16x16x32_bf16 v[164:167], v[72:75], v[84:87], v[164:167]
  v_mfma_f32_16x16x32_bf16 v[168:171], v[72:75], v[88:91], v[168:171]
  ds_read_b64_tr_b16 v[108:109], v34 offset:36864
  ds_read_b64_tr_b16 v[110:111], v34 offset:38912
  v_mfma_f32_16x16x32_bf16 v[176:179], v[76:79], v[80:83], v[176:179]
  v_mfma_f32_16x16x32_bf16 v[180:183], v[76:79], v[84:87], v[180:183]
  v_mfma_f32_16x16x32_bf16 v[184:187], v[76:79], v[88:91], v[184:187]
  s_waitcnt vmcnt(8) lgkmcnt(0)
  s_barrier
  v_mfma_f32_16x16x32_bf16 v[128:131], v[96:99], v[112:115], v[128:131]
  s_add_u32 m0, s46, 0
  s_add_u32 s51, s4, 0
  ds_read_b64_tr_b16 v[64:65], v31 offset:16384
  ds_read_b64_tr_b16 v[66:67], v31 offset:18432
  ds_read_b128 v[80:83], v37 offset:8192
  v_mfma_f32_16x16x32_bf16 v[132:135], v[96:99], v[116:119], v[132:135]
  buffer_load_dwordx4 v18, s[20:23], s51 offen lds
  v_mfma_f32_16x16x32_bf16 v[136:139], v[96:99], v[120:123], v[136:139]
  ds_read_b64_tr_b16 v[68:69], v32 offset:16384
  ds_read_b128 v[84:87], v37 offset:49152
  v_mfma_f32_16x16x32_bf16 v[144:147], v[100:103], v[112:115], v[144:147]
  buffer_load_dwordx4 v19, s[20:23], s51 offen offset:1024 lds
  v_mfma_f32_16x16x32_bf16 v[148:151], v[100:103], v[116:119], v[148:151]
  s_add_u32 m0, s46, 2048
  ds_read_b64_tr_b16 v[70:71], v32 offset:18432
  ds_read_b128 v[88:91], v38 offset:8192
  v_mfma_f32_16x16x32_bf16 v[152:155], v[100:103], v[120:123], v[152:155]
  buffer_load_dwordx4 v20, s[20:23], s51 offen lds
  v_mfma_f32_16x16x32_bf16 v[160:163], v[104:107], v[112:115], v[160:163]
  ds_read_b64_tr_b16 v[72:73], v33 offset:16384
  ds_read_b64_tr_b16 v[74:75], v33 offset:18432
  v_mfma_f32_16x16x32_bf16 v[164:167], v[104:107], v[116:119], v[164:167]
  buffer_load_dwordx4 v21, s[20:23], s51 offen offset:1024 lds
  v_mfma_f32_16x16x32_bf16 v[168:171], v[104:107], v[120:123], v[168:171]
  s_add_u32 m0, s46, 4096
  s_add_u32 s51, s4, 16384
  ds_read_b64_tr_b16 v[76:77], v34 offset:16384
  ds_read_b64_tr_b16 v[78:79], v34 offset:18432
  v_mfma_f32_16x16x32_bf16 v[176:179], v[108:111], v[112:115], v[176:179]
  buffer_load_dwordx4 v18, s[20:23], s51 offen lds
  v_mfma_f32_16x16x32_bf16 v[180:183], v[108:111], v[116:119], v[180:183]
  v_mfma_f32_16x16x32_bf16 v[184:187], v[108:111], v[120:123], v[184:187]
  buffer_load_dwordx4 v19, s[20:23], s51 offen offset:1024 lds
  s_waitcnt vmcnt(10) lgkmcnt(0)
  v_mfma_f32_16x16x32_bf16 v[128:131], v[64:67], v[80:83], v[128:131]
  s_add_u32 m0, s46, 6144
  ds_read_b64_tr_b16 v[96:97], v31 offset:20480
  ds_read_b64_tr_b16 v[98:99], v31 offset:22528
  ds_read_b128 v[112:115], v39 offset:8192
  v_mfma_f32_16x16x32_bf16 v[132:135], v[64:67], v[84:87], v[132:135]
  buffer_load_dwordx4 v20, s[20:23], s51 offen lds
  v_mfma_f32_16x16x32_bf16 v[136:139], v[64:67], v[88:91], v[136:139]
  ds_read_b64_tr_b16 v[100:101], v32 offset:20480
  ds_read_b128 v[116:119], v39 offset:49152
  v_mfma_f32_16x16x32_bf16 v[144:147], v[68:71], v[80:83], v[144:147]
  buffer_load_dwordx4 v21, s[20:23], s51 offen offset:1024 lds
  v_mfma_f32_16x16x32_bf16 v[148:151], v[68:71], v[84:87], v[148:151]
  s_add_u32 m0, s46, 28672
  s_add_u32 s51, s72, 262144
  ds_read_b64_tr_b16 v[102:103], v32 offset:22528
  ds_read_b128 v[120:123], v40 offset:8192
  v_mfma_f32_16x16x32_bf16 v[152:155], v[68:71], v[88:91], v[152:155]
  buffer_load_dwordx4 v10, s[28:31], s51 offen lds
  v_mfma_f32_16x16x32_bf16 v[160:163], v[72:75], v[80:83], v[160:163]
  ds_read_b64_tr_b16 v[104:105], v33 offset:20480
  ds_read_b64_tr_b16 v[106:107], v33 offset:22528
  v_mfma_f32_16x16x32_bf16 v[164:167], v[72:75], v[84:87], v[164:167]
  buffer_load_dwordx4 v11, s[28:31], s51 offen offset:1024 lds
  v_mfma_f32_16x16x32_bf16 v[168:171], v[72:75], v[88:91], v[168:171]
  s_add_u32 m0, s46, 14336
  ds_read_b64_tr_b16 v[108:109], v34 offset:20480
  ds_read_b64_tr_b16 v[110:111], v34 offset:22528
  v_mfma_f32_16x16x32_bf16 v[176:179], v[76:79], v[80:83], v[176:179]
  buffer_load_dwordx4 v12, s[28:31], s51 offen lds
  v_mfma_f32_16x16x32_bf16 v[180:183], v[76:79], v[84:87], v[180:183]
  v_mfma_f32_16x16x32_bf16 v[184:187], v[76:79], v[88:91], v[184:187]
  buffer_load_dwordx4 v13, s[28:31], s51 offen offset:1024 lds
  s_waitcnt vmcnt(12) lgkmcnt(0)
  v_mfma_f32_16x16x32_bf16 v[128:131], v[96:99], v[112:115], v[128:131]
  s_add_u32 m0, s46, 32768
  ds_read_b64_tr_b16 v[64:65], v31 offset:24576
  ds_read_b64_tr_b16 v[66:67], v31 offset:26624
  ds_read_b128 v[80:83], v37 offset:10240
  v_mfma_f32_16x16x32_bf16 v[132:135], v[96:99], v[116:119], v[132:135]
  buffer_load_dwordx4 v10, s[28:31], s73 offen lds
  v_mfma_f32_16x16x32_bf16 v[136:139], v[96:99], v[120:123], v[136:139]
  ds_read_b64_tr_b16 v[68:69], v32 offset:24576
  ds_read_b128 v[84:87], v37 offset:51200
  v_mfma_f32_16x16x32_bf16 v[144:147], v[100:103], v[112:115], v[144:147]
  buffer_load_dwordx4 v11, s[28:31], s73 offen offset:1024 lds
  v_mfma_f32_16x16x32_bf16 v[148:151], v[100:103], v[116:119], v[148:151]
  s_add_u32 m0, s46, 34816
  ds_read_b64_tr_b16 v[70:71], v32 offset:26624
  ds_read_b128 v[88:91], v38 offset:10240
  v_mfma_f32_16x16x32_bf16 v[152:155], v[100:103], v[120:123], v[152:155]
  buffer_load_dwordx4 v12, s[28:31], s73 offen lds
  v_mfma_f32_16x16x32_bf16 v[160:163], v[104:107], v[112:115], v[160:163]
  ds_read_b64_tr_b16 v[72:73], v33 offset:24576
  ds_read_b64_tr_b16 v[74:75], v33 offset:26624
  v_mfma_f32_16x16x32_bf16 v[164:167], v[104:107], v[116:119], v[164:167]
  buffer_load_dwordx4 v13, s[28:31], s73 offen offset:1024 lds
  v_mfma_f32_16x16x32_bf16 v[168:171], v[104:107], v[120:123], v[168:171]
  s_add_u32 m0, s46, 36864
  s_add_u32 s51, s73, 262144
  ds_read_b64_tr_b16 v[76:77], v34 offset:24576
  ds_read_b64_tr_b16 v[78:79], v34 offset:26624
  v_mfma_f32_16x16x32_bf16 v[176:179], v[108:111], v[112:115], v[176:179]
  buffer_load_dwordx4 v10, s[28:31], s51 offen lds
  v_mfma_f32_16x16x32_bf16 v[180:183], v[108:111], v[116:119], v[180:183]
  v_mfma_f32_16x16x32_bf16 v[184:187], v[108:111], v[120:123], v[184:187]
  buffer_load_dwordx4 v11, s[28:31], s51 offen offset:1024 lds
  s_waitcnt vmcnt(6) lgkmcnt(0)
  v_mfma_f32_16x16x32_bf16 v[128:131], v[64:67], v[80:83], v[128:131]
  s_add_u32 m0, s46, 38912
  ds_read_b64_tr_b16 v[96:97], v31 offset:28672
  ds_read_b64_tr_b16 v[98:99], v31 offset:14336
  ds_read_b128 v[112:115], v39 offset:10240
  v_mfma_f32_16x16x32_bf16 v[132:135], v[64:67], v[84:87], v[132:135]
  buffer_load_dwordx4 v12, s[28:31], s51 offen lds
  v_mfma_f32_16x16x32_bf16 v[136:139], v[64:67], v[88:91], v[136:139]
  ds_read_b64_tr_b16 v[100:101], v32 offset:28672
  ds_read_b128 v[116:119], v39 offset:51200
  v_mfma_f32_16x16x32_bf16 v[144:147], v[68:71], v[80:83], v[144:147]
  buffer_load_dwordx4 v13, s[28:31], s51 offen offset:1024 lds
  v_mfma_f32_16x16x32_bf16 v[148:151], v[68:71], v[84:87], v[148:151]
  s_add_u32 m0, s46, 16384
  s_add_u32 s51, s6, 0
  ds_read_b64_tr_b16 v[102:103], v32 offset:14336
  ds_read_b128 v[120:123], v40 offset:10240
  v_mfma_f32_16x16x32_bf16 v[152:155], v[68:71], v[88:91], v[152:155]
  buffer_load_dwordx4 v18, s[20:23], s51 offen lds
  v_mfma_f32_16x16x32_bf16 v[160:163], v[72:75], v[80:83], v[160:163]
  ds_read_b64_tr_b16 v[104:105], v33 offset:28672
  ds_read_b64_tr_b16 v[106:107], v33 offset:14336
  v_mfma_f32_16x16x32_bf16 v[164:167], v[72:75], v[84:87], v[164:167]
  buffer_load_dwordx4 v19, s[20:23], s51 offen offset:1024 lds
  v_mfma_f32_16x16x32_bf16 v[168:171], v[72:75], v[88:91], v[168:171]
  s_add_u32 m0, s46, 18432
  ds_read_b64_tr_b16 v[108:109], v34 offset:28672
  ds_read_b64_tr_b16 v[110:111], v34 offset:14336
  v_mfma_f32_16x16x32_bf16 v[176:179], v[76:79], v[80:83], v[176:179]
  buffer_load_dwordx4 v20, s[20:23], s51 offen lds
  v_mfma_f32_16x16x32_bf16 v[180:183], v[76:79], v[84:87], v[180:183]
  v_mfma_f32_16x16x32_bf16 v[184:187], v[76:79], v[88:91], v[184:187]
  buffer_load_dwordx4 v21, s[20:23], s51 offen offset:1024 lds
  s_waitcnt vmcnt(8) lgkmcnt(0)
  v_mfma_f32_16x16x32_bf16 v[128:131], v[96:99], v[112:115], v[128:131]
  s_add_u32 m0, s46, 20480
  s_add_u32 s51, s6, 16384
  ds_read_b64_tr_b16 v[64:65], v31 offset:32768
  ds_read_b64_tr_b16 v[66:67], v31 offset:34816
  ds_read_b128 v[80:83], v37 offset:12288
  v_mfma_f32_16x16x32_bf16 v[132:135], v[96:99], v[116:119], v[132:135]
  buffer_load_dwordx4 v18, s[20:23], s51 offen lds
  v_mfma_f32_16x16x32_bf16 v[136:139], v[96:99], v[120:123], v[136:139]
  ds_read_b64_tr_b16 v[68:69], v32 offset:32768
  ds_read_b128 v[84:87], v37 offset:53248
  v_mfma_f32_16x16x32_bf16 v[144:147], v[100:103], v[112:115], v[144:147]
  buffer_load_dwordx4 v19, s[20:23], s51 offen offset:1024 lds
  v_mfma_f32_16x16x32_bf16 v[148:151], v[100:103], v[116:119], v[148:151]
  s_add_u32 m0, s46, 22528
  ds_read_b64_tr_b16 v[70:71], v32 offset:34816
  ds_read_b128 v[88:91], v38 offset:12288
  v_mfma_f32_16x16x32_bf16 v[152:155], v[100:103], v[120:123], v[152:155]
  buffer_load_dwordx4 v20, s[20:23], s51 offen lds
  v_mfma_f32_16x16x32_bf16 v[160:163], v[104:107], v[112:115], v[160:163]
  ds_read_b64_tr_b16 v[72:73], v33 offset:32768
  ds_read_b64_tr_b16 v[74:75], v33 offset:34816
  v_mfma_f32_16x16x32_bf16 v[164:167], v[104:107], v[116:119], v[164:167]
  buffer_load_dwordx4 v21, s[20:23], s51 offen offset:1024 lds
  v_mfma_f32_16x16x32_bf16 v[168:171], v[104:107], v[120:123], v[168:171]
  s_add_u32 m0, s46, 24576
  s_add_u32 s51, s4, 32768
  ds_read_b64_tr_b16 v[76:77], v34 offset:32768
  ds_read_b64_tr_b16 v[78:79], v34 offset:34816
  v_mfma_f32_16x16x32_bf16 v[176:179], v[108:111], v[112:115], v[176:179]
  buffer_load_dwordx4 v18, s[20:23], s51 offen lds
  v_mfma_f32_16x16x32_bf16 v[180:183], v[108:111], v[116:119], v[180:183]
  v_mfma_f32_16x16x32_bf16 v[184:187], v[108:111], v[120:123], v[184:187]
  buffer_load_dwordx4 v19, s[20:23], s51 offen offset:1024 lds
  s_waitcnt vmcnt(10) lgkmcnt(0)
  v_mfma_f32_16x16x32_bf16 v[128:131], v[64:67], v[80:83], v[128:131]
  s_add_u32 m0, s46, 26624
  ds_read_b64_tr_b16 v[96:97], v31 offset:36864
  ds_read_b64_tr_b16 v[98:99], v31 offset:38912
  ds_read_b128 v[112:115], v39 offset:12288
  v_mfma_f32_16x16x32_bf16 v[132:135], v[64:67], v[84:87], v[132:135]
  buffer_load_dwordx4 v20, s[20:23], s51 offen lds
  v_mfma_f32_16x16x32_bf16 v[136:139], v[64:67], v[88:91], v[136:139]
  ds_read_b64_tr_b16 v[100:101], v32 offset:36864
  ds_read_b128 v[116:119], v39 offset:53248
  v_mfma_f32_16x16x32_bf16 v[144:147], v[68:71], v[80:83], v[144:147]
  buffer_load_dwordx4 v21, s[20:23], s51 offen offset:1024 lds
  v_mfma_f32_16x16x32_bf16 v[148:151], v[68:71], v[84:87], v[148:151]
  s_add_u32 m0, s46, 28672
  s_add_u32 s51, s4, 49152
  ds_read_b64_tr_b16 v[102:103], v32 offset:38912
  ds_read_b128 v[120:123], v40 offset:12288
  v_mfma_f32_16x16x32_bf16 v[152:155], v[68:71], v[88:91], v[152:155]
  buffer_load_dwordx4 v18, s[20:23], s51 offen lds
  v_mfma_f32_16x16x32_bf16 v[160:163], v[72:75], v[80:83], v[160:163]
  ds_read_b64_tr_b16 v[104:105], v33 offset:36864
  ds_read_b64_tr_b16 v[106:107], v33 offset:38912
  v_mfma_f32_16x16x32_bf16 v[164:167], v[72:75], v[84:87], v[164:167]
  buffer_load_dwordx4 v19, s[20:23], s51 offen offset:1024 lds
  v_mfma_f32_16x16x32_bf16 v[168:171], v[72:75], v[88:91], v[168:171]
  s_add_u32 m0, s46, 14336
  ds_read_b64_tr_b16 v[108:109], v34 offset:36864
  ds_read_b64_tr_b16 v[110:111], v34 offset:38912
  v_mfma_f32_16x16x32_bf16 v[176:179], v[76:79], v[80:83], v[176:179]
  buffer_load_dwordx4 v20, s[20:23], s51 offen lds
  v_mfma_f32_16x16x32_bf16 v[180:183], v[76:79], v[84:87], v[180:183]
  v_mfma_f32_16x16x32_bf16 v[184:187], v[76:79], v[88:91], v[184:187]
  buffer_load_dwordx4 v21, s[20:23], s51 offen offset:1024 lds
  s_waitcnt lgkmcnt(0)
  v_mfma_f32_16x16x32_bf16 v[128:131], v[96:99], v[112:115], v[128:131]
  v_mfma_f32_16x16x32_bf16 v[132:135], v[96:99], v[116:119], v[132:135]
  v_mfma_f32_16x16x32_bf16 v[136:139], v[96:99], v[120:123], v[136:139]
  v_mfma_f32_16x16x32_bf16 v[144:147], v[100:103], v[112:115], v[144:147]
  v_mfma_f32_16x16x32_bf16 v[148:151], v[100:103], v[116:119], v[148:151]
  v_mfma_f32_16x16x32_bf16 v[152:155], v[100:103], v[120:123], v[152:155]
  v_cvt_pk_bf16_f32 v64, v128, v129
  v_cvt_pk_bf16_f32 v65, v130, v131
  v_mfma_f32_16x16x32_bf16 v[160:163], v[104:107], v[112:115], v[160:163]
  v_cvt_pk_bf16_f32 v66, v132, v133
  v_cvt_pk_bf16_f32 v67, v134, v135
  v_mfma_f32_16x16x32_bf16 v[164:167], v[104:107], v[116:119], v[164:167]
  v_mfma_f32_16x16x32_bf16 v[168:171], v[104:107], v[120:123], v[168:171]
  v_cvt_pk_bf16_f32 v68, v136, v137
  v_cvt_pk_bf16_f32 v69, v138, v139
  v_mfma_f32_16x16x32_bf16 v[176:179], v[108:111], v[112:115], v[176:179]
  v_cvt_pk_bf16_f32 v72, v144, v145
  v_cvt_pk_bf16_f32 v73, v146, v147
  v_mfma_f32_16x16x32_bf16 v[180:183], v[108:111], v[116:119], v[180:183]
  v_cvt_pk_bf16_f32 v74, v148, v149
  v_cvt_pk_bf16_f32 v75, v150, v151
  v_mfma_f32_16x16x32_bf16 v[184:187], v[108:111], v[120:123], v[184:187]
  ds_write_b64 v45, v[64:65] offset:32768
  ds_write_b64 v45, v[66:67] offset:33792
  ds_write_b64 v45, v[68:69] offset:34816
  ds_write_b64 v45, v[72:73] offset:33280
  ds_write_b64 v45, v[74:75] offset:34304
  v_cvt_pk_bf16_f32 v76, v152, v153
  v_cvt_pk_bf16_f32 v77, v154, v155
  ds_write_b64 v45, v[76:77] offset:35328
  v_cvt_pk_bf16_f32 v80, v160, v161
  v_cvt_pk_bf16_f32 v81, v162, v163
  ds_write_b64 v45, v[80:81] offset:36864
  v_cvt_pk_bf16_f32 v82, v164, v165
  v_cvt_pk_bf16_f32 v83, v166, v167
  ds_write_b64 v45, v[82:83] offset:37888
  v_cvt_pk_bf16_f32 v84, v168, v169
  v_cvt_pk_bf16_f32 v85, v170, v171
  ds_write_b64 v45, v[84:85] offset:38912
  v_cvt_pk_bf16_f32 v88, v176, v177
  v_cvt_pk_bf16_f32 v89, v178, v179
  ds_write_b64 v45, v[88:89] offset:37376
  v_cvt_pk_bf16_f32 v90, v180, v181
  v_cvt_pk_bf16_f32 v91, v182, v183
  ds_write_b64 v45, v[90:91] offset:38400
  v_cvt_pk_bf16_f32 v92, v184, v185
  v_cvt_pk_bf16_f32 v93, v186, v187
  ds_write_b64 v45, v[92:93] offset:39424
  s_waitcnt lgkmcnt(0)
  ds_read_b128 v[64:67], v35 offset:0
  ds_read_b128 a[0:3], v41 offset:32768
  ds_read_b128 a[4:7], v41 offset:33792
  ds_read_b128 a[8:11], v41 offset:34816
  ds_read_b128 v[68:71], v35 offset:2048
  ds_read_b128 v[72:75], v35 offset:4096
  ds_read_b128 v[76:79], v35 offset:6144
  s_waitcnt lgkmcnt(0)
  v_mfma_f32_16x16x32_bf16 v[128:131], v[64:67], a[0:3], 0
  ds_read_b128 v[96:99], v36 offset:0
  ds_read_b128 a[16:19], v41 offset:36864
  v_mfma_f32_16x16x32_bf16 v[132:135], v[64:67], a[4:7], 0
  v_mfma_f32_16x16x32_bf16 v[136:139], v[64:67], a[8:11], 0
  ds_read_b128 a[20:23], v41 offset:37888
  ds_read_b128 a[24:27], v41 offset:38912
  v_mfma_f32_16x16x32_bf16 v[144:147], v[68:71], a[0:3], 0
  v_mfma_f32_16x16x32_bf16 v[148:151], v[68:71], a[4:7], 0
  ds_read_b128 v[100:103], v36 offset:2048
  v_mfma_f32_16x16x32_bf16 v[152:155], v[68:71], a[8:11], 0
  v_mfma_f32_16x16x32_bf16 v[160:163], v[72:75], a[0:3], 0
  ds_read_b128 v[104:107], v36 offset:4096
  v_mfma_f32_16x16x32_bf16 v[164:167], v[72:75], a[4:7], 0
  v_mfma_f32_16x16x32_bf16 v[168:171], v[72:75], a[8:11], 0
  ds_read_b128 v[108:111], v36 offset:6144
  v_mfma_f32_16x16x32_bf16 v[176:179], v[76:79], a[0:3], 0
  v_mfma_f32_16x16x32_bf16 v[180:183], v[76:79], a[4:7], 0
  v_mfma_f32_16x16x32_bf16 v[184:187], v[76:79], a[8:11], 0
  s_waitcnt vmcnt(8) lgkmcnt(0)
  s_barrier
  v_mfma_f32_16x16x32_bf16 v[128:131], v[96:99], a[16:19], v[128:131]
  s_add_u32 m0, s46, 8192
  s_add_u32 s51, s5, 0
  ds_read_b128 v[64:67], v35 offset:16384
  ds_read_b128 a[32:35], v43 offset:32768
  v_mfma_f32_16x16x32_bf16 v[132:135], v[96:99], a[20:23], v[132:135]
  buffer_load_dwordx4 v18, s[20:23], s51 offen lds
  v_mfma_f32_16x16x32_bf16 v[136:139], v[96:99], a[24:27], v[136:139]
  ds_read_b128 a[36:39], v43 offset:33792
  ds_read_b128 a[40:43], v43 offset:34816
  v_mfma_f32_16x16x32_bf16 v[144:147], v[100:103], a[16:19], v[144:147]
  buffer_load_dwordx4 v19, s[20:23], s51 offen offset:1024 lds
  v_mfma_f32_16x16x32_bf16 v[148:151], v[100:103], a[20:23], v[148:151]
  s_add_u32 m0, s46, 10240
  ds_read_b128 v[68:71], v35 offset:18432
  v_mfma_f32_16x16x32_bf16 v[152:155], v[100:103], a[24:27], v[152:155]
  buffer_load_dwordx4 v20, s[20:23], s51 offen lds
  v_mfma_f32_16x16x32_bf16 v[160:163], v[104:107], a[16:19], v[160:163]
  ds_read_b128 v[72:75], v35 offset:20480
  v_mfma_f32_16x16x32_bf16 v[164:167], v[104:107], a[20:23], v[164:167]
  buffer_load_dwordx4 v21, s[20:23], s51 offen offset:1024 lds
  v_mfma_f32_16x16x32_bf16 v[168:171], v[104:107], a[24:27], v[168:171]
  s_add_u32 m0, s46, 12288
  s_add_u32 s51, s5, 16384
  ds_read_b128 v[76:79], v35 offset:22528
  v_mfma_f32_16x16x32_bf16 v[176:179], v[108:111], a[16:19], v[176:179]
  buffer_load_dwordx4 v18, s[20:23], s51 offen lds
  v_mfma_f32_16x16x32_bf16 v[180:183], v[108:111], a[20:23], v[180:183]
  v_mfma_f32_16x16x32_bf16 v[184:187], v[108:111], a[24:27], v[184:187]
  buffer_load_dwordx4 v19, s[20:23], s51 offen offset:1024 lds
  s_waitcnt lgkmcnt(0)
  v_mfma_f32_16x16x32_bf16 v[128:131], v[64:67], a[32:35], v[128:131]
  s_add_u32 m0, s46, 0
  ds_read_b128 v[96:99], v36 offset:16384
  ds_read_b128 a[48:51], v43 offset:36864
  v_mfma_f32_16x16x32_bf16 v[132:135], v[64:67], a[36:39], v[132:135]
  buffer_load_dwordx4 v20, s[20:23], s51 offen lds
  v_mfma_f32_16x16x32_bf16 v[136:139], v[64:67], a[40:43], v[136:139]
  ds_read_b128 a[52:55], v43 offset:37888
  ds_read_b128 a[56:59], v43 offset:38912
  v_mfma_f32_16x16x32_bf16 v[144:147], v[68:71], a[32:35], v[144:147]
  buffer_load_dwordx4 v21, s[20:23], s51 offen offset:1024 lds
  v_mfma_f32_16x16x32_bf16 v[148:151], v[68:71], a[36:39], v[148:151]
  s_add_u32 m0, s46, 2048
  s_add_u32 s51, s7, 0
  ds_read_b128 v[100:103], v36 offset:18432
  v_mfma_f32_16x16x32_bf16 v[152:155], v[68:71], a[40:43], v[152:155]
  buffer_load_dwordx4 v18, s[20:23], s51 offen lds
  v_mfma_f32_16x16x32_bf16 v[160:163], v[72:75], a[32:35], v[160:163]
  ds_read_b128 v[104:107], v36 offset:20480
  v_mfma_f32_16x16x32_bf16 v[164:167], v[72:75], a[36:39], v[164:167]
  buffer_load_dwordx4 v19, s[20:23], s51 offen offset:1024 lds
  v_mfma_f32_16x16x32_bf16 v[168:171], v[72:75], a[40:43], v[168:171]
  ds_read_b128 v[108:111], v36 offset:22528
  v_mfma_f32_16x16x32_bf16 v[176:179], v[76:79], a[32:35], v[176:179]
  v_mfma_f32_16x16x32_bf16 v[180:183], v[76:79], a[36:39], v[180:183]
  s_add_u32 m0, s46, 4096
  v_mfma_f32_16x16x32_bf16 v[184:187], v[76:79], a[40:43], v[184:187]
  buffer_load_dwordx4 v20, s[20:23], s51 offen lds
  s_waitcnt vmcnt(3) lgkmcnt(0)
  v_mfma_f32_16x16x32_bf16 v[128:131], v[96:99], a[48:51], v[128:131]
  ds_read_b128 v[64:67], v35 offset:8192
  ds_read_b128 a[64:67], v42 offset:32768
  v_mfma_f32_16x16x32_bf16 v[132:135], v[96:99], a[52:55], v[132:135]
  buffer_load_dwordx4 v21, s[20:23], s51 offen offset:1024 lds
  v_mfma_f32_16x16x32_bf16 v[136:139], v[96:99], a[56:59], v[136:139]
  s_add_u32 m0, s46, 6144
  s_add_u32 s51, s7, 16384
  ds_read_b128 a[68:71], v42 offset:33792
  ds_read_b128 a[72:75], v42 offset:34816
  v_mfma_f32_16x16x32_bf16 v[144:147], v[100:103], a[48:51], v[144:147]
  buffer_load_dwordx4 v18, s[20:23], s51 offen lds
  v_mfma_f32_16x16x32_bf16 v[148:151], v[100:103], a[52:55], v[148:151]
  ds_read_b128 v[68:71], v35 offset:10240
  v_mfma_f32_16x16x32_bf16 v[152:155], v[100:103], a[56:59], v[152:155]
  buffer_load_dwordx4 v19, s[20:23], s51 offen offset:1024 lds
  v_mfma_f32_16x16x32_bf16 v[160:163], v[104:107], a[48:51], v[160:163]
  s_add_u32 m0, s46, 16384
  ds_read_b128 v[72:75], v35 offset:12288
  v_mfma_f32_16x16x32_bf16 v[164:167], v[104:107], a[52:55], v[164:167]
  buffer_load_dwordx4 v20, s[20:23], s51 offen lds
  v_mfma_f32_16x16x32_bf16 v[168:171], v[104:107], a[56:59], v[168:171]
  ds_read_b128 v[76:79], v35 offset:0
  v_mfma_f32_16x16x32_bf16 v[176:179], v[108:111], a[48:51], v[176:179]
  buffer_load_dwordx4 v21, s[20:23], s51 offen offset:1024 lds
  v_mfma_f32_16x16x32_bf16 v[180:183], v[108:111], a[52:55], v[180:183]
  s_add_u32 m0, s46, 18432
  s_add_u32 s51, s6, 32768
  v_mfma_f32_16x16x32_bf16 v[184:187], v[108:111], a[56:59], v[184:187]
  buffer_load_dwordx4 v18, s[20:23], s51 offen lds
  s_waitcnt lgkmcnt(0)
  v_mfma_f32_16x16x32_bf16 v[128:131], v[64:67], a[64:67], v[128:131]
  ds_read_b128 v[96:99], v36 offset:8192
  ds_read_b128 a[80:83], v42 offset:36864
  v_mfma_f32_16x16x32_bf16 v[132:135], v[64:67], a[68:71], v[132:135]
  buffer_load_dwordx4 v19, s[20:23], s51 offen offset:1024 lds
  v_mfma_f32_16x16x32_bf16 v[136:139], v[64:67], a[72:75], v[136:139]
  s_add_u32 m0, s46, 20480
  ds_read_b128 a[84:87], v42 offset:37888
  ds_read_b128 a[88:91], v42 offset:38912
  v_mfma_f32_16x16x32_bf16 v[144:147], v[68:71], a[64:67], v[144:147]
  buffer_load_dwordx4 v20, s[20:23], s51 offen lds
  v_mfma_f32_16x16x32_bf16 v[148:151], v[68:71], a[68:71], v[148:151]
  ds_read_b128 v[100:103], v36 offset:10240
  v_mfma_f32_16x16x32_bf16 v[152:155], v[68:71], a[72:75], v[152:155]
  buffer_load_dwordx4 v21, s[20:23], s51 offen offset:1024 lds
  v_mfma_f32_16x16x32_bf16 v[160:163], v[72:75], a[64:67], v[160:163]
  s_add_u32 m0, s46, 22528
  s_add_u32 s51, s6, 49152
  ds_read_b128 v[104:107], v36 offset:12288
  v_mfma_f32_16x16x32_bf16 v[164:167], v[72:75], a[68:71], v[164:167]
  buffer_load_dwordx4 v18, s[20:23], s51 offen lds
  v_mfma_f32_16x16x32_bf16 v[168:171], v[72:75], a[72:75], v[168:171]
  ds_read_b128 v[108:111], v36 offset:0
  v_mfma_f32_16x16x32_bf16 v[176:179], v[76:79], a[64:67], v[176:179]
  buffer_load_dwordx4 v19, s[20:23], s51 offen offset:1024 lds
  v_mfma_f32_16x16x32_bf16 v[180:183], v[76:79], a[68:71], v[180:183]
  v_mfma_f32_16x16x32_bf16 v[184:187], v[76:79], a[72:75], v[184:187]
  s_waitcnt vmcnt(6) lgkmcnt(0)
  v_mfma_f32_16x16x32_bf16 v[128:131], v[96:99], a[80:83], v[128:131]
  s_add_u32 m0, s46, 8192
  ds_read_b128 v[64:67], v35 offset:2048
  ds_read_b128 a[96:99], v44 offset:32768
  v_mfma_f32_16x16x32_bf16 v[132:135], v[96:99], a[84:87], v[132:135]
  buffer_load_dwordx4 v20, s[20:23], s51 offen lds
  v_mfma_f32_16x16x32_bf16 v[136:139], v[96:99], a[88:91], v[136:139]
  ds_read_b128 a[100:103], v44 offset:33792
  ds_read_b128 a[104:107], v44 offset:34816
  v_mfma_f32_16x16x32_bf16 v[144:147], v[100:103], a[80:83], v[144:147]
  buffer_load_dwordx4 v21, s[20:23], s51 offen offset:1024 lds
  v_mfma_f32_16x16x32_bf16 v[148:151], v[100:103], a[84:87], v[148:151]
  ds_read_b128 v[68:71], v35 offset:4096
  v_mfma_f32_16x16x32_bf16 v[152:155], v[100:103], a[88:91], v[152:155]
  v_mfma_f32_16x16x32_bf16 v[160:163], v[104:107], a[80:83], v[160:163]
  ds_read_b128 v[72:75], v35 offset:6144
  v_mfma_f32_16x16x32_bf16 v[164:167], v[104:107], a[84:87], v[164:167]
  v_mfma_f32_16x16x32_bf16 v[168:171], v[104:107], a[88:91], v[168:171]
  ds_read_b128 v[76:79], v35 offset:16384
  v_mfma_f32_16x16x32_bf16 v[176:179], v[108:111], a[80:83], v[176:179]
  v_mfma_f32_16x16x32_bf16 v[180:183], v[108:111], a[84:87], v[180:183]
  v_mfma_f32_16x16x32_bf16 v[184:187], v[108:111], a[88:91], v[184:187]
  s_waitcnt lgkmcnt(0)
  v_mfma_f32_16x16x32_bf16 v[128:131], v[64:67], a[96:99], v[128:131]
  ds_read_b128 v[96:99], v36 offset:2048
  ds_read_b128 a[112:115], v44 offset:36864
  v_mfma_f32_16x16x32_bf16 v[132:135], v[64:67], a[100:103], v[132:135]
  v_mfma_f32_16x16x32_bf16 v[136:139], v[64:67], a[104:107], v[136:139]
  ds_read_b128 a[116:119], v44 offset:37888
  ds_read_b128 a[120:123], v44 offset:38912
  v_mfma_f32_16x16x32_bf16 v[144:147], v[68:71], a[96:99], v[144:147]
  v_mfma_f32_16x16x32_bf16 v[148:151], v[68:71], a[100:103], v[148:151]
  ds_read_b128 v[100:103], v36 offset:4096
  v_mfma_f32_16x16x32_bf16 v[152:155], v[68:71], a[104:107], v[152:155]
  v_mfma_f32_16x16x32_bf16 v[160:163], v[72:75], a[96:99], v[160:163]
  ds_read_b128 v[104:107], v36 offset:6144
  v_mfma_f32_16x16x32_bf16 v[164:167], v[72:75], a[100:103], v[164:167]
  v_mfma_f32_16x16x32_bf16 v[168:171], v[72:75], a[104:107], v[168:171]
  ds_read_b128 v[108:111], v36 offset:16384
  v_mfma_f32_16x16x32_bf16 v[176:179], v[76:79], a[96:99], v[176:179]
  v_mfma_f32_16x16x32_bf16 v[180:183], v[76:79], a[100:103], v[180:183]
  v_mfma_f32_16x16x32_bf16 v[184:187], v[76:79], a[104:107], v[184:187]
  s_waitcnt lgkmcnt(0)
  s_barrier
  v_mfma_f32_16x16x32_bf16 v[128:131], v[96:99], a[112:115], v[128:131]
  s_add_u32 m0, s46, 32768
  ds_read_b128 v[64:67], v35 offset:24576
  v_mfma_f32_16x16x32_bf16 v[132:135], v[96:99], a[116:119], v[132:135]
  buffer_load_dwordx4 v14, s[24:27], s57 offen lds
  v_mfma_f32_16x16x32_bf16 v[136:139], v[96:99], a[120:123], v[136:139]
  ds_read_b128 v[68:71], v35 offset:26624
  v_mfma_f32_16x16x32_bf16 v[144:147], v[100:103], a[112:115], v[144:147]
  buffer_load_dwordx4 v15, s[24:27], s57 offen offset:1024 lds
  v_mfma_f32_16x16x32_bf16 v[148:151], v[100:103], a[116:119], v[148:151]
  s_add_u32 m0, s46, 34816
  ds_read_b128 v[72:75], v35 offset:28672
  v_mfma_f32_16x16x32_bf16 v[152:155], v[100:103], a[120:123], v[152:155]
  buffer_load_dwordx4 v16, s[24:27], s57 offen lds
  v_mfma_f32_16x16x32_bf16 v[160:163], v[104:107], a[112:115], v[160:163]
  ds_read_b128 v[76:79], v35 offset:14336
  v_mfma_f32_16x16x32_bf16 v[164:167], v[104:107], a[116:119], v[164:167]
  buffer_load_dwordx4 v17, s[24:27], s57 offen offset:1024 lds
  v_mfma_f32_16x16x32_bf16 v[168:171], v[104:107], a[120:123], v[168:171]
  s_add_u32 m0, s46, 36864
  s_add_u32 s57, s57, 16384
  v_mfma_f32_16x16x32_bf16 v[176:179], v[108:111], a[112:115], v[176:179]
  buffer_load_dwordx4 v14, s[24:27], s57 offen lds
  v_mfma_f32_16x16x32_bf16 v[180:183], v[108:111], a[116:119], v[180:183]
  v_mfma_f32_16x16x32_bf16 v[184:187], v[108:111], a[120:123], v[184:187]
  buffer_load_dwordx4 v15, s[24:27], s57 offen offset:1024 lds
  s_waitcnt lgkmcnt(0)
  v_mfma_f32_16x16x32_bf16 v[192:195], v[64:67], a[0:3], 0
  s_add_u32 m0, s46, 38912
  ds_read_b128 v[96:99], v36 offset:24576
  v_mfma_f32_16x16x32_bf16 v[196:199], v[64:67], a[4:7], 0
  buffer_load_dwordx4 v16, s[24:27], s57 offen lds
  v_mfma_f32_16x16x32_bf16 v[200:203], v[64:67], a[8:11], 0
  ds_read_b128 v[100:103], v36 offset:26624
  v_mfma_f32_16x16x32_bf16 v[208:211], v[68:71], a[0:3], 0
  buffer_load_dwordx4 v17, s[24:27], s57 offen offset:1024 lds
  v_mfma_f32_16x16x32_bf16 v[212:215], v[68:71], a[4:7], 0
  s_add_u32 m0, s46, 10240
  s_add_u32 s51, s5, 32768
  ds_read_b128 v[104:107], v36 offset:28672
  v_mfma_f32_16x16x32_bf16 v[216:219], v[68:71], a[8:11], 0
  buffer_load_dwordx4 v18, s[20:23], s51 offen lds
  v_mfma_f32_16x16x32_bf16 v[224:227], v[72:75], a[0:3], 0
  ds_read_b128 v[108:111], v36 offset:14336
  v_mfma_f32_16x16x32_bf16 v[228:231], v[72:75], a[4:7], 0
  buffer_load_dwordx4 v19, s[20:23], s51 offen offset:1024 lds
  v_mfma_f32_16x16x32_bf16 v[232:235], v[72:75], a[8:11], 0
  v_mfma_f32_16x16x32_bf16 v[240:243], v[76:79], a[0:3], 0
  v_mfma_f32_16x16x32_bf16 v[244:247], v[76:79], a[4:7], 0
  s_add_u32 m0, s46, 12288
  v_mfma_f32_16x16x32_bf16 v[248:251], v[76:79], a[8:11], 0
  buffer_load_dwordx4 v20, s[20:23], s51 offen lds
  s_waitcnt vmcnt(11) lgkmcnt(0)
  v_mfma_f32_16x16x32_bf16 v[192:195], v[96:99], a[16:19], v[192:195]
  ds_read_b128 v[64:67], v35 offset:18432
  v_mfma_f32_16x16x32_bf16 v[196:199], v[96:99], a[20:23], v[196:199]
  buffer_load_dwordx4 v21, s[20:23], s51 offen offset:1024 lds
  v_mfma_f32_16x16x32_bf16 v[200:203], v[96:99], a[24:27], v[200:203]
  s_add_u32 m0, s46, 0
  s_add_u32 s51, s5, 49152
  ds_read_b128 v[68:71], v35 offset:20480
  v_mfma_f32_16x16x32_bf16 v[208:211], v[100:103], a[16:19], v[208:211]
  buffer_load_dwordx4 v18, s[20:23], s51 offen lds
  v_mfma_f32_16x16x32_bf16 v[212:215], v[100:103], a[20:23], v[212:215]
  ds_read_b128 v[72:75], v35 offset:22528
  v_mfma_f32_16x16x32_bf16 v[216:219], v[100:103], a[24:27], v[216:219]
  buffer_load_dwordx4 v19, s[20:23], s51 offen offset:1024 lds
  v_mfma_f32_16x16x32_bf16 v[224:227], v[104:107], a[16:19], v[224:227]
  s_add_u32 m0, s46, 2048
  ds_read_b128 v[76:79], v35 offset:8192
  v_mfma_f32_16x16x32_bf16 v[228:231], v[104:107], a[20:23], v[228:231]
  buffer_load_dwordx4 v20, s[20:23], s51 offen lds
  v_mfma_f32_16x16x32_bf16 v[232:235], v[104:107], a[24:27], v[232:235]
  v_max_f32 v56, v128, v129
  v_max_f32 v57, v132, v133
  v_mfma_f32_16x16x32_bf16 v[240:243], v[108:111], a[16:19], v[240:243]
  buffer_load_dwordx4 v21, s[20:23], s51 offen offset:1024 lds
  v_mfma_f32_16x16x32_bf16 v[244:247], v[108:111], a[20:23], v[244:247]
  s_add_u32 m0, s46, 4096
  s_add_u32 s51, s7, 32768
  v_max_f32 v58, v136, v137
  v_max3_f32 v56, v130, v131, v56
  v_mfma_f32_16x16x32_bf16 v[248:251], v[108:111], a[24:27], v[248:251]
  buffer_load_dwordx4 v18, s[20:23], s51 offen lds
  s_waitcnt lgkmcnt(0)
  v_mfma_f32_16x16x32_bf16 v[192:195], v[64:67], a[32:35], v[192:195]
  ds_read_b128 v[96:99], v36 offset:18432
  v_mfma_f32_16x16x32_bf16 v[196:199], v[64:67], a[36:39], v[196:199]
  buffer_load_dwordx4 v19, s[20:23], s51 offen offset:1024 lds
  v_mfma_f32_16x16x32_bf16 v[200:203], v[64:67], a[40:43], v[200:203]
  s_add_u32 m0, s46, 6144
  ds_read_b128 v[100:103], v36 offset:20480
  v_mfma_f32_16x16x32_bf16 v[208:211], v[68:71], a[32:35], v[208:211]
  buffer_load_dwordx4 v20, s[20:23], s51 offen lds
  v_mfma_f32_16x16x32_bf16 v[212:215], v[68:71], a[36:39], v[212:215]
  ds_read_b128 v[104:107], v36 offset:22528
  v_mfma_f32_16x16x32_bf16 v[216:219], v[68:71], a[40:43], v[216:219]
  v_mfma_f32_16x16x32_bf16 v[224:227], v[72:75], a[32:35], v[224:227]
  ds_read_b128 v[108:111], v36 offset:8192
  v_mfma_f32_16x16x32_bf16 v[228:231], v[72:75], a[36:39], v[228:231]
  buffer_load_dwordx4 v21, s[20:23], s51 offen offset:1024 lds
  v_mfma_f32_16x16x32_bf16 v[232:235], v[72:75], a[40:43], v[232:235]
  v_max3_f32 v57, v134, v135, v57
  v_max3_f32 v58, v138, v139, v58
  v_mfma_f32_16x16x32_bf16 v[240:243], v[76:79], a[32:35], v[240:243]
  v_mfma_f32_16x16x32_bf16 v[244:247], v[76:79], a[36:39], v[244:247]
  s_add_u32 m0, s46, 16384
  s_add_u32 s51, s7, 49152
  v_max3_f32 v56, v144, v145, v56
  v_max3_f32 v57, v148, v149, v57
  v_mfma_f32_16x16x32_bf16 v[248:251], v[76:79], a[40:43], v[248:251]
  buffer_load_dwordx4 v18, s[20:23], s51 offen lds
  s_waitcnt vmcnt(5) lgkmcnt(0)
  v_mfma_f32_16x16x32_bf16 v[192:195], v[96:99], a[48:51], v[192:195]
  ds_read_b128 v[64:67], v35 offset:10240
  v_mfma_f32_16x16x32_bf16 v[196:199], v[96:99], a[52:55], v[196:199]
  buffer_load_dwordx4 v19, s[20:23], s51 offen offset:1024 lds
  v_mfma_f32_16x16x32_bf16 v[200:203], v[96:99], a[56:59], v[200:203]
  s_add_u32 m0, s46, 24576
  ds_read_b128 v[68:71], v35 offset:12288
  v_mfma_f32_16x16x32_bf16 v[208:211], v[100:103], a[48:51], v[208:211]
  buffer_load_dwordx4 v20, s[20:23], s51 offen lds
  v_mfma_f32_16x16x32_bf16 v[212:215], v[100:103], a[52:55], v[212:215]
  ds_read_b128 v[72:75], v35 offset:0
  v_mfma_f32_16x16x32_bf16 v[216:219], v[100:103], a[56:59], v[216:219]
  buffer_load_dwordx4 v21, s[20:23], s51 offen offset:1024 lds
  v_mfma_f32_16x16x32_bf16 v[224:227], v[104:107], a[48:51], v[224:227]
  s_add_u32 m0, s46, 26624
  s_add_u32 s57, s57, 16384
  ds_read_b128 v[76:79], v35 offset:2048
  v_mfma_f32_16x16x32_bf16 v[228:231], v[104:107], a[52:55], v[228:231]
  buffer_load_dwordx4 v14, s[24:27], s57 offen lds
  v_mfma_f32_16x16x32_bf16 v[232:235], v[104:107], a[56:59], v[232:235]
  v_max3_f32 v58, v152, v153, v58
  v_max3_f32 v56, v146, v147, v56
  v_mfma_f32_16x16x32_bf16 v[240:243], v[108:111], a[48:51], v[240:243]
  buffer_load_dwordx4 v15, s[24:27], s57 offen offset:1024 lds
  v_mfma_f32_16x16x32_bf16 v[244:247], v[108:111], a[52:55], v[244:247]
  s_add_u32 m0, s46, 28672
  v_max3_f32 v57, v150, v151, v57
  v_max3_f32 v58, v154, v155, v58
  v_mfma_f32_16x16x32_bf16 v[248:251], v[108:111], a[56:59], v[248:251]
  buffer_load_dwordx4 v16, s[24:27], s57 offen lds
  s_waitcnt lgkmcnt(0)
  v_mfma_f32_16x16x32_bf16 v[192:195], v[64:67], a[64:67], v[192:195]
  ds_read_b128 v[96:99], v36 offset:10240
  v_mfma_f32_16x16x32_bf16 v[196:199], v[64:67], a[68:71], v[196:199]
  buffer_load_dwordx4 v17, s[24:27], s57 offen offset:1024 lds
  v_mfma_f32_16x16x32_bf16 v[200:203], v[64:67], a[72:75], v[200:203]
  s_add_u32 m0, s46, 18432
  s_add_u32 s57, s57, 16384
  ds_read_b128 v[100:103], v36 offset:12288
  v_mfma_f32_16x16x32_bf16 v[208:211], v[68:71], a[64:67], v[208:211]
  buffer_load_dwordx4 v14, s[24:27], s57 offen lds
  v_mfma_f32_16x16x32_bf16 v[212:215], v[68:71], a[68:71], v[212:215]
  ds_read_b128 v[104:107], v36 offset:0
  v_mfma_f32_16x16x32_bf16 v[216:219], v[68:71], a[72:75], v[216:219]
  buffer_load_dwordx4 v15, s[24:27], s57 offen offset:1024 lds
  v_mfma_f32_16x16x32_bf16 v[224:227], v[72:75], a[64:67], v[224:227]
  s_add_u32 m0, s46, 20480
  ds_read_b128 v[108:111], v36 offset:2048
  v_mfma_f32_16x16x32_bf16 v[228:231], v[72:75], a[68:71], v[228:231]
  buffer_load_dwordx4 v16, s[24:27], s57 offen lds
  v_mfma_f32_16x16x32_bf16 v[232:235], v[72:75], a[72:75], v[232:235]
  v_max3_f32 v56, v160, v161, v56
  v_max3_f32 v57, v164, v165, v57
  v_mfma_f32_16x16x32_bf16 v[240:243], v[76:79], a[64:67], v[240:243]
  buffer_load_dwordx4 v17, s[24:27], s57 offen offset:1024 lds
  v_mfma_f32_16x16x32_bf16 v[244:247], v[76:79], a[68:71], v[244:247]
  v_max3_f32 v58, v168, v169, v58
  v_max3_f32 v56, v162, v163, v56
  v_mfma_f32_16x16x32_bf16 v[248:251], v[76:79], a[72:75], v[248:251]
  s_waitcnt vmcnt(8) lgkmcnt(0)
  v_mfma_f32_16x16x32_bf16 v[192:195], v[96:99], a[80:83], v[192:195]
  ds_read_b128 v[64:67], v35 offset:4096
  v_mfma_f32_16x16x32_bf16 v[196:199], v[96:99], a[84:87], v[196:199]
  v_mfma_f32_16x16x32_bf16 v[200:203], v[96:99], a[88:91], v[200:203]
  ds_read_b128 v[68:71], v35 offset:6144
  v_mfma_f32_16x16x32_bf16 v[208:211], v[100:103], a[80:83], v[208:211]
  v_mfma_f32_16x16x32_bf16 v[212:215], v[100:103], a[84:87], v[212:215]
  ds_read_b128 v[72:75], v35 offset:16384
  v_mfma_f32_16x16x32_bf16 v[216:219], v[100:103], a[88:91], v[216:219]
  v_mfma_f32_16x16x32_bf16 v[224:227], v[104:107], a[80:83], v[224:227]
  ds_read_b128 v[76:79], v35 offset:24576
  v_mfma_f32_16x16x32_bf16 v[228:231], v[104:107], a[84:87], v[228:231]
  v_mfma_f32_16x16x32_bf16 v[232:235], v[104:107], a[88:91], v[232:235]
  v_max3_f32 v57, v166, v167, v57
  v_max3_f32 v58, v170, v171, v58
  v_mfma_f32_16x16x32_bf16 v[240:243], v[108:111], a[80:83], v[240:243]
  v_mfma_f32_16x16x32_bf16 v[244:247], v[108:111], a[84:87], v[244:247]
  v_max3_f32 v56, v176, v177, v56
  v_max3_f32 v57, v180, v181, v57
  v_mfma_f32_16x16x32_bf16 v[248:251], v[108:111], a[88:91], v[248:251]
  s_waitcnt lgkmcnt(0)
  v_mfma_f32_16x16x32_bf16 v[192:195], v[64:67], a[96:99], v[192:195]
  ds_read_b128 v[96:99], v36 offset:4096
  v_mfma_f32_16x16x32_bf16 v[196:199], v[64:67], a[100:103], v[196:199]
  v_mfma_f32_16x16x32_bf16 v[200:203], v[64:67], a[104:107], v[200:203]
  ds_read_b128 v[100:103], v36 offset:6144
  v_mfma_f32_16x16x32_bf16 v[208:211], v[68:71], a[96:99], v[208:211]
  v_mfma_f32_16x16x32_bf16 v[212:215], v[68:71], a[100:103], v[212:215]
  ds_read_b128 v[104:107], v36 offset:16384
  v_mfma_f32_16x16x32_bf16 v[216:219], v[68:71], a[104:107], v[216:219]
  v_mfma_f32_16x16x32_bf16 v[224:227], v[72:75], a[96:99], v[224:227]
  ds_read_b128 v[108:111], v36 offset:24576
  v_mfma_f32_16x16x32_bf16 v[228:231], v[72:75], a[100:103], v[228:231]
  v_mfma_f32_16x16x32_bf16 v[232:235], v[72:75], a[104:107], v[232:235]
  v_max3_f32 v58, v184, v185, v58
  v_max3_f32 v56, v178, v179, v56
  v_mfma_f32_16x16x32_bf16 v[240:243], v[76:79], a[96:99], v[240:243]
  v_mfma_f32_16x16x32_bf16 v[244:247], v[76:79], a[100:103], v[244:247]
  v_max3_f32 v57, v182, v183, v57
  v_max3_f32 v58, v186, v187, v58
  v_mfma_f32_16x16x32_bf16 v[248:251], v[76:79], a[104:107], v[248:251]
  s_waitcnt lgkmcnt(0)
  v_mfma_f32_16x16x32_bf16 v[192:195], v[96:99], a[112:115], v[192:195]
  v_mfma_f32_16x16x32_bf16 v[196:199], v[96:99], a[116:119], v[196:199]
  v_mfma_f32_16x16x32_bf16 v[200:203], v[96:99], a[120:123], v[200:203]
  v_mfma_f32_16x16x32_bf16 v[208:211], v[100:103], a[112:115], v[208:211]
  v_mfma_f32_16x16x32_bf16 v[212:215], v[100:103], a[116:119], v[212:215]
  v_mfma_f32_16x16x32_bf16 v[216:219], v[100:103], a[120:123], v[216:219]
  v_mfma_f32_16x16x32_bf16 v[224:227], v[104:107], a[112:115], v[224:227]
  v_max3_f32 v56, v192, v193, v56
  v_max3_f32 v57, v196, v197, v57
  v_mfma_f32_16x16x32_bf16 v[228:231], v[104:107], a[116:119], v[228:231]
  v_mfma_f32_16x16x32_bf16 v[232:235], v[104:107], a[120:123], v[232:235]
  v_max3_f32 v58, v200, v201, v58
  v_max3_f32 v56, v194, v195, v56
  v_mfma_f32_16x16x32_bf16 v[240:243], v[108:111], a[112:115], v[240:243]
  v_max3_f32 v57, v198, v199, v57
  v_max3_f32 v58, v202, v203, v58
  v_mfma_f32_16x16x32_bf16 v[244:247], v[108:111], a[116:119], v[244:247]
  s_add_u32 m0, s46, 22528
  s_add_u32 s57, s57, 81920
  s_and_b32 s57, s57, 0x3ffff
  v_max3_f32 v56, v208, v209, v56
  v_max3_f32 v57, v212, v213, v57
  v_mfma_f32_16x16x32_bf16 v[248:251], v[108:111], a[120:123], v[248:251]
  v_max3_f32 v58, v216, v217, v58
  v_max3_f32 v56, v210, v211, v56
  v_max3_f32 v57, v214, v215, v57
  v_max3_f32 v58, v218, v219, v58
  v_max3_f32 v56, v224, v225, v56
  v_max3_f32 v57, v228, v229, v57
  v_max3_f32 v58, v232, v233, v58
  v_max3_f32 v56, v226, v227, v56
  v_max3_f32 v57, v230, v231, v57
  v_max3_f32 v58, v234, v235, v58
  v_max3_f32 v56, v240, v241, v56
  v_max3_f32 v57, v244, v245, v57
  v_max3_f32 v58, v248, v249, v58
  v_max3_f32 v56, v242, v243, v56
  v_max3_f32 v57, v246, v247, v57
  v_max3_f32 v58, v250, v251, v58
  v_mov_b32 v59, v58
  s_nop 1
  v_permlane32_swap_b32 v56, v57
  v_permlane32_swap_b32 v58, v59
  s_nop 1
  v_max_f32 v56, v56, v57
  v_max_f32 v58, v58, v59
  s_nop 1
  v_permlane16_swap_b32 v56, v58
  s_nop 1
  v_max_f32 v56, v56, v58
  ds_write_b32 v47, v56 offset:30720
  s_waitcnt lgkmcnt(0)
  s_barrier
  ds_read_b128 v[64:67], v48 offset:30720
  ds_read_b128 v[68:71], v48 offset:30976
  ds_read_b128 v[72:75], v48 offset:31232
  s_waitcnt lgkmcnt(0)
  v_max3_f32 v64, v64, v65, v66
  v_max3_f32 v68, v68, v69, v70
  v_max3_f32 v72, v72, v73, v74
  v_max_f32 v64, v64, v67
  v_max_f32 v68, v68, v71
  v_max_f32 v72, v72, v75
  v_mul_f32 v112, s54, v64
  v_mul_f32 v114, s54, v68
  v_mul_f32 v116, s54, v72
  v_pk_fma_f32 v[128:129], v[128:129], s[54:55], v[112:113] op_sel_hi:[1,1,0] neg_lo:[0,0,1] neg_hi:[0,0,1]
  v_pk_fma_f32 v[130:131], v[130:131], s[54:55], v[112:113] op_sel_hi:[1,1,0] neg_lo:[0,0,1] neg_hi:[0,0,1]
  v_pk_fma_f32 v[144:145], v[144:145], s[54:55], v[112:113] op_sel_hi:[1,1,0] neg_lo:[0,0,1] neg_hi:[0,0,1]
  v_pk_fma_f32 v[146:147], v[146:147], s[54:55], v[112:113] op_sel_hi:[1,1,0] neg_lo:[0,0,1] neg_hi:[0,0,1]
  v_exp_f32 v128, v128
  v_exp_f32 v129, v129
  v_exp_f32 v130, v130
  v_exp_f32 v131, v131
  v_exp_f32 v144, v144
  v_exp_f32 v145, v145
  v_exp_f32 v146, v146
  v_exp_f32 v147, v147
  v_cvt_pk_bf16_f32 v64, v128, v129
  v_cvt_pk_bf16_f32 v65, v130, v131
  v_cvt_pk_bf16_f32 v66, v144, v145
  v_cvt_pk_bf16_f32 v67, v146, v147
  ds_write_b128 v41, v[64:67] offset:0
  v_pk_add_f32 v[128:129], v[128:129], v[130:131]
  v_pk_add_f32 v[144:145], v[144:145], v[146:147]
  v_pk_add_f32 v[120:121], v[128:129], v[144:145]
  v_pk_fma_f32 v[132:133], v[132:133], s[54:55], v[114:115] op_sel_hi:[1,1,0] neg_lo:[0,0,1] neg_hi:[0,0,1]
  v_pk_fma_f32 v[134:135], v[134:135], s[54:55], v[114:115] op_sel_hi:[1,1,0] neg_lo:[0,0,1] neg_hi:[0,0,1]
  v_pk_fma_f32 v[148:149], v[148:149], s[54:55], v[114:115] op_sel_hi:[1,1,0] neg_lo:[0,0,1] neg_hi:[0,0,1]
  v_pk_fma_f32 v[150:151], v[150:151], s[54:55], v[114:115] op_sel_hi:[1,1,0] neg_lo:[0,0,1] neg_hi:[0,0,1]
  v_exp_f32 v132, v132
  v_exp_f32 v133, v133
  v_exp_f32 v134, v134
  v_exp_f32 v135, v135
  v_exp_f32 v148, v148
  v_exp_f32 v149, v149
  v_exp_f32 v150, v150
  v_exp_f32 v151, v151
  v_cvt_pk_bf16_f32 v68, v132, v133
  v_cvt_pk_bf16_f32 v69, v134, v135
  v_cvt_pk_bf16_f32 v70, v148, v149
  v_cvt_pk_bf16_f32 v71, v150, v151
  ds_write_b128 v41, v[68:71] offset:1024
  v_pk_add_f32 v[132:133], v[132:133], v[134:135]
  v_pk_add_f32 v[148:149], v[148:149], v[150:151]
  v_pk_add_f32 v[122:123], v[132:133], v[148:149]
  v_pk_fma_f32 v[136:137], v[136:137], s[54:55], v[116:117] op_sel_hi:[1,1,0] neg_lo:[0,0,1] neg_hi:[0,0,1]
  v_pk_fma_f32 v[138:139], v[138:139], s[54:55], v[116:117] op_sel_hi:[1,1,0] neg_lo:[0,0,1] neg_hi:[0,0,1]
  v_pk_fma_f32 v[152:153], v[152:153], s[54:55], v[116:117] op_sel_hi:[1,1,0] neg_lo:[0,0,1] neg_hi:[0,0,1]
  v_pk_fma_f32 v[154:155], v[154:155], s[54:55], v[116:117] op_sel_hi:[1,1,0] neg_lo:[0,0,1] neg_hi:[0,0,1]
  v_exp_f32 v136, v136
  v_exp_f32 v137, v137
  v_exp_f32 v138, v138
  v_exp_f32 v139, v139
  v_exp_f32 v152, v152
  v_exp_f32 v153, v153
  v_exp_f32 v154, v154
  v_exp_f32 v155, v155
  v_cvt_pk_bf16_f32 v72, v136, v137
  v_cvt_pk_bf16_f32 v73, v138, v139
  v_cvt_pk_bf16_f32 v74, v152, v153
  v_cvt_pk_bf16_f32 v75, v154, v155
  ds_write_b128 v41, v[72:75] offset:2048
  v_pk_add_f32 v[136:137], v[136:137], v[138:139]
  v_pk_add_f32 v[152:153], v[152:153], v[154:155]
  v_pk_add_f32 v[124:125], v[136:137], v[152:153]
  buffer_load_dwordx4 a[140:143], v29, s[32:35], s13 offen offset:0
  v_pk_fma_f32 v[160:161], v[160:161], s[54:55], v[112:113] op_sel_hi:[1,1,0] neg_lo:[0,0,1] neg_hi:[0,0,1]
  v_pk_fma_f32 v[162:163], v[162:163], s[54:55], v[112:113] op_sel_hi:[1,1,0] neg_lo:[0,0,1] neg_hi:[0,0,1]
  v_pk_fma_f32 v[176:177], v[176:177], s[54:55], v[112:113] op_sel_hi:[1,1,0] neg_lo:[0,0,1] neg_hi:[0,0,1]
  v_pk_fma_f32 v[178:179], v[178:179], s[54:55], v[112:113] op_sel_hi:[1,1,0] neg_lo:[0,0,1] neg_hi:[0,0,1]
  v_exp_f32 v160, v160
  v_exp_f32 v161, v161
  v_exp_f32 v162, v162
  v_exp_f32 v163, v163
  v_exp_f32 v176, v176
  v_exp_f32 v177, v177
  v_exp_f32 v178, v178
  v_exp_f32 v179, v179
  v_cvt_pk_bf16_f32 v76, v160, v161
  v_cvt_pk_bf16_f32 v77, v162, v163
  v_cvt_pk_bf16_f32 v78, v176, v177
  v_cvt_pk_bf16_f32 v79, v178, v179
  ds_write_b128 v41, v[76:79] offset:4096
  v_pk_add_f32 v[160:161], v[160:161], v[162:163]
  v_pk_add_f32 v[176:177], v[176:177], v[178:179]
  v_pk_add_f32 v[160:161], v[160:161], v[176:177]
  v_pk_add_f32 v[120:121], v[120:121], v[160:161]
  buffer_load_dwordx4 a[136:139], v29, s[32:35], s13 offen offset:1024
  v_pk_fma_f32 v[164:165], v[164:165], s[54:55], v[114:115] op_sel_hi:[1,1,0] neg_lo:[0,0,1] neg_hi:[0,0,1]
  v_pk_fma_f32 v[166:167], v[166:167], s[54:55], v[114:115] op_sel_hi:[1,1,0] neg_lo:[0,0,1] neg_hi:[0,0,1]
  v_pk_fma_f32 v[180:181], v[180:181], s[54:55], v[114:115] op_sel_hi:[1,1,0] neg_lo:[0,0,1] neg_hi:[0,0,1]
  v_pk_fma_f32 v[182:183], v[182:183], s[54:55], v[114:115] op_sel_hi:[1,1,0] neg_lo:[0,0,1] neg_hi:[0,0,1]
  v_exp_f32 v164, v164
  v_exp_f32 v165, v165
  v_exp_f32 v166, v166
  v_exp_f32 v167, v167
  v_exp_f32 v180, v180
  v_exp_f32 v181, v181
  v_exp_f32 v182, v182
  v_exp_f32 v183, v183
  v_cvt_pk_bf16_f32 v80, v164, v165
  v_cvt_pk_bf16_f32 v81, v166, v167
  v_cvt_pk_bf16_f32 v82, v180, v181
  v_cvt_pk_bf16_f32 v83, v182, v183
  ds_write_b128 v41, v[80:83] offset:5120
  v_pk_add_f32 v[164:165], v[164:165], v[166:167]
  v_pk_add_f32 v[180:181], v[180:181], v[182:183]
  v_pk_add_f32 v[164:165], v[164:165], v[180:181]
  v_pk_add_f32 v[122:123], v[122:123], v[164:165]
  buffer_load_dwordx4 a[132:135], v29, s[32:35], s13 offen offset:2048
  v_pk_fma_f32 v[168:169], v[168:169], s[54:55], v[116:117] op_sel_hi:[1,1,0] neg_lo:[0,0,1] neg_hi:[0,0,1]
  v_pk_fma_f32 v[170:171], v[170:171], s[54:55], v[116:117] op_sel_hi:[1,1,0] neg_lo:[0,0,1] neg_hi:[0,0,1]
  v_pk_fma_f32 v[184:185], v[184:185], s[54:55], v[116:117] op_sel_hi:[1,1,0] neg_lo:[0,0,1] neg_hi:[0,0,1]
  v_pk_fma_f32 v[186:187], v[186:187], s[54:55], v[116:117] op_sel_hi:[1,1,0] neg_lo:[0,0,1] neg_hi:[0,0,1]
  v_exp_f32 v168, v168
  v_exp_f32 v169, v169
  v_exp_f32 v170, v170
  v_exp_f32 v171, v171
  v_exp_f32 v184, v184
  v_exp_f32 v185, v185
  v_exp_f32 v186, v186
  v_exp_f32 v187, v187
  v_cvt_pk_bf16_f32 v84, v168, v169
  v_cvt_pk_bf16_f32 v85, v170, v171
  v_cvt_pk_bf16_f32 v86, v184, v185
  v_cvt_pk_bf16_f32 v87, v186, v187
  ds_write_b128 v41, v[84:87] offset:6144
  v_pk_add_f32 v[168:169], v[168:169], v[170:171]
  v_pk_add_f32 v[184:185], v[184:185], v[186:187]
  v_pk_add_f32 v[168:169], v[168:169], v[184:185]
  v_pk_add_f32 v[124:125], v[124:125], v[168:169]
  buffer_load_dwordx4 a[128:131], v29, s[32:35], s13 offen offset:2560
  v_pk_fma_f32 v[192:193], v[192:193], s[54:55], v[112:113] op_sel_hi:[1,1,0] neg_lo:[0,0,1] neg_hi:[0,0,1]
  v_pk_fma_f32 v[194:195], v[194:195], s[54:55], v[112:113] op_sel_hi:[1,1,0] neg_lo:[0,0,1] neg_hi:[0,0,1]
  v_pk_fma_f32 v[208:209], v[208:209], s[54:55], v[112:113] op_sel_hi:[1,1,0] neg_lo:[0,0,1] neg_hi:[0,0,1]
  v_pk_fma_f32 v[210:211], v[210:211], s[54:55], v[112:113] op_sel_hi:[1,1,0] neg_lo:[0,0,1] neg_hi:[0,0,1]
  v_exp_f32 v192, v192
  v_exp_f32 v193, v193
  v_exp_f32 v194, v194
  v_exp_f32 v195, v195
  v_exp_f32 v208, v208
  v_exp_f32 v209, v209
  v_exp_f32 v210, v210
  v_exp_f32 v211, v211
  v_cvt_pk_bf16_f32 v88, v192, v193
  v_cvt_pk_bf16_f32 v89, v194, v195
  v_cvt_pk_bf16_f32 v90, v208, v209
  v_cvt_pk_bf16_f32 v91, v210, v211
  ds_write_b128 v41, v[88:91] offset:8192
  v_pk_add_f32 v[192:193], v[192:193], v[194:195]
  v_pk_add_f32 v[208:209], v[208:209], v[210:211]
  v_pk_add_f32 v[192:193], v[192:193], v[208:209]
  v_pk_add_f32 v[120:121], v[120:121], v[192:193]
  buffer_load_dwordx4 v14, s[24:27], s57 offen lds
  v_pk_fma_f32 v[196:197], v[196:197], s[54:55], v[114:115] op_sel_hi:[1,1,0] neg_lo:[0,0,1] neg_hi:[0,0,1]
  v_pk_fma_f32 v[198:199], v[198:199], s[54:55], v[114:115] op_sel_hi:[1,1,0] neg_lo:[0,0,1] neg_hi:[0,0,1]
  v_pk_fma_f32 v[212:213], v[212:213], s[54:55], v[114:115] op_sel_hi:[1,1,0] neg_lo:[0,0,1] neg_hi:[0,0,1]
  v_pk_fma_f32 v[214:215], v[214:215], s[54:55], v[114:115] op_sel_hi:[1,1,0] neg_lo:[0,0,1] neg_hi:[0,0,1]
  v_exp_f32 v196, v196
  v_exp_f32 v197, v197
  v_exp_f32 v198, v198
  v_exp_f32 v199, v199
  v_exp_f32 v212, v212
  v_exp_f32 v213, v213
  v_exp_f32 v214, v214
  v_exp_f32 v215, v215
  v_cvt_pk_bf16_f32 v92, v196, v197
  v_cvt_pk_bf16_f32 v93, v198, v199
  v_cvt_pk_bf16_f32 v94, v212, v213
  v_cvt_pk_bf16_f32 v95, v214, v215
  ds_write_b128 v41, v[92:95] offset:9216
  v_pk_add_f32 v[196:197], v[196:197], v[198:199]
  v_pk_add_f32 v[212:213], v[212:213], v[214:215]
  v_pk_add_f32 v[196:197], v[196:197], v[212:213]
  v_pk_add_f32 v[122:123], v[122:123], v[196:197]
  buffer_load_dwordx4 v15, s[24:27], s57 offen offset:1024 lds
  v_pk_fma_f32 v[200:201], v[200:201], s[54:55], v[116:117] op_sel_hi:[1,1,0] neg_lo:[0,0,1] neg_hi:[0,0,1]
  v_pk_fma_f32 v[202:203], v[202:203], s[54:55], v[116:117] op_sel_hi:[1,1,0] neg_lo:[0,0,1] neg_hi:[0,0,1]
  v_pk_fma_f32 v[216:217], v[216:217], s[54:55], v[116:117] op_sel_hi:[1,1,0] neg_lo:[0,0,1] neg_hi:[0,0,1]
  v_pk_fma_f32 v[218:219], v[218:219], s[54:55], v[116:117] op_sel_hi:[1,1,0] neg_lo:[0,0,1] neg_hi:[0,0,1]
  v_exp_f32 v200, v200
  v_exp_f32 v201, v201
  v_exp_f32 v202, v202
  v_exp_f32 v203, v203
  v_exp_f32 v216, v216
  v_exp_f32 v217, v217
  v_exp_f32 v218, v218
  v_exp_f32 v219, v219
  v_cvt_pk_bf16_f32 v64, v200, v201
  v_cvt_pk_bf16_f32 v65, v202, v203
  v_cvt_pk_bf16_f32 v66, v216, v217
  v_cvt_pk_bf16_f32 v67, v218, v219
  ds_write_b128 v41, v[64:67] offset:10240
  v_pk_add_f32 v[200:201], v[200:201], v[202:203]
  v_pk_add_f32 v[216:217], v[216:217], v[218:219]
  v_pk_add_f32 v[200:201], v[200:201], v[216:217]
  v_pk_add_f32 v[124:125], v[124:125], v[200:201]
  s_add_u32 m0, s46, 16384
  s_nop 0
  buffer_load_dwordx4 v16, s[24:27], s57 offen lds
  v_pk_fma_f32 v[224:225], v[224:225], s[54:55], v[112:113] op_sel_hi:[1,1,0] neg_lo:[0,0,1] neg_hi:[0,0,1]
  v_pk_fma_f32 v[226:227], v[226:227], s[54:55], v[112:113] op_sel_hi:[1,1,0] neg_lo:[0,0,1] neg_hi:[0,0,1]
  v_pk_fma_f32 v[240:241], v[240:241], s[54:55], v[112:113] op_sel_hi:[1,1,0] neg_lo:[0,0,1] neg_hi:[0,0,1]
  v_pk_fma_f32 v[242:243], v[242:243], s[54:55], v[112:113] op_sel_hi:[1,1,0] neg_lo:[0,0,1] neg_hi:[0,0,1]
  v_exp_f32 v224, v224
  v_exp_f32 v225, v225
  v_exp_f32 v226, v226
  v_exp_f32 v227, v227
  v_exp_f32 v240, v240
  v_exp_f32 v241, v241
  v_exp_f32 v242, v242
  v_exp_f32 v243, v243
  v_cvt_pk_bf16_f32 v68, v224, v225
  v_cvt_pk_bf16_f32 v69, v226, v227
  v_cvt_pk_bf16_f32 v70, v240, v241
  v_cvt_pk_bf16_f32 v71, v242, v243
  ds_write_b128 v41, v[68:71] offset:12288
  v_pk_add_f32 v[224:225], v[224:225], v[226:227]
  v_pk_add_f32 v[240:241], v[240:241], v[242:243]
  v_pk_add_f32 v[224:225], v[224:225], v[240:241]
  v_pk_add_f32 v[120:121], v[120:121], v[224:225]
  buffer_load_dwordx4 v17, s[24:27], s57 offen offset:1024 lds
  v_pk_fma_f32 v[228:229], v[228:229], s[54:55], v[114:115] op_sel_hi:[1,1,0] neg_lo:[0,0,1] neg_hi:[0,0,1]
  v_pk_fma_f32 v[230:231], v[230:231], s[54:55], v[114:115] op_sel_hi:[1,1,0] neg_lo:[0,0,1] neg_hi:[0,0,1]
  v_pk_fma_f32 v[244:245], v[244:245], s[54:55], v[114:115] op_sel_hi:[1,1,0] neg_lo:[0,0,1] neg_hi:[0,0,1]
  v_pk_fma_f32 v[246:247], v[246:247], s[54:55], v[114:115] op_sel_hi:[1,1,0] neg_lo:[0,0,1] neg_hi:[0,0,1]
  v_exp_f32 v228, v228
  v_exp_f32 v229, v229
  v_exp_f32 v230, v230
  v_exp_f32 v231, v231
  v_exp_f32 v244, v244
  v_exp_f32 v245, v245
  v_exp_f32 v246, v246
  v_exp_f32 v247, v247
  v_cvt_pk_bf16_f32 v72, v228, v229
  v_cvt_pk_bf16_f32 v73, v230, v231
  v_cvt_pk_bf16_f32 v74, v244, v245
  v_cvt_pk_bf16_f32 v75, v246, v247
  ds_write_b128 v41, v[72:75] offset:13312
  v_pk_add_f32 v[228:229], v[228:229], v[230:231]
  v_pk_add_f32 v[244:245], v[244:245], v[246:247]
  v_pk_add_f32 v[228:229], v[228:229], v[244:245]
  v_pk_add_f32 v[122:123], v[122:123], v[228:229]
  s_add_u32 m0, s46, 24576
  s_add_u32 s57, s57, 16384
  buffer_load_dwordx4 v14, s[24:27], s57 offen lds
  v_pk_fma_f32 v[232:233], v[232:233], s[54:55], v[116:117] op_sel_hi:[1,1,0] neg_lo:[0,0,1] neg_hi:[0,0,1]
  v_pk_fma_f32 v[234:235], v[234:235], s[54:55], v[116:117] op_sel_hi:[1,1,0] neg_lo:[0,0,1] neg_hi:[0,0,1]
  v_pk_fma_f32 v[248:249], v[248:249], s[54:55], v[116:117] op_sel_hi:[1,1,0] neg_lo:[0,0,1] neg_hi:[0,0,1]
  v_pk_fma_f32 v[250:251], v[250:251], s[54:55], v[116:117] op_sel_hi:[1,1,0] neg_lo:[0,0,1] neg_hi:[0,0,1]
  v_exp_f32 v232, v232
  v_exp_f32 v233, v233
  v_exp_f32 v234, v234
  v_exp_f32 v235, v235
  v_exp_f32 v248, v248
  v_exp_f32 v249, v249
  v_exp_f32 v250, v250
  v_exp_f32 v251, v251
  v_cvt_pk_bf16_f32 v76, v232, v233
  v_cvt_pk_bf16_f32 v77, v234, v235
  v_cvt_pk_bf16_f32 v78, v248, v249
  v_cvt_pk_bf16_f32 v79, v250, v251
  ds_write_b128 v41, v[76:79] offset:14336
  v_pk_add_f32 v[232:233], v[232:233], v[234:235]
  v_pk_add_f32 v[248:249], v[248:249], v[250:251]
  v_pk_add_f32 v[232:233], v[232:233], v[248:249]
  v_pk_add_f32 v[124:125], v[124:125], v[232:233]
  buffer_load_dwordx4 v15, s[24:27], s57 offen offset:1024 lds
  buffer_load_dwordx2 v[4:5], v8, s[80:83], 0 offen sc1
  s_waitcnt lgkmcnt(0)
  ds_read_b64_tr_b16 v[64:65], v31 offset:32768
  ds_read_b64_tr_b16 v[66:67], v31 offset:34816
  ds_read_b128 v[80:83], v41 offset:0
  ds_read_b64_tr_b16 v[68:69], v32 offset:32768
  ds_read_b128 v[84:87], v41 offset:1024
  ds_read_b64_tr_b16 v[70:71], v32 offset:34816
  ds_read_b128 v[88:91], v41 offset:2048
  ds_read_b64_tr_b16 v[72:73], v33 offset:32768
  ds_read_b64_tr_b16 v[74:75], v33 offset:34816
  ds_read_b64_tr_b16 v[76:77], v34 offset:32768
  ds_read_b64_tr_b16 v[78:79], v34 offset:34816
  v_add_f32 v60, v120, v121
  v_add_f32 v61, v122, v123
  v_add_f32 v62, v124, v125
  s_nop 1
  v_permlane32_swap_b32 v60, v61
  v_permlane32_swap_b32 v62, v63
  s_nop 1
  v_add_f32 v60, v60, v61
  v_add_f32 v62, v62, v63
  s_nop 1
  v_permlane16_swap_b32 v60, v62
  s_nop 1
  v_add_f32 v60, v60, v62
  ds_write_b32 v47, v60 offset:31744
  s_waitcnt lgkmcnt(1)
  v_mfma_f32_16x16x32_bf16 v[128:131], v[64:67], v[80:83], 0
  s_add_u32 m0, s46, 32768
  ds_read_b64_tr_b16 v[96:97], v31 offset:36864
  ds_read_b64_tr_b16 v[98:99], v31 offset:38912
  ds_read_b128 v[112:115], v41 offset:4096
  v_mfma_f32_16x16x32_bf16 v[132:135], v[64:67], v[84:87], 0
  buffer_load_dwordx4 v16, s[24:27], s57 offen lds
  v_mfma_f32_16x16x32_bf16 v[136:139], v[64:67], v[88:91], 0
  ds_read_b64_tr_b16 v[100:101], v32 offset:36864
  ds_read_b128 v[116:119], v41 offset:5120
  v_mfma_f32_16x16x32_bf16 v[144:147], v[68:71], v[80:83], 0
  buffer_load_dwordx4 v17, s[24:27], s57 offen offset:1024 lds
  v_mfma_f32_16x16x32_bf16 v[148:151], v[68:71], v[84:87], 0
  ds_read_b64_tr_b16 v[102:103], v32 offset:38912
  ds_read_b128 v[120:123], v41 offset:6144
  v_mfma_f32_16x16x32_bf16 v[152:155], v[68:71], v[88:91], 0
  v_mfma_f32_16x16x32_bf16 v[160:163], v[72:75], v[80:83], 0
  s_add_u32 m0, s46, 34816
  s_add_u32 s57, s57, 16384
  ds_read_b64_tr_b16 v[104:105], v33 offset:36864
  ds_read_b64_tr_b16 v[106:107], v33 offset:38912
  v_mfma_f32_16x16x32_bf16 v[164:167], v[72:75], v[84:87], 0
  buffer_load_dwordx4 v14, s[24:27], s57 offen lds
  v_mfma_f32_16x16x32_bf16 v[168:171], v[72:75], v[88:91], 0
  ds_read_b64_tr_b16 v[108:109], v34 offset:36864
  ds_read_b64_tr_b16 v[110:111], v34 offset:38912
  v_mfma_f32_16x16x32_bf16 v[176:179], v[76:79], v[80:83], 0
  v_mfma_f32_16x16x32_bf16 v[180:183], v[76:79], v[84:87], 0
  v_mfma_f32_16x16x32_bf16 v[184:187], v[76:79], v[88:91], 0
  buffer_load_dwordx4 v15, s[24:27], s57 offen offset:1024 lds
  s_waitcnt vmcnt(19) lgkmcnt(0)
  v_mfma_f32_16x16x32_bf16 v[128:131], v[96:99], v[112:115], v[128:131]
  s_add_u32 m0, s46, 36864
  ds_read_b64_tr_b16 v[64:65], v31 offset:26624
  ds_read_b64_tr_b16 v[66:67], v31 offset:28672
  ds_read_b128 v[80:83], v41 offset:8192
  v_mfma_f32_16x16x32_bf16 v[132:135], v[96:99], v[116:119], v[132:135]
  buffer_load_dwordx4 v16, s[24:27], s57 offen lds
  v_mfma_f32_16x16x32_bf16 v[136:139], v[96:99], v[120:123], v[136:139]
  ds_read_b64_tr_b16 v[68:69], v32 offset:26624
  ds_read_b128 v[84:87], v41 offset:9216
  v_mfma_f32_16x16x32_bf16 v[144:147], v[100:103], v[112:115], v[144:147]
  buffer_load_dwordx4 v17, s[24:27], s57 offen offset:1024 lds
  v_mfma_f32_16x16x32_bf16 v[148:151], v[100:103], v[116:119], v[148:151]
  ds_read_b64_tr_b16 v[70:71], v32 offset:28672
  ds_read_b128 v[88:91], v41 offset:10240
  v_mfma_f32_16x16x32_bf16 v[152:155], v[100:103], v[120:123], v[152:155]
  v_mfma_f32_16x16x32_bf16 v[160:163], v[104:107], v[112:115], v[160:163]
  s_add_u32 m0, s46, 38912
  s_add_u32 s57, s57, 16384
  ds_read_b64_tr_b16 v[72:73], v33 offset:26624
  ds_read_b64_tr_b16 v[74:75], v33 offset:28672
  v_mfma_f32_16x16x32_bf16 v[164:167], v[104:107], v[116:119], v[164:167]
  buffer_load_dwordx4 v14, s[24:27], s57 offen lds
  v_mfma_f32_16x16x32_bf16 v[168:171], v[104:107], v[120:123], v[168:171]
  ds_read_b64_tr_b16 v[76:77], v34 offset:26624
  ds_read_b64_tr_b16 v[78:79], v34 offset:28672
  v_mfma_f32_16x16x32_bf16 v[176:179], v[108:111], v[112:115], v[176:179]
  v_mfma_f32_16x16x32_bf16 v[180:183], v[108:111], v[116:119], v[180:183]
  v_mfma_f32_16x16x32_bf16 v[184:187], v[108:111], v[120:123], v[184:187]
  buffer_load_dwordx4 v15, s[24:27], s57 offen offset:1024 lds
  s_waitcnt vmcnt(19) lgkmcnt(0)
  v_mfma_f32_16x16x32_bf16 v[128:131], v[64:67], v[80:83], v[128:131]
  s_add_u32 m0, s46, 26624
  ds_read_b64_tr_b16 v[96:97], v31 offset:18432
  ds_read_b64_tr_b16 v[98:99], v31 offset:20480
  ds_read_b128 v[112:115], v41 offset:12288
  v_mfma_f32_16x16x32_bf16 v[132:135], v[64:67], v[84:87], v[132:135]
  buffer_load_dwordx4 v16, s[24:27], s57 offen lds
  v_mfma_f32_16x16x32_bf16 v[136:139], v[64:67], v[88:91], v[136:139]
  ds_read_b64_tr_b16 v[100:101], v32 offset:18432
  ds_read_b128 v[116:119], v41 offset:13312
  v_mfma_f32_16x16x32_bf16 v[144:147], v[68:71], v[80:83], v[144:147]
  buffer_load_dwordx4 v17, s[24:27], s57 offen offset:1024 lds
  v_mfma_f32_16x16x32_bf16 v[148:151], v[68:71], v[84:87], v[148:151]
  ds_read_b64_tr_b16 v[102:103], v32 offset:20480
  ds_read_b128 v[120:123], v41 offset:14336
  v_mfma_f32_16x16x32_bf16 v[152:155], v[68:71], v[88:91], v[152:155]
  v_mfma_f32_16x16x32_bf16 v[160:163], v[72:75], v[80:83], v[160:163]
  s_add_u32 m0, s46, 28672
  s_add_u32 s57, s57, 147456
  s_and_b32 s57, s57, 0x3ffff
  ds_read_b64_tr_b16 v[104:105], v33 offset:18432
  ds_read_b64_tr_b16 v[106:107], v33 offset:20480
  v_mfma_f32_16x16x32_bf16 v[164:167], v[72:75], v[84:87], v[164:167]
  buffer_load_dwordx4 v14, s[24:27], s57 offen lds
  v_mfma_f32_16x16x32_bf16 v[168:171], v[72:75], v[88:91], v[168:171]
  ds_read_b64_tr_b16 v[108:109], v34 offset:18432
  ds_read_b64_tr_b16 v[110:111], v34 offset:20480
  v_mfma_f32_16x16x32_bf16 v[176:179], v[76:79], v[80:83], v[176:179]
  v_mfma_f32_16x16x32_bf16 v[180:183], v[76:79], v[84:87], v[180:183]
  v_mfma_f32_16x16x32_bf16 v[184:187], v[76:79], v[88:91], v[184:187]
  buffer_load_dwordx4 v15, s[24:27], s57 offen offset:1024 lds
  s_waitcnt vmcnt(15) lgkmcnt(0)
  s_barrier
  v_mfma_f32_16x16x32_bf16 v[128:131], v[96:99], v[112:115], v[128:131]
  s_add_u32 m0, s46, 18432
  ds_read_b64_tr_b16 v[64:65], v31 offset:22528
  ds_read_b64_tr_b16 v[66:67], v31 offset:16384
  ds_read_b128 v[80:83], v43 offset:0
  v_mfma_f32_16x16x32_bf16 v[132:135], v[96:99], v[116:119], v[132:135]
  buffer_load_dwordx4 v16, s[24:27], s57 offen lds
  v_mfma_f32_16x16x32_bf16 v[136:139], v[96:99], v[120:123], v[136:139]
  ds_read_b64_tr_b16 v[68:69], v32 offset:22528
  ds_read_b128 v[84:87], v43 offset:1024
  v_mfma_f32_16x16x32_bf16 v[144:147], v[100:103], v[112:115], v[144:147]
  buffer_load_dwordx4 v17, s[24:27], s57 offen offset:1024 lds
  v_mfma_f32_16x16x32_bf16 v[148:151], v[100:103], v[116:119], v[148:151]
  s_add_u32 m0, s46, 20480
  s_add_u32 s57, s57, 16384
  ds_read_b64_tr_b16 v[70:71], v32 offset:16384
  ds_read_b128 v[88:91], v43 offset:2048
  v_mfma_f32_16x16x32_bf16 v[152:155], v[100:103], v[120:123], v[152:155]
  buffer_load_dwordx4 v14, s[24:27], s57 offen lds
  v_mfma_f32_16x16x32_bf16 v[160:163], v[104:107], v[112:115], v[160:163]
  ds_read_b64_tr_b16 v[72:73], v33 offset:22528
  ds_read_b64_tr_b16 v[74:75], v33 offset:16384
  v_mfma_f32_16x16x32_bf16 v[164:167], v[104:107], v[116:119], v[164:167]
  buffer_load_dwordx4 v15, s[24:27], s57 offen offset:1024 lds
  v_mfma_f32_16x16x32_bf16 v[168:171], v[104:107], v[120:123], v[168:171]
  ds_read_b64_tr_b16 v[76:77], v34 offset:22528
  ds_read_b64_tr_b16 v[78:79], v34 offset:16384
  v_mfma_f32_16x16x32_bf16 v[176:179], v[108:111], v[112:115], v[176:179]
  v_mfma_f32_16x16x32_bf16 v[180:183], v[108:111], v[116:119], v[180:183]
  v_mfma_f32_16x16x32_bf16 v[184:187], v[108:111], v[120:123], v[184:187]
  s_waitcnt vmcnt(14) lgkmcnt(0)
  v_mfma_f32_16x16x32_bf16 v[128:131], v[64:67], v[80:83], v[128:131]
  s_add_u32 m0, s46, 22528
  ds_read_b64_tr_b16 v[96:97], v31 offset:24576
  ds_read_b64_tr_b16 v[98:99], v31 offset:32768
  ds_read_b128 v[112:115], v43 offset:4096
  v_mfma_f32_16x16x32_bf16 v[132:135], v[64:67], v[84:87], v[132:135]
  buffer_load_dwordx4 v16, s[24:27], s57 offen lds
  v_mfma_f32_16x16x32_bf16 v[136:139], v[64:67], v[88:91], v[136:139]
  ds_read_b64_tr_b16 v[100:101], v32 offset:24576
  ds_read_b128 v[116:119], v43 offset:5120
  v_mfma_f32_16x16x32_bf16 v[144:147], v[68:71], v[80:83], v[144:147]
  buffer_load_dwordx4 v17, s[24:27], s57 offen offset:1024 lds
  v_mfma_f32_16x16x32_bf16 v[148:151], v[68:71], v[84:87], v[148:151]
  s_add_u32 m0, s46, 16384
  s_add_u32 s57, s57, 16384
  ds_read_b64_tr_b16 v[102:103], v32 offset:32768
  ds_read_b128 v[120:123], v43 offset:6144
  v_mfma_f32_16x16x32_bf16 v[152:155], v[68:71], v[88:91], v[152:155]
  buffer_load_dwordx4 v14, s[24:27], s57 offen lds
  v_mfma_f32_16x16x32_bf16 v[160:163], v[72:75], v[80:83], v[160:163]
  ds_read_b64_tr_b16 v[104:105], v33 offset:24576
  ds_read_b64_tr_b16 v[106:107], v33 offset:32768
  v_mfma_f32_16x16x32_bf16 v[164:167], v[72:75], v[84:87], v[164:167]
  buffer_load_dwordx4 v15, s[24:27], s57 offen offset:1024 lds
  v_mfma_f32_16x16x32_bf16 v[168:171], v[72:75], v[88:91], v[168:171]
  ds_read_b64_tr_b16 v[108:109], v34 offset:24576
  ds_read_b64_tr_b16 v[110:111], v34 offset:32768
  v_mfma_f32_16x16x32_bf16 v[176:179], v[76:79], v[80:83], v[176:179]
  v_mfma_f32_16x16x32_bf16 v[180:183], v[76:79], v[84:87], v[180:183]
  v_mfma_f32_16x16x32_bf16 v[184:187], v[76:79], v[88:91], v[184:187]
  s_waitcnt vmcnt(14) lgkmcnt(0)
  v_mfma_f32_16x16x32_bf16 v[128:131], v[96:99], v[112:115], v[128:131]
  s_add_u32 m0, s46, 24576
  ds_read_b64_tr_b16 v[64:65], v31 offset:34816
  ds_read_b64_tr_b16 v[66:67], v31 offset:36864
  ds_read_b128 v[80:83], v43 offset:8192
  v_mfma_f32_16x16x32_bf16 v[132:135], v[96:99], v[116:119], v[132:135]
  buffer_load_dwordx4 v16, s[24:27], s57 offen lds
  v_mfma_f32_16x16x32_bf16 v[136:139], v[96:99], v[120:123], v[136:139]
  ds_read_b64_tr_b16 v[68:69], v32 offset:34816
  ds_read_b128 v[84:87], v43 offset:9216
  v_mfma_f32_16x16x32_bf16 v[144:147], v[100:103], v[112:115], v[144:147]
  buffer_load_dwordx4 v17, s[24:27], s57 offen offset:1024 lds
  v_mfma_f32_16x16x32_bf16 v[148:151], v[100:103], v[116:119], v[148:151]
  s_add_u32 m0, s46, 32768
  s_add_u32 s57, s57, 16384
  ds_read_b64_tr_b16 v[70:71], v32 offset:36864
  ds_read_b128 v[88:91], v43 offset:10240
  v_mfma_f32_16x16x32_bf16 v[152:155], v[100:103], v[120:123], v[152:155]
  buffer_load_dwordx4 v14, s[24:27], s57 offen lds
  v_mfma_f32_16x16x32_bf16 v[160:163], v[104:107], v[112:115], v[160:163]
  ds_read_b64_tr_b16 v[72:73], v33 offset:34816
  ds_read_b64_tr_b16 v[74:75], v33 offset:36864
  v_mfma_f32_16x16x32_bf16 v[164:167], v[104:107], v[116:119], v[164:167]
  buffer_load_dwordx4 v15, s[24:27], s57 offen offset:1024 lds
  v_mfma_f32_16x16x32_bf16 v[168:171], v[104:107], v[120:123], v[168:171]
  ds_read_b64_tr_b16 v[76:77], v34 offset:34816
  ds_read_b64_tr_b16 v[78:79], v34 offset:36864
  v_mfma_f32_16x16x32_bf16 v[176:179], v[108:111], v[112:115], v[176:179]
  v_mfma_f32_16x16x32_bf16 v[180:183], v[108:111], v[116:119], v[180:183]
  ds_read_b128 v[192:195], v48 offset:31744
  ds_read_b128 v[196:199], v48 offset:32000
  ds_read_b128 v[200:203], v48 offset:32256
  v_mfma_f32_16x16x32_bf16 v[184:187], v[108:111], v[120:123], v[184:187]
  s_waitcnt vmcnt(14) lgkmcnt(0)
  v_mfma_f32_16x16x32_bf16 v[128:131], v[64:67], v[80:83], v[128:131]
  s_add_u32 m0, s46, 34816
  ds_read_b64_tr_b16 v[96:97], v31 offset:38912
  ds_read_b64_tr_b16 v[98:99], v31 offset:26624
  ds_read_b128 v[112:115], v43 offset:12288
  v_mfma_f32_16x16x32_bf16 v[132:135], v[64:67], v[84:87], v[132:135]
  buffer_load_dwordx4 v16, s[24:27], s57 offen lds
  v_mfma_f32_16x16x32_bf16 v[136:139], v[64:67], v[88:91], v[136:139]
  ds_read_b64_tr_b16 v[100:101], v32 offset:38912
  ds_read_b128 v[116:119], v43 offset:13312
  v_mfma_f32_16x16x32_bf16 v[144:147], v[68:71], v[80:83], v[144:147]
  buffer_load_dwordx4 v17, s[24:27], s57 offen offset:1024 lds
  v_mfma_f32_16x16x32_bf16 v[148:151], v[68:71], v[84:87], v[148:151]
  s_add_u32 m0, s46, 36864
  s_add_u32 s57, s57, 81920
  s_and_b32 s57, s57, 0x3ffff
  ds_read_b64_tr_b16 v[102:103], v32 offset:26624
  ds_read_b128 v[120:123], v43 offset:14336
  v_mfma_f32_16x16x32_bf16 v[152:155], v[68:71], v[88:91], v[152:155]
  buffer_load_dwordx4 v14, s[24:27], s57 offen lds
  v_mfma_f32_16x16x32_bf16 v[160:163], v[72:75], v[80:83], v[160:163]
  ds_read_b64_tr_b16 v[104:105], v33 offset:38912
  ds_read_b64_tr_b16 v[106:107], v33 offset:26624
  v_mfma_f32_16x16x32_bf16 v[164:167], v[72:75], v[84:87], v[164:167]
  buffer_load_dwordx4 v15, s[24:27], s57 offen offset:1024 lds
  v_mfma_f32_16x16x32_bf16 v[168:171], v[72:75], v[88:91], v[168:171]
  ds_read_b64_tr_b16 v[108:109], v34 offset:38912
  ds_read_b64_tr_b16 v[110:111], v34 offset:26624
  v_mfma_f32_16x16x32_bf16 v[176:179], v[76:79], v[80:83], v[176:179]
  v_mfma_f32_16x16x32_bf16 v[180:183], v[76:79], v[84:87], v[180:183]
  v_add_f32 v192, v192, v193
  v_add_f32 v194, v194, v195
  v_add_f32 v196, v196, v197
  v_add_f32 v198, v198, v199
  v_add_f32 v200, v200, v201
  v_add_f32 v202, v202, v203
  v_mfma_f32_16x16x32_bf16 v[184:187], v[76:79], v[88:91], v[184:187]
  s_waitcnt vmcnt(14) lgkmcnt(0)
  v_mfma_f32_16x16x32_bf16 v[128:131], v[96:99], v[112:115], v[128:131]
  s_add_u32 m0, s46, 38912
  ds_read_b64_tr_b16 v[64:65], v31 offset:28672
  ds_read_b64_tr_b16 v[66:67], v31 offset:18432
  ds_read_b128 v[80:83], v42 offset:0
  v_mfma_f32_16x16x32_bf16 v[132:135], v[96:99], v[116:119], v[132:135]
  buffer_load_dwordx4 v16, s[24:27], s57 offen lds
  v_mfma_f32_16x16x32_bf16 v[136:139], v[96:99], v[120:123], v[136:139]
  ds_read_b64_tr_b16 v[68:69], v32 offset:28672
  ds_read_b128 v[84:87], v42 offset:1024
  v_mfma_f32_16x16x32_bf16 v[144:147], v[100:103], v[112:115], v[144:147]
  buffer_load_dwordx4 v17, s[24:27], s57 offen offset:1024 lds
  v_mfma_f32_16x16x32_bf16 v[148:151], v[100:103], v[116:119], v[148:151]
  s_add_u32 m0, s46, 26624
  s_add_u32 s57, s57, 16384
  ds_read_b64_tr_b16 v[70:71], v32 offset:18432
  ds_read_b128 v[88:91], v42 offset:2048
  v_mfma_f32_16x16x32_bf16 v[152:155], v[100:103], v[120:123], v[152:155]
  buffer_load_dwordx4 v14, s[24:27], s57 offen lds
  v_mfma_f32_16x16x32_bf16 v[160:163], v[104:107], v[112:115], v[160:163]
  ds_read_b64_tr_b16 v[72:73], v33 offset:28672
  ds_read_b64_tr_b16 v[74:75], v33 offset:18432
  v_mfma_f32_16x16x32_bf16 v[164:167], v[104:107], v[116:119], v[164:167]
  buffer_load_dwordx4 v15, s[24:27], s57 offen offset:1024 lds
  v_mfma_f32_16x16x32_bf16 v[168:171], v[104:107], v[120:123], v[168:171]
  ds_read_b64_tr_b16 v[76:77], v34 offset:28672
  ds_read_b64_tr_b16 v[78:79], v34 offset:18432
  v_mfma_f32_16x16x32_bf16 v[176:179], v[108:111], v[112:115], v[176:179]
  v_mfma_f32_16x16x32_bf16 v[180:183], v[108:111], v[116:119], v[180:183]
  v_add_f32 v192, v192, v194
  v_add_f32 v196, v196, v198
  v_add_f32 v200, v200, v202
  v_mfma_f32_16x16x32_bf16 v[184:187], v[108:111], v[120:123], v[184:187]
  s_waitcnt vmcnt(14) lgkmcnt(0)
  v_mfma_f32_16x16x32_bf16 v[128:131], v[64:67], v[80:83], v[128:131]
  s_add_u32 m0, s46, 28672
  ds_read_b64_tr_b16 v[96:97], v31 offset:20480
  ds_read_b64_tr_b16 v[98:99], v31 offset:22528
  ds_read_b128 v[112:115], v42 offset:4096
  v_mfma_f32_16x16x32_bf16 v[132:135], v[64:67], v[84:87], v[132:135]
  buffer_load_dwordx4 v16, s[24:27], s57 offen lds
  v_mfma_f32_16x16x32_bf16 v[136:139], v[64:67], v[88:91], v[136:139]
  ds_read_b64_tr_b16 v[100:101], v32 offset:20480
  ds_read_b128 v[116:119], v42 offset:5120
  v_mfma_f32_16x16x32_bf16 v[144:147], v[68:71], v[80:83], v[144:147]
  buffer_load_dwordx4 v17, s[24:27], s57 offen offset:1024 lds
  v_mfma_f32_16x16x32_bf16 v[148:151], v[68:71], v[84:87], v[148:151]
  s_add_u32 m0, s46, 18432
  s_add_u32 s57, s57, 16384
  ds_read_b64_tr_b16 v[102:103], v32 offset:22528
  ds_read_b128 v[120:123], v42 offset:6144
  v_mfma_f32_16x16x32_bf16 v[152:155], v[68:71], v[88:91], v[152:155]
  buffer_load_dwordx4 v14, s[24:27], s57 offen lds
  v_mfma_f32_16x16x32_bf16 v[160:163], v[72:75], v[80:83], v[160:163]
  ds_read_b64_tr_b16 v[104:105], v33 offset:20480
  ds_read_b64_tr_b16 v[106:107], v33 offset:22528
  v_mfma_f32_16x16x32_bf16 v[164:167], v[72:75], v[84:87], v[164:167]
  buffer_load_dwordx4 v15, s[24:27], s57 offen offset:1024 lds
  v_mfma_f32_16x16x32_bf16 v[168:171], v[72:75], v[88:91], v[168:171]
  ds_read_b64_tr_b16 v[108:109], v34 offset:20480
  ds_read_b64_tr_b16 v[110:111], v34 offset:22528
  v_mfma_f32_16x16x32_bf16 v[176:179], v[76:79], v[80:83], v[176:179]
  v_mfma_f32_16x16x32_bf16 v[180:183], v[76:79], v[84:87], v[180:183]
  v_rcp_f32 v60, v192
  v_rcp_f32 v61, v196
  v_rcp_f32 v62, v200
  v_mfma_f32_16x16x32_bf16 v[184:187], v[76:79], v[88:91], v[184:187]
  s_waitcnt vmcnt(14) lgkmcnt(0)
  v_mfma_f32_16x16x32_bf16 v[128:131], v[96:99], v[112:115], v[128:131]
  s_add_u32 m0, s46, 20480
  ds_read_b64_tr_b16 v[64:65], v31 offset:16384
  ds_read_b64_tr_b16 v[66:67], v31 offset:24576
  ds_read_b128 v[80:83], v42 offset:8192
  v_mfma_f32_16x16x32_bf16 v[132:135], v[96:99], v[116:119], v[132:135]
  buffer_load_dwordx4 v16, s[24:27], s57 offen lds
  v_mfma_f32_16x16x32_bf16 v[136:139], v[96:99], v[120:123], v[136:139]
  ds_read_b64_tr_b16 v[68:69], v32 offset:16384
  ds_read_b128 v[84:87], v42 offset:9216
  v_mfma_f32_16x16x32_bf16 v[144:147], v[100:103], v[112:115], v[144:147]
  buffer_load_dwordx4 v17, s[24:27], s57 offen offset:1024 lds
  v_mfma_f32_16x16x32_bf16 v[148:151], v[100:103], v[116:119], v[148:151]
  s_add_u32 m0, s46, 22528
  s_add_u32 s57, s57, 16384
  ds_read_b64_tr_b16 v[70:71], v32 offset:24576
  ds_read_b128 v[88:91], v42 offset:10240
  v_mfma_f32_16x16x32_bf16 v[152:155], v[100:103], v[120:123], v[152:155]
  buffer_load_dwordx4 v14, s[24:27], s57 offen lds
  v_mfma_f32_16x16x32_bf16 v[160:163], v[104:107], v[112:115], v[160:163]
  ds_read_b64_tr_b16 v[72:73], v33 offset:16384
  ds_read_b64_tr_b16 v[74:75], v33 offset:24576
  v_mfma_f32_16x16x32_bf16 v[164:167], v[104:107], v[116:119], v[164:167]
  buffer_load_dwordx4 v15, s[24:27], s57 offen offset:1024 lds
  v_mfma_f32_16x16x32_bf16 v[168:171], v[104:107], v[120:123], v[168:171]
  ds_read_b64_tr_b16 v[76:77], v34 offset:16384
  ds_read_b64_tr_b16 v[78:79], v34 offset:24576
  v_mfma_f32_16x16x32_bf16 v[176:179], v[108:111], v[112:115], v[176:179]
  v_mfma_f32_16x16x32_bf16 v[180:183], v[108:111], v[116:119], v[180:183]
  v_mfma_f32_16x16x32_bf16 v[184:187], v[108:111], v[120:123], v[184:187]
  s_waitcnt vmcnt(14) lgkmcnt(0)
  v_mfma_f32_16x16x32_bf16 v[128:131], v[64:67], v[80:83], v[128:131]
  s_add_u32 m0, s46, 16384
  ds_read_b64_tr_b16 v[96:97], v31 offset:32768
  ds_read_b64_tr_b16 v[98:99], v31 offset:34816
  ds_read_b128 v[112:115], v42 offset:12288
  v_mfma_f32_16x16x32_bf16 v[132:135], v[64:67], v[84:87], v[132:135]
  buffer_load_dwordx4 v16, s[24:27], s57 offen lds
  v_mfma_f32_16x16x32_bf16 v[136:139], v[64:67], v[88:91], v[136:139]
  ds_read_b64_tr_b16 v[100:101], v32 offset:32768
  ds_read_b128 v[116:119], v42 offset:13312
  v_mfma_f32_16x16x32_bf16 v[144:147], v[68:71], v[80:83], v[144:147]
  buffer_load_dwordx4 v17, s[24:27], s57 offen offset:1024 lds
  v_mfma_f32_16x16x32_bf16 v[148:151], v[68:71], v[84:87], v[148:151]
  s_add_u32 m0, s46, 24576
  s_add_u32 s51, s12, 0
  ds_read_b64_tr_b16 v[102:103], v32 offset:34816
  ds_read_b128 v[120:123], v42 offset:14336
  v_mfma_f32_16x16x32_bf16 v[152:155], v[68:71], v[88:91], v[152:155]
  buffer_load_dwordx4 v24, s[32:35], s51 offen lds
  v_mfma_f32_16x16x32_bf16 v[160:163], v[72:75], v[80:83], v[160:163]
  ds_read_b64_tr_b16 v[104:105], v33 offset:32768
  ds_read_b64_tr_b16 v[106:107], v33 offset:34816
  v_mfma_f32_16x16x32_bf16 v[164:167], v[72:75], v[84:87], v[164:167]
  buffer_load_dwordx4 v25, s[32:35], s51 offen offset:1024 lds
  v_mfma_f32_16x16x32_bf16 v[168:171], v[72:75], v[88:91], v[168:171]
  ds_read_b64_tr_b16 v[108:109], v34 offset:32768
  ds_read_b64_tr_b16 v[110:111], v34 offset:34816
  v_mfma_f32_16x16x32_bf16 v[176:179], v[76:79], v[80:83], v[176:179]
  v_mfma_f32_16x16x32_bf16 v[180:183], v[76:79], v[84:87], v[180:183]
  v_mfma_f32_16x16x32_bf16 v[184:187], v[76:79], v[88:91], v[184:187]
  s_waitcnt vmcnt(14) lgkmcnt(0)
  v_mfma_f32_16x16x32_bf16 v[128:131], v[96:99], v[112:115], v[128:131]
  s_add_u32 m0, s46, 32768
  ds_read_b64_tr_b16 v[64:65], v31 offset:36864
  ds_read_b64_tr_b16 v[66:67], v31 offset:38912
  ds_read_b128 v[80:83], v44 offset:0
  v_mfma_f32_16x16x32_bf16 v[132:135], v[96:99], v[116:119], v[132:135]
  buffer_load_dwordx4 v26, s[32:35], s51 offen lds
  v_mfma_f32_16x16x32_bf16 v[136:139], v[96:99], v[120:123], v[136:139]
  ds_read_b64_tr_b16 v[68:69], v32 offset:36864
  ds_read_b128 v[84:87], v44 offset:1024
  v_mfma_f32_16x16x32_bf16 v[144:147], v[100:103], v[112:115], v[144:147]
  buffer_load_dwordx4 v27, s[32:35], s51 offen offset:1024 lds
  v_mfma_f32_16x16x32_bf16 v[148:151], v[100:103], v[116:119], v[148:151]
  s_add_u32 m0, s46, 34816
  s_add_u32 s51, s12, 28672
  ds_read_b64_tr_b16 v[70:71], v32 offset:38912
  ds_read_b128 v[88:91], v44 offset:2048
  v_mfma_f32_16x16x32_bf16 v[152:155], v[100:103], v[120:123], v[152:155]
  buffer_load_dwordx4 v24, s[32:35], s51 offen lds
  v_mfma_f32_16x16x32_bf16 v[160:163], v[104:107], v[112:115], v[160:163]
  ds_read_b64_tr_b16 v[72:73], v33 offset:36864
  ds_read_b64_tr_b16 v[74:75], v33 offset:38912
  v_mfma_f32_16x16x32_bf16 v[164:167], v[104:107], v[116:119], v[164:167]
  buffer_load_dwordx4 v25, s[32:35], s51 offen offset:1024 lds
  v_mfma_f32_16x16x32_bf16 v[168:171], v[104:107], v[120:123], v[168:171]
  ds_read_b64_tr_b16 v[76:77], v34 offset:36864
  ds_read_b64_tr_b16 v[78:79], v34 offset:38912
  v_mfma_f32_16x16x32_bf16 v[176:179], v[108:111], v[112:115], v[176:179]
  v_mfma_f32_16x16x32_bf16 v[180:183], v[108:111], v[116:119], v[180:183]
  v_mfma_f32_16x16x32_bf16 v[184:187], v[108:111], v[120:123], v[184:187]
  s_waitcnt vmcnt(14) lgkmcnt(0)
  v_mfma_f32_16x16x32_bf16 v[128:131], v[64:67], v[80:83], v[128:131]
  s_add_u32 m0, s46, 36864
  ds_read_b64_tr_b16 v[96:97], v31 offset:26624
  ds_read_b64_tr_b16 v[98:99], v31 offset:28672
  ds_read_b128 v[112:115], v44 offset:4096
  v_mfma_f32_16x16x32_bf16 v[132:135], v[64:67], v[84:87], v[132:135]
  buffer_load_dwordx4 v26, s[32:35], s51 offen lds
  v_mfma_f32_16x16x32_bf16 v[136:139], v[64:67], v[88:91], v[136:139]
  ds_read_b64_tr_b16 v[100:101], v32 offset:26624
  ds_read_b128 v[116:119], v44 offset:5120
  v_mfma_f32_16x16x32_bf16 v[144:147], v[68:71], v[80:83], v[144:147]
  buffer_load_dwordx4 v27, s[32:35], s51 offen offset:1024 lds
  v_mfma_f32_16x16x32_bf16 v[148:151], v[68:71], v[84:87], v[148:151]
  s_add_u32 m0, s46, 38912
  s_add_u32 s51, s12, 128
  ds_read_b64_tr_b16 v[102:103], v32 offset:28672
  ds_read_b128 v[120:123], v44 offset:6144
  v_mfma_f32_16x16x32_bf16 v[152:155], v[68:71], v[88:91], v[152:155]
  buffer_load_dwordx4 v24, s[32:35], s51 offen lds
  v_mfma_f32_16x16x32_bf16 v[160:163], v[72:75], v[80:83], v[160:163]
  ds_read_b64_tr_b16 v[104:105], v33 offset:26624
  ds_read_b64_tr_b16 v[106:107], v33 offset:28672
  v_mfma_f32_16x16x32_bf16 v[164:167], v[72:75], v[84:87], v[164:167]
  buffer_load_dwordx4 v25, s[32:35], s51 offen offset:1024 lds
  v_mfma_f32_16x16x32_bf16 v[168:171], v[72:75], v[88:91], v[168:171]
  ds_read_b64_tr_b16 v[108:109], v34 offset:26624
  ds_read_b64_tr_b16 v[110:111], v34 offset:28672
  v_mfma_f32_16x16x32_bf16 v[176:179], v[76:79], v[80:83], v[176:179]
  v_mfma_f32_16x16x32_bf16 v[180:183], v[76:79], v[84:87], v[180:183]
  v_mfma_f32_16x16x32_bf16 v[184:187], v[76:79], v[88:91], v[184:187]
  s_waitcnt vmcnt(14) lgkmcnt(0)
  v_mfma_f32_16x16x32_bf16 v[128:131], v[96:99], v[112:115], v[128:131]
  s_add_u32 m0, s46, 26624
  ds_read_b64_tr_b16 v[64:65], v31 offset:18432
  ds_read_b64_tr_b16 v[66:67], v31 offset:20480
  ds_read_b128 v[80:83], v44 offset:8192
  v_mfma_f32_16x16x32_bf16 v[132:135], v[96:99], v[116:119], v[132:135]
  buffer_load_dwordx4 v26, s[32:35], s51 offen lds
  v_mfma_f32_16x16x32_bf16 v[136:139], v[96:99], v[120:123], v[136:139]
  ds_read_b64_tr_b16 v[68:69], v32 offset:18432
  ds_read_b128 v[84:87], v44 offset:9216
  v_mfma_f32_16x16x32_bf16 v[144:147], v[100:103], v[112:115], v[144:147]
  buffer_load_dwordx4 v27, s[32:35], s51 offen offset:1024 lds
  v_mfma_f32_16x16x32_bf16 v[148:151], v[100:103], v[116:119], v[148:151]
  s_add_u32 m0, s46, 28672
  s_add_u32 s51, s12, 28800
  ds_read_b64_tr_b16 v[70:71], v32 offset:20480
  ds_read_b128 v[88:91], v44 offset:10240
  v_mfma_f32_16x16x32_bf16 v[152:155], v[100:103], v[120:123], v[152:155]
  buffer_load_dwordx4 v24, s[32:35], s51 offen lds
  v_mfma_f32_16x16x32_bf16 v[160:163], v[104:107], v[112:115], v[160:163]
  ds_read_b64_tr_b16 v[72:73], v33 offset:18432
  ds_read_b64_tr_b16 v[74:75], v33 offset:20480
  v_mfma_f32_16x16x32_bf16 v[164:167], v[104:107], v[116:119], v[164:167]
  buffer_load_dwordx4 v25, s[32:35], s51 offen offset:1024 lds
  v_mfma_f32_16x16x32_bf16 v[168:171], v[104:107], v[120:123], v[168:171]
  ds_read_b64_tr_b16 v[76:77], v34 offset:18432
  ds_read_b64_tr_b16 v[78:79], v34 offset:20480
  v_mfma_f32_16x16x32_bf16 v[176:179], v[108:111], v[112:115], v[176:179]
  v_mfma_f32_16x16x32_bf16 v[180:183], v[108:111], v[116:119], v[180:183]
  v_mfma_f32_16x16x32_bf16 v[184:187], v[108:111], v[120:123], v[184:187]
  s_waitcnt vmcnt(14) lgkmcnt(0)
  v_mfma_f32_16x16x32_bf16 v[128:131], v[64:67], v[80:83], v[128:131]
  s_add_u32 m0, s46, 18432
  ds_read_b64_tr_b16 v[96:97], v31 offset:22528
  ds_read_b64_tr_b16 v[98:99], v31 offset:16384
  ds_read_b128 v[112:115], v44 offset:12288
  v_mfma_f32_16x16x32_bf16 v[132:135], v[64:67], v[84:87], v[132:135]
  buffer_load_dwordx4 v26, s[32:35], s51 offen lds
  v_mfma_f32_16x16x32_bf16 v[136:139], v[64:67], v[88:91], v[136:139]
  ds_read_b64_tr_b16 v[100:101], v32 offset:22528
  ds_read_b128 v[116:119], v44 offset:13312
  v_mfma_f32_16x16x32_bf16 v[144:147], v[68:71], v[80:83], v[144:147]
  buffer_load_dwordx4 v27, s[32:35], s51 offen offset:1024 lds
  v_mfma_f32_16x16x32_bf16 v[148:151], v[68:71], v[84:87], v[148:151]
  s_add_u32 m0, s46, 20480
  s_add_u32 s51, s12, 256
  ds_read_b64_tr_b16 v[102:103], v32 offset:16384
  ds_read_b128 v[120:123], v44 offset:14336
  v_mfma_f32_16x16x32_bf16 v[152:155], v[68:71], v[88:91], v[152:155]
  buffer_load_dwordx4 v24, s[32:35], s51 offen lds
  v_mfma_f32_16x16x32_bf16 v[160:163], v[72:75], v[80:83], v[160:163]
  ds_read_b64_tr_b16 v[104:105], v33 offset:22528
  ds_read_b64_tr_b16 v[106:107], v33 offset:16384
  v_mfma_f32_16x16x32_bf16 v[164:167], v[72:75], v[84:87], v[164:167]
  buffer_load_dwordx4 v25, s[32:35], s51 offen offset:1024 lds
  v_mfma_f32_16x16x32_bf16 v[168:171], v[72:75], v[88:91], v[168:171]
  ds_read_b64_tr_b16 v[108:109], v34 offset:22528
  ds_read_b64_tr_b16 v[110:111], v34 offset:16384
  v_mfma_f32_16x16x32_bf16 v[176:179], v[76:79], v[80:83], v[176:179]
  v_mfma_f32_16x16x32_bf16 v[180:183], v[76:79], v[84:87], v[180:183]
  v_mfma_f32_16x16x32_bf16 v[184:187], v[76:79], v[88:91], v[184:187]
  s_waitcnt vmcnt(10) lgkmcnt(0)
  v_readfirstlane_b32 s52, v5
  s_barrier
  s_cmp_eq_u32 s52, 1
  s_cbranch_scc0 L_nonceb
L_havenonceb:
  v_mfma_f32_16x16x32_bf16 v[128:131], v[96:99], v[112:115], v[128:131]
  s_add_u32 m0, s46, 8192
  ds_read_b64_tr_b16 v[64:65], v49 offset:24576
  ds_read_b64_tr_b16 v[66:67], v49 offset:32768
  v_mfma_f32_16x16x32_bf16 v[144:147], v[100:103], v[112:115], v[144:147]
  buffer_load_dwordx4 v26, s[32:35], s51 offen lds
  v_mfma_f32_16x16x32_bf16 v[132:135], v[96:99], v[116:119], v[132:135]
  ds_read_b64_tr_b16 v[68:69], v49 offset:34816
  ds_read_b64_tr_b16 v[70:71], v49 offset:36864
  v_mfma_f32_16x16x32_bf16 v[148:151], v[100:103], v[116:119], v[148:151]
  buffer_load_dwordx4 v27, s[32:35], s51 offen offset:1024 lds
  v_mfma_f32_16x16x32_bf16 v[136:139], v[96:99], v[120:123], v[136:139]
  ds_read_b64_tr_b16 v[72:73], v50 offset:24576
  ds_read_b64_tr_b16 v[74:75], v50 offset:32768
  v_mfma_f32_16x16x32_bf16 v[152:155], v[100:103], v[120:123], v[152:155]
  ds_read_b64_tr_b16 v[76:77], v50 offset:34816
  ds_read_b64_tr_b16 v[78:79], v50 offset:36864
  v_mfma_f32_16x16x32_bf16 v[160:163], v[104:107], v[112:115], v[160:163]
  s_add_u32 m0, s46, 10240
  s_add_u32 s51, s12, 28928
  v_not_b32 v5, v4
  v_cvt_pk_bf16_f32 v192, v128, v129
  v_cvt_pk_bf16_f32 v193, v130, v131
  v_mfma_f32_16x16x32_bf16 v[176:179], v[108:111], v[112:115], v[176:179]
  buffer_load_dwordx4 v24, s[32:35], s51 offen lds
  v_mfma_f32_16x16x32_bf16 v[164:167], v[104:107], v[116:119], v[164:167]
  v_cvt_pk_bf16_f32 v194, v144, v145
  v_cvt_pk_bf16_f32 v195, v146, v147
  ds_write_b128 v41, v[192:195] offset:0
  v_mfma_f32_16x16x32_bf16 v[180:183], v[108:111], v[116:119], v[180:183]
  v_cvt_pk_bf16_f32 v196, v132, v133
  v_cvt_pk_bf16_f32 v197, v134, v135
  v_cvt_pk_bf16_f32 v198, v148, v149
  v_mfma_f32_16x16x32_bf16 v[168:171], v[104:107], v[120:123], v[168:171]
  v_cvt_pk_bf16_f32 v199, v150, v151
  ds_write_b128 v41, v[196:199] offset:1024
  v_cvt_pk_bf16_f32 v200, v136, v137
  v_mfma_f32_16x16x32_bf16 v[184:187], v[108:111], v[120:123], v[184:187]
  buffer_load_dwordx4 v25, s[32:35], s51 offen offset:1024 lds
  s_nop 3
  v_cvt_pk_bf16_f32 v201, v138, v139
  v_cvt_pk_bf16_f32 v202, v152, v153
  v_cvt_pk_bf16_f32 v203, v154, v155
  ds_write_b128 v41, v[200:203] offset:2048
  v_cvt_pk_bf16_f32 v208, v160, v161
  v_cvt_pk_bf16_f32 v209, v162, v163
  v_cvt_pk_bf16_f32 v210, v176, v177
  v_cvt_pk_bf16_f32 v211, v178, v179
  ds_write_b128 v41, v[208:211] offset:4096
  v_cvt_pk_bf16_f32 v212, v164, v165
  v_cvt_pk_bf16_f32 v213, v166, v167
  v_cvt_pk_bf16_f32 v214, v180, v181
  v_cvt_pk_bf16_f32 v215, v182, v183
  ds_write_b128 v41, v[212:215] offset:5120
  v_cvt_pk_bf16_f32 v216, v168, v169
  v_cvt_pk_bf16_f32 v217, v170, v171
  v_cvt_pk_bf16_f32 v218, v184, v185
  v_cvt_pk_bf16_f32 v219, v186, v187
  ds_write_b128 v41, v[216:219] offset:6144
  ds_read_b64_tr_b16 v[80:81], v51 offset:24576
  ds_read_b64_tr_b16 v[82:83], v51 offset:32768
  ds_read_b64_tr_b16 v[84:85], v51 offset:34816
  ds_read_b64_tr_b16 v[86:87], v51 offset:36864
  ds_read_b64_tr_b16 v[88:89], v52 offset:24576
  ds_read_b64_tr_b16 v[90:91], v52 offset:32768
  ds_read_b64_tr_b16 v[92:93], v52 offset:34816
  ds_read_b64_tr_b16 v[94:95], v52 offset:36864
  s_add_u32 m0, s46, 12288
  s_nop 0
  buffer_load_dwordx4 v26, s[32:35], s51 offen lds
  buffer_load_dwordx4 v27, s[32:35], s51 offen offset:1024 lds
  s_waitcnt lgkmcnt(8)
  s_barrier
  ds_read_b128 a[32:35], v42 offset:0
  ds_read_b128 a[36:39], v42 offset:1024
  ds_read_b128 a[40:43], v42 offset:2048
  ds_read_b128 a[48:51], v42 offset:4096
  ds_read_b128 a[52:55], v42 offset:5120
  ds_read_b128 a[56:59], v42 offset:6144
  v_mfma_f32_16x16x32_bf16 v[128:131], v[64:67], v[192:195], 0
  s_add_u32 m0, s46, 14336
  s_add_u32 s51, s12, 384
  ds_read_b128 a[64:67], v43 offset:0
  ds_read_b128 a[68:71], v43 offset:1024
  v_mfma_f32_16x16x32_bf16 v[132:135], v[64:67], v[196:199], 0
  buffer_load_dwordx4 v24, s[32:35], s51 offen lds
  v_mfma_f32_16x16x32_bf16 v[136:139], v[64:67], v[200:203], 0
  ds_read_b128 a[72:75], v43 offset:2048
  v_mfma_f32_16x16x32_bf16 v[128:131], v[68:71], v[208:211], v[128:131]
  ds_read_b128 a[80:83], v43 offset:4096
  ds_read_b128 a[84:87], v43 offset:5120
  v_mfma_f32_16x16x32_bf16 v[132:135], v[68:71], v[212:215], v[132:135]
  buffer_load_dwordx4 v25, s[32:35], s51 offen offset:1024 lds
  v_mfma_f32_16x16x32_bf16 v[136:139], v[68:71], v[216:219], v[136:139]
  ds_read_b128 a[88:91], v43 offset:6144
  s_waitcnt lgkmcnt(9)
  v_mfma_f32_16x16x32_bf16 v[128:131], v[72:75], a[32:35], v[128:131]
  s_add_u32 m0, s46, 22528
  ds_read_b128 a[96:99], v44 offset:0
  ds_read_b128 a[100:103], v44 offset:1024
  v_mfma_f32_16x16x32_bf16 v[132:135], v[72:75], a[36:39], v[132:135]
  buffer_load_dwordx4 v26, s[32:35], s51 offen lds
  v_mfma_f32_16x16x32_bf16 v[136:139], v[72:75], a[40:43], v[136:139]
  ds_read_b128 a[104:107], v44 offset:2048
  s_waitcnt lgkmcnt(9)
  v_mfma_f32_16x16x32_bf16 v[128:131], v[76:79], a[48:51], v[128:131]
  ds_read_b128 a[112:115], v44 offset:4096
  ds_read_b128 a[116:119], v44 offset:5120
  v_mfma_f32_16x16x32_bf16 v[132:135], v[76:79], a[52:55], v[132:135]
  buffer_load_dwordx4 v27, s[32:35], s51 offen offset:1024 lds
  v_mfma_f32_16x16x32_bf16 v[136:139], v[76:79], a[56:59], v[136:139]
  ds_read_b128 a[120:123], v44 offset:6144
  s_waitcnt lgkmcnt(9)
  s_waitcnt vmcnt(12)
  s_barrier
  v_mfma_f32_16x16x32_bf16 v[128:131], v[80:83], a[64:67], v[128:131]
  s_add_u32 m0, s46, 16384
  s_add_u32 s51, s12, 29056
  ds_read_b64_tr_b16 v[96:97], v49 offset:38912
  ds_read_b64_tr_b16 v[98:99], v49 offset:26624
  v_mfma_f32_16x16x32_bf16 v[132:135], v[80:83], a[68:71], v[132:135]
  buffer_load_dwordx4 v24, s[32:35], s51 offen lds
  v_mfma_f32_16x16x32_bf16 v[136:139], v[80:83], a[72:75], v[136:139]
  ds_read_b64_tr_b16 v[100:101], v49 offset:28672
  ds_read_b64_tr_b16 v[102:103], v49 offset:18432
  s_waitcnt lgkmcnt(10)
  v_mfma_f32_16x16x32_bf16 v[128:131], v[84:87], a[80:83], v[128:131]
  ds_read_b64_tr_b16 v[104:105], v50 offset:38912
  ds_read_b64_tr_b16 v[106:107], v50 offset:26624
  v_mfma_f32_16x16x32_bf16 v[132:135], v[84:87], a[84:87], v[132:135]
  buffer_load_dwordx4 v25, s[32:35], s51 offen offset:1024 lds
  v_mfma_f32_16x16x32_bf16 v[136:139], v[84:87], a[88:91], v[136:139]
  ds_read_b64_tr_b16 v[108:109], v50 offset:28672
  ds_read_b64_tr_b16 v[110:111], v50 offset:18432
  s_waitcnt lgkmcnt(11)
  v_mfma_f32_16x16x32_bf16 v[128:131], v[88:91], a[96:99], v[128:131]
  s_add_u32 m0, s46, 24576
  ds_read_b64_tr_b16 v[112:113], v51 offset:38912
  ds_read_b64_tr_b16 v[114:115], v51 offset:26624
  v_mfma_f32_16x16x32_bf16 v[132:135], v[88:91], a[100:103], v[132:135]
  buffer_load_dwordx4 v26, s[32:35], s51 offen lds
  v_mfma_f32_16x16x32_bf16 v[136:139], v[88:91], a[104:107], v[136:139]
  ds_read_b64_tr_b16 v[116:117], v51 offset:28672
  ds_read_b64_tr_b16 v[118:119], v51 offset:18432
  s_waitcnt lgkmcnt(12)
  v_mfma_f32_16x16x32_bf16 v[128:131], v[92:95], a[112:115], v[128:131]
  ds_read_b64_tr_b16 v[120:121], v52 offset:38912
  ds_read_b64_tr_b16 v[122:123], v52 offset:26624
  v_mfma_f32_16x16x32_bf16 v[132:135], v[92:95], a[116:119], v[132:135]
  buffer_load_dwordx4 v27, s[32:35], s51 offen offset:1024 lds
  v_mfma_f32_16x16x32_bf16 v[136:139], v[92:95], a[120:123], v[136:139]
  ds_read_b64_tr_b16 v[124:125], v52 offset:28672
  ds_read_b64_tr_b16 v[126:127], v52 offset:18432
  s_waitcnt vmcnt(8) lgkmcnt(0)
  s_barrier
  v_mfma_f32_16x16x32_bf16 v[144:147], v[96:99], v[192:195], 0
  s_add_u32 m0, s46, 32768
  s_add_u32 s51, s12, 512
  ds_read_b64_tr_b16 v[64:65], v49 offset:20480
  ds_read_b64_tr_b16 v[66:67], v49 offset:8192
  v_mfma_f32_16x16x32_bf16 v[148:151], v[96:99], v[196:199], 0
  buffer_load_dwordx4 v24, s[32:35], s51 offen lds
  v_mfma_f32_16x16x32_bf16 v[152:155], v[96:99], v[200:203], 0
  ds_read_b64_tr_b16 v[68:69], v49 offset:10240
  ds_read_b64_tr_b16 v[70:71], v49 offset:12288
  v_mfma_f32_16x16x32_bf16 v[144:147], v[100:103], v[208:211], v[144:147]
  buffer_load_dwordx4 v25, s[32:35], s51 offen offset:1024 lds
  v_mfma_f32_16x16x32_bf16 v[148:151], v[100:103], v[212:215], v[148:151]
  s_add_u32 m0, s46, 34816
  ds_read_b64_tr_b16 v[72:73], v50 offset:20480
  ds_read_b64_tr_b16 v[74:75], v50 offset:8192
  v_mfma_f32_16x16x32_bf16 v[152:155], v[100:103], v[216:219], v[152:155]
  buffer_load_dwordx4 v26, s[32:35], s51 offen lds
  v_mfma_f32_16x16x32_bf16 v[144:147], v[104:107], a[32:35], v[144:147]
  ds_read_b64_tr_b16 v[76:77], v50 offset:10240
  ds_read_b64_tr_b16 v[78:79], v50 offset:12288
  v_mfma_f32_16x16x32_bf16 v[148:151], v[104:107], a[36:39], v[148:151]
  buffer_load_dwordx4 v27, s[32:35], s51 offen offset:1024 lds
  v_mfma_f32_16x16x32_bf16 v[152:155], v[104:107], a[40:43], v[152:155]
  s_add_u32 m0, s46, 36864
  s_add_u32 s51, s12, 29184
  ds_read_b64_tr_b16 v[80:81], v51 offset:20480
  ds_read_b64_tr_b16 v[82:83], v51 offset:8192
  v_mfma_f32_16x16x32_bf16 v[144:147], v[108:111], a[48:51], v[144:147]
  buffer_load_dwordx4 v24, s[32:35], s51 offen lds
  v_mfma_f32_16x16x32_bf16 v[148:151], v[108:111], a[52:55], v[148:151]
  ds_read_b64_tr_b16 v[84:85], v51 offset:10240
  ds_read_b64_tr_b16 v[86:87], v51 offset:12288
  v_mfma_f32_16x16x32_bf16 v[152:155], v[108:111], a[56:59], v[152:155]
  buffer_load_dwordx4 v25, s[32:35], s51 offen offset:1024 lds
  v_mfma_f32_16x16x32_bf16 v[144:147], v[112:115], a[64:67], v[144:147]
  s_add_u32 m0, s46, 38912
  ds_read_b64_tr_b16 v[88:89], v52 offset:20480
  ds_read_b64_tr_b16 v[90:91], v52 offset:8192
  v_mfma_f32_16x16x32_bf16 v[148:151], v[112:115], a[68:71], v[148:151]
  buffer_load_dwordx4 v26, s[32:35], s51 offen lds
  v_mfma_f32_16x16x32_bf16 v[152:155], v[112:115], a[72:75], v[152:155]
  ds_read_b64_tr_b16 v[92:93], v52 offset:10240
  ds_read_b64_tr_b16 v[94:95], v52 offset:12288
  v_mfma_f32_16x16x32_bf16 v[144:147], v[116:119], a[80:83], v[144:147]
  buffer_load_dwordx4 v27, s[32:35], s51 offen offset:1024 lds
  v_mfma_f32_16x16x32_bf16 v[148:151], v[116:119], a[84:87], v[148:151]
  s_add_u32 m0, s46, 26624
  s_add_u32 s51, s12, 640
  v_mul_f32 v128, v128, v60
  v_mul_f32 v129, v129, v60
  v_mul_f32 v130, v130, v60
  v_mfma_f32_16x16x32_bf16 v[152:155], v[116:119], a[88:91], v[152:155]
  buffer_load_dwordx4 v24, s[32:35], s51 offen lds
  v_mfma_f32_16x16x32_bf16 v[144:147], v[120:123], a[96:99], v[144:147]
  v_mul_f32 v131, v131, v60
  v_mul_f32 v132, v132, v61
  v_mul_f32 v133, v133, v61
  v_mfma_f32_16x16x32_bf16 v[148:151], v[120:123], a[100:103], v[148:151]
  buffer_load_dwordx4 v25, s[32:35], s51 offen offset:1024 lds
  v_mfma_f32_16x16x32_bf16 v[152:155], v[120:123], a[104:107], v[152:155]
  v_mul_f32 v134, v134, v61
  v_mul_f32 v135, v135, v61
  v_cvt_pk_bf16_f32 v160, v128, v129
  v_mfma_f32_16x16x32_bf16 v[144:147], v[124:127], a[112:115], v[144:147]
  v_cvt_pk_bf16_f32 v161, v130, v131
  v_cvt_pk_bf16_f32 v162, v132, v133
  v_cvt_pk_bf16_f32 v163, v134, v135
  v_mfma_f32_16x16x32_bf16 v[148:151], v[124:127], a[116:119], v[148:151]
  v_mul_f32 v136, v136, v62
  v_mul_f32 v137, v137, v62
  v_mul_f32 v138, v138, v62
  v_mfma_f32_16x16x32_bf16 v[152:155], v[124:127], a[120:123], v[152:155]
  v_mul_f32 v139, v139, v62
  v_cvt_pk_bf16_f32 v172, v136, v137
  v_cvt_pk_bf16_f32 v173, v138, v139
  s_waitcnt vmcnt(10) lgkmcnt(0)
  s_barrier
  v_mfma_f32_16x16x32_bf16 v[128:131], v[64:67], v[192:195], 0
  ds_read_b64_tr_b16 v[96:97], v49 offset:14336
  ds_read_b64_tr_b16 v[98:99], v49 offset:22528
  v_mfma_f32_16x16x32_bf16 v[132:135], v[64:67], v[196:199], 0
  buffer_store_dwordx4 v[160:163], v28, s[36:39], s96 offen sc1
  s_add_u32 s96, s96, 131072
  v_mfma_f32_16x16x32_bf16 v[136:139], v[64:67], v[200:203], 0
  s_add_u32 m0, s46, 28672
  ds_read_b64_tr_b16 v[100:101], v49 offset:16384
  ds_read_b64_tr_b16 v[102:103], v49 offset:24576
  v_mfma_f32_16x16x32_bf16 v[128:131], v[68:71], v[208:211], v[128:131]
  buffer_load_dwordx4 v26, s[32:35], s51 offen lds
  v_mfma_f32_16x16x32_bf16 v[132:135], v[68:71], v[212:215], v[132:135]
  ds_read_b64_tr_b16 v[104:105], v50 offset:14336
  ds_read_b64_tr_b16 v[106:107], v50 offset:22528
  v_mfma_f32_16x16x32_bf16 v[136:139], v[68:71], v[216:219], v[136:139]
  buffer_load_dwordx4 v27, s[32:35], s51 offen offset:1024 lds
  v_mfma_f32_16x16x32_bf16 v[128:131], v[72:75], a[32:35], v[128:131]
  s_add_u32 m0, s46, 18432
  s_add_u32 s51, s12, 29312
  ds_read_b64_tr_b16 v[108:109], v50 offset:16384
  ds_read_b64_tr_b16 v[110:111], v50 offset:24576
  v_mfma_f32_16x16x32_bf16 v[132:135], v[72:75], a[36:39], v[132:135]
  buffer_load_dwordx4 v24, s[32:35], s51 offen lds
  v_mfma_f32_16x16x32_bf16 v[136:139], v[72:75], a[40:43], v[136:139]
  ds_read_b64_tr_b16 v[112:113], v51 offset:14336
  ds_read_b64_tr_b16 v[114:115], v51 offset:22528
  v_mfma_f32_16x16x32_bf16 v[128:131], v[76:79], a[48:51], v[128:131]
  buffer_load_dwordx4 v25, s[32:35], s51 offen offset:1024 lds
  v_mfma_f32_16x16x32_bf16 v[132:135], v[76:79], a[52:55], v[132:135]
  s_add_u32 m0, s46, 0
  ds_read_b64_tr_b16 v[116:117], v51 offset:16384
  ds_read_b64_tr_b16 v[118:119], v51 offset:24576
  v_mfma_f32_16x16x32_bf16 v[136:139], v[76:79], a[56:59], v[136:139]
  buffer_load_dwordx4 v26, s[32:35], s51 offen lds
  v_mfma_f32_16x16x32_bf16 v[128:131], v[80:83], a[64:67], v[128:131]
  ds_read_b64_tr_b16 v[120:121], v52 offset:14336
  ds_read_b64_tr_b16 v[122:123], v52 offset:22528
  v_mfma_f32_16x16x32_bf16 v[132:135], v[80:83], a[68:71], v[132:135]
  buffer_load_dwordx4 v27, s[32:35], s51 offen offset:1024 lds
  v_mfma_f32_16x16x32_bf16 v[136:139], v[80:83], a[72:75], v[136:139]
  s_add_u32 m0, s46, 2048
  s_add_u32 s51, s12, 768
  ds_read_b64_tr_b16 v[124:125], v52 offset:16384
  ds_read_b64_tr_b16 v[126:127], v52 offset:24576
  v_mfma_f32_16x16x32_bf16 v[128:131], v[84:87], a[80:83], v[128:131]
  buffer_load_dwordx4 v24, s[32:35], s51 offen lds
  v_mfma_f32_16x16x32_bf16 v[132:135], v[84:87], a[84:87], v[132:135]
  v_mul_f32 v144, v144, v60
  v_mul_f32 v145, v145, v60
  v_mul_f32 v146, v146, v60
  v_mfma_f32_16x16x32_bf16 v[136:139], v[84:87], a[88:91], v[136:139]
  buffer_load_dwordx4 v25, s[32:35], s51 offen offset:1024 lds
  v_mfma_f32_16x16x32_bf16 v[128:131], v[88:91], a[96:99], v[128:131]
  s_add_u32 m0, s46, 4096
  v_mul_f32 v147, v147, v60
  v_mul_f32 v148, v148, v61
  v_mul_f32 v149, v149, v61
  v_mfma_f32_16x16x32_bf16 v[132:135], v[88:91], a[100:103], v[132:135]
  buffer_load_dwordx4 v26, s[32:35], s51 offen lds
  v_mfma_f32_16x16x32_bf16 v[136:139], v[88:91], a[104:107], v[136:139]
  v_mul_f32 v150, v150, v61
  v_mul_f32 v151, v151, v61
  v_cvt_pk_bf16_f32 v168, v144, v145
  v_mfma_f32_16x16x32_bf16 v[128:131], v[92:95], a[112:115], v[128:131]
  v_cvt_pk_bf16_f32 v169, v146, v147
  v_cvt_pk_bf16_f32 v170, v148, v149
  v_cvt_pk_bf16_f32 v171, v150, v151
  v_mfma_f32_16x16x32_bf16 v[132:135], v[92:95], a[116:119], v[132:135]
  v_mul_f32 v152, v152, v62
  v_mul_f32 v153, v153, v62
  v_mul_f32 v154, v154, v62
  v_mfma_f32_16x16x32_bf16 v[136:139], v[92:95], a[120:123], v[136:139]
  v_mul_f32 v155, v155, v62
  v_cvt_pk_bf16_f32 v174, v152, v153
  v_cvt_pk_bf16_f32 v175, v154, v155
  s_waitcnt vmcnt(12) lgkmcnt(0)
  s_barrier
  v_mfma_f32_16x16x32_bf16 v[144:147], v[96:99], v[192:195], 0
  ds_read_b64_tr_b16 v[64:65], v49 offset:32768
  ds_read_b64_tr_b16 v[66:67], v49 offset:34816
  v_mfma_f32_16x16x32_bf16 v[148:151], v[96:99], v[196:199], 0
  buffer_store_dwordx4 v[168:171], v28, s[36:39], s96 offen sc1
  s_add_u32 s96, s96, 16384
  v_mfma_f32_16x16x32_bf16 v[152:155], v[96:99], v[200:203], 0
  ds_read_b64_tr_b16 v[68:69], v49 offset:36864
  ds_read_b64_tr_b16 v[70:71], v49 offset:38912
  v_mfma_f32_16x16x32_bf16 v[144:147], v[100:103], v[208:211], v[144:147]
  buffer_store_dwordx4 v[172:175], v28, s[36:39], s96 offen sc1
  s_add_u32 s96, s96, 114688
  v_mfma_f32_16x16x32_bf16 v[148:151], v[100:103], v[212:215], v[148:151]
  ds_read_b64_tr_b16 v[72:73], v50 offset:32768
  ds_read_b64_tr_b16 v[74:75], v50 offset:34816
  v_mfma_f32_16x16x32_bf16 v[152:155], v[100:103], v[216:219], v[152:155]
  buffer_load_dwordx4 v27, s[32:35], s51 offen offset:1024 lds
  v_mfma_f32_16x16x32_bf16 v[144:147], v[104:107], a[32:35], v[144:147]
  s_add_u32 m0, s46, 6144
  s_add_u32 s51, s12, 29440
  ds_read_b64_tr_b16 v[76:77], v50 offset:36864
  ds_read_b64_tr_b16 v[78:79], v50 offset:38912
  v_mfma_f32_16x16x32_bf16 v[148:151], v[104:107], a[36:39], v[148:151]
  buffer_load_dwordx4 v24, s[32:35], s51 offen lds
  v_mfma_f32_16x16x32_bf16 v[152:155], v[104:107], a[40:43], v[152:155]
  ds_read_b64_tr_b16 v[80:81], v51 offset:32768
  ds_read_b64_tr_b16 v[82:83], v51 offset:34816
  v_mfma_f32_16x16x32_bf16 v[144:147], v[108:111], a[48:51], v[144:147]
  buffer_load_dwordx4 v25, s[32:35], s51 offen offset:1024 lds
  v_mfma_f32_16x16x32_bf16 v[148:151], v[108:111], a[52:55], v[148:151]
  s_add_u32 m0, s46, 20480
  ds_read_b64_tr_b16 v[84:85], v51 offset:36864
  ds_read_b64_tr_b16 v[86:87], v51 offset:38912
  v_mfma_f32_16x16x32_bf16 v[152:155], v[108:111], a[56:59], v[152:155]
  buffer_load_dwordx4 v26, s[32:35], s51 offen lds
  v_mfma_f32_16x16x32_bf16 v[144:147], v[112:115], a[64:67], v[144:147]
  ds_read_b64_tr_b16 v[88:89], v52 offset:32768
  ds_read_b64_tr_b16 v[90:91], v52 offset:34816
  v_mfma_f32_16x16x32_bf16 v[148:151], v[112:115], a[68:71], v[148:151]
  buffer_load_dwordx4 v27, s[32:35], s51 offen offset:1024 lds
  v_mfma_f32_16x16x32_bf16 v[152:155], v[112:115], a[72:75], v[152:155]
  ds_read_b64_tr_b16 v[92:93], v52 offset:36864
  ds_read_b64_tr_b16 v[94:95], v52 offset:38912
  v_mfma_f32_16x16x32_bf16 v[144:147], v[116:119], a[80:83], v[144:147]
  v_mul_f32 v128, v128, v60
  v_mul_f32 v129, v129, v60
  v_mul_f32 v130, v130, v60
  v_mfma_f32_16x16x32_bf16 v[148:151], v[116:119], a[84:87], v[148:151]
  v_mul_f32 v131, v131, v60
  v_mul_f32 v132, v132, v61
  v_mul_f32 v133, v133, v61
  v_mfma_f32_16x16x32_bf16 v[152:155], v[116:119], a[88:91], v[152:155]
  v_mul_f32 v134, v134, v61
  v_mul_f32 v135, v135, v61
  v_cvt_pk_bf16_f32 v176, v128, v129
  v_mfma_f32_16x16x32_bf16 v[144:147], v[120:123], a[96:99], v[144:147]
  v_cvt_pk_bf16_f32 v177, v130, v131
  v_cvt_pk_bf16_f32 v178, v132, v133
  v_cvt_pk_bf16_f32 v179, v134, v135
  v_mfma_f32_16x16x32_bf16 v[148:151], v[120:123], a[100:103], v[148:151]
  buffer_store_dwordx4 v[176:179], v28, s[36:39], s96 offen sc1
  s_add_u32 s96, s96, 131072
  v_mfma_f32_16x16x32_bf16 v[152:155], v[120:123], a[104:107], v[152:155]
  v_mul_f32 v136, v136, v62
  v_mul_f32 v137, v137, v62
  v_mul_f32 v138, v138, v62
  v_mfma_f32_16x16x32_bf16 v[144:147], v[124:127], a[112:115], v[144:147]
  v_mul_f32 v139, v139, v62
  v_cvt_pk_bf16_f32 v188, v136, v137
  v_cvt_pk_bf16_f32 v189, v138, v139
  v_mfma_f32_16x16x32_bf16 v[148:151], v[124:127], a[116:119], v[148:151]
  v_mfma_f32_16x16x32_bf16 v[152:155], v[124:127], a[120:123], v[152:155]
  s_waitcnt vmcnt(11) lgkmcnt(0)
  s_barrier
  v_mfma_f32_16x16x32_bf16 v[128:131], v[64:67], v[192:195], 0
  ds_read_b64_tr_b16 v[96:97], v49 offset:26624
  ds_read_b64_tr_b16 v[98:99], v49 offset:28672
  v_mfma_f32_16x16x32_bf16 v[132:135], v[64:67], v[196:199], 0
  v_mul_f32 v144, v144, v60
  v_mul_f32 v145, v145, v60
  v_mul_f32 v146, v146, v60
  v_mfma_f32_16x16x32_bf16 v[136:139], v[64:67], v[200:203], 0
  ds_read_b64_tr_b16 v[100:101], v49 offset:18432
  ds_read_b64_tr_b16 v[102:103], v49 offset:0
  v_mfma_f32_16x16x32_bf16 v[128:131], v[68:71], v[208:211], v[128:131]
  v_mul_f32 v147, v147, v60
  v_mul_f32 v148, v148, v61
  v_mul_f32 v149, v149, v61
  v_mfma_f32_16x16x32_bf16 v[132:135], v[68:71], v[212:215], v[132:135]
  ds_read_b64_tr_b16 v[104:105], v50 offset:26624
  ds_read_b64_tr_b16 v[106:107], v50 offset:28672
  v_mfma_f32_16x16x32_bf16 v[136:139], v[68:71], v[216:219], v[136:139]
  v_mul_f32 v150, v150, v61
  v_mul_f32 v151, v151, v61
  v_cvt_pk_bf16_f32 v184, v144, v145
  v_mfma_f32_16x16x32_bf16 v[128:131], v[72:75], a[32:35], v[128:131]
  ds_read_b64_tr_b16 v[108:109], v50 offset:18432
  ds_read_b64_tr_b16 v[110:111], v50 offset:0
  v_mfma_f32_16x16x32_bf16 v[132:135], v[72:75], a[36:39], v[132:135]
  v_cvt_pk_bf16_f32 v185, v146, v147
  v_cvt_pk_bf16_f32 v186, v148, v149
  v_cvt_pk_bf16_f32 v187, v150, v151
  v_mfma_f32_16x16x32_bf16 v[136:139], v[72:75], a[40:43], v[136:139]
  ds_read_b64_tr_b16 v[112:113], v51 offset:26624
  ds_read_b64_tr_b16 v[114:115], v51 offset:28672
  v_mfma_f32_16x16x32_bf16 v[128:131], v[76:79], a[48:51], v[128:131]
  buffer_store_dwordx4 v[184:187], v28, s[36:39], s96 offen sc1
  s_add_u32 s96, s96, 16384
  v_mfma_f32_16x16x32_bf16 v[132:135], v[76:79], a[52:55], v[132:135]
  ds_read_b64_tr_b16 v[116:117], v51 offset:18432
  ds_read_b64_tr_b16 v[118:119], v51 offset:0
  v_mfma_f32_16x16x32_bf16 v[136:139], v[76:79], a[56:59], v[136:139]
  v_mul_f32 v152, v152, v62
  v_mul_f32 v153, v153, v62
  v_mul_f32 v154, v154, v62
  v_mfma_f32_16x16x32_bf16 v[128:131], v[80:83], a[64:67], v[128:131]
  ds_read_b64_tr_b16 v[120:121], v52 offset:26624
  ds_read_b64_tr_b16 v[122:123], v52 offset:28672
  v_mfma_f32_16x16x32_bf16 v[132:135], v[80:83], a[68:71], v[132:135]
  v_mul_f32 v155, v155, v62
  v_cvt_pk_bf16_f32 v190, v152, v153
  v_cvt_pk_bf16_f32 v191, v154, v155
  v_mfma_f32_16x16x32_bf16 v[136:139], v[80:83], a[72:75], v[136:139]
  ds_read_b64_tr_b16 v[124:125], v52 offset:18432
  ds_read_b64_tr_b16 v[126:127], v52 offset:0
  v_mfma_f32_16x16x32_bf16 v[128:131], v[84:87], a[80:83], v[128:131]
  buffer_store_dwordx4 v[188:191], v28, s[36:39], s96 offen sc1
  s_add_u32 s96, s96, 114688
  v_mfma_f32_16x16x32_bf16 v[132:135], v[84:87], a[84:87], v[132:135]
  v_mfma_f32_16x16x32_bf16 v[136:139], v[84:87], a[88:91], v[136:139]
  v_mfma_f32_16x16x32_bf16 v[128:131], v[88:91], a[96:99], v[128:131]
  v_mfma_f32_16x16x32_bf16 v[132:135], v[88:91], a[100:103], v[132:135]
  v_mfma_f32_16x16x32_bf16 v[136:139], v[88:91], a[104:107], v[136:139]
  v_mfma_f32_16x16x32_bf16 v[128:131], v[92:95], a[112:115], v[128:131]
  v_mfma_f32_16x16x32_bf16 v[132:135], v[92:95], a[116:119], v[132:135]
  v_mfma_f32_16x16x32_bf16 v[136:139], v[92:95], a[120:123], v[136:139]
  s_waitcnt vmcnt(3) lgkmcnt(0)
  s_barrier
  v_mfma_f32_16x16x32_bf16 v[144:147], v[96:99], v[192:195], 0
  ds_read_b64_tr_b16 v[64:65], v49 offset:2048
  ds_read_b64_tr_b16 v[66:67], v49 offset:4096
  v_mfma_f32_16x16x32_bf16 v[148:151], v[96:99], v[196:199], 0
  v_mul_f32 v128, v128, v60
  v_mul_f32 v129, v129, v60
  v_mul_f32 v130, v130, v60
  v_mfma_f32_16x16x32_bf16 v[152:155], v[96:99], v[200:203], 0
  ds_read_b64_tr_b16 v[68:69], v49 offset:6144
  ds_read_b64_tr_b16 v[70:71], v49 offset:20480
  v_mfma_f32_16x16x32_bf16 v[144:147], v[100:103], v[208:211], v[144:147]
  v_mul_f32 v131, v131, v60
  v_mul_f32 v132, v132, v61
  v_mul_f32 v133, v133, v61
  v_mfma_f32_16x16x32_bf16 v[148:151], v[100:103], v[212:215], v[148:151]
  ds_read_b64_tr_b16 v[72:73], v50 offset:2048
  ds_read_b64_tr_b16 v[74:75], v50 offset:4096
  v_mfma_f32_16x16x32_bf16 v[152:155], v[100:103], v[216:219], v[152:155]
  v_mul_f32 v134, v134, v61
  v_mul_f32 v135, v135, v61
  v_cvt_pk_bf16_f32 v160, v128, v129
  v_mfma_f32_16x16x32_bf16 v[144:147], v[104:107], a[32:35], v[144:147]
  ds_read_b64_tr_b16 v[76:77], v50 offset:6144
  ds_read_b64_tr_b16 v[78:79], v50 offset:20480
  v_mfma_f32_16x16x32_bf16 v[148:151], v[104:107], a[36:39], v[148:151]
  v_cvt_pk_bf16_f32 v161, v130, v131
  v_cvt_pk_bf16_f32 v162, v132, v133
  v_cvt_pk_bf16_f32 v163, v134, v135
  v_mfma_f32_16x16x32_bf16 v[152:155], v[104:107], a[40:43], v[152:155]
  ds_read_b64_tr_b16 v[80:81], v51 offset:2048
  ds_read_b64_tr_b16 v[82:83], v51 offset:4096
  v_mfma_f32_16x16x32_bf16 v[144:147], v[108:111], a[48:51], v[144:147]
  buffer_store_dwordx4 v[160:163], v28, s[36:39], s96 offen sc1
  s_add_u32 s96, s96, 131072
  v_mfma_f32_16x16x32_bf16 v[148:151], v[108:111], a[52:55], v[148:151]
  ds_read_b64_tr_b16 v[84:85], v51 offset:6144
  ds_read_b64_tr_b16 v[86:87], v51 offset:20480
  v_mfma_f32_16x16x32_bf16 v[152:155], v[108:111], a[56:59], v[152:155]
  v_mul_f32 v136, v136, v62
  v_mul_f32 v137, v137, v62
  v_mul_f32 v138, v138, v62
  v_mfma_f32_16x16x32_bf16 v[144:147], v[112:115], a[64:67], v[144:147]
  ds_read_b64_tr_b16 v[88:89], v52 offset:2048
  ds_read_b64_tr_b16 v[90:91], v52 offset:4096
  v_mfma_f32_16x16x32_bf16 v[148:151], v[112:115], a[68:71], v[148:151]
  v_mul_f32 v139, v139, v62
  v_cvt_pk_bf16_f32 v172, v136, v137
  v_cvt_pk_bf16_f32 v173, v138, v139
  v_mfma_f32_16x16x32_bf16 v[152:155], v[112:115], a[72:75], v[152:155]
  ds_read_b64_tr_b16 v[92:93], v52 offset:6144
  ds_read_b64_tr_b16 v[94:95], v52 offset:20480
  v_mfma_f32_16x16x32_bf16 v[144:147], v[116:119], a[80:83], v[144:147]
  v_mfma_f32_16x16x32_bf16 v[148:151], v[116:119], a[84:87], v[148:151]
  v_mfma_f32_16x16x32_bf16 v[152:155], v[116:119], a[88:91], v[152:155]
  v_mfma_f32_16x16x32_bf16 v[144:147], v[120:123], a[96:99], v[144:147]
  v_mfma_f32_16x16x32_bf16 v[148:151], v[120:123], a[100:103], v[148:151]
  v_mfma_f32_16x16x32_bf16 v[152:155], v[120:123], a[104:107], v[152:155]
  v_mfma_f32_16x16x32_bf16 v[144:147], v[124:127], a[112:115], v[144:147]
  v_mfma_f32_16x16x32_bf16 v[148:151], v[124:127], a[116:119], v[148:151]
  v_mfma_f32_16x16x32_bf16 v[152:155], v[124:127], a[120:123], v[152:155]
  s_waitcnt vmcnt(1) lgkmcnt(0)
  s_barrier
  v_mfma_f32_16x16x32_bf16 v[128:131], v[64:67], v[192:195], 0
  v_mfma_f32_16x16x32_bf16 v[132:135], v[64:67], v[196:199], 0
  s_mov_b64 exec, s[14:15]
  buffer_store_dwordx2 v[4:5], v9, s[36:39], s3 offen sc1
  s_mov_b64 exec, -1
  s_add_u32 s3, s3, 32768
  v_mfma_f32_16x16x32_bf16 v[136:139], v[64:67], v[200:203], 0
  v_mul_f32 v144, v144, v60
  v_mul_f32 v145, v145, v60
  v_mul_f32 v146, v146, v60
  v_mfma_f32_16x16x32_bf16 v[128:131], v[68:71], v[208:211], v[128:131]
  v_mul_f32 v147, v147, v60
  v_mul_f32 v148, v148, v61
  v_mul_f32 v149, v149, v61
  v_mfma_f32_16x16x32_bf16 v[132:135], v[68:71], v[212:215], v[132:135]
  v_mul_f32 v150, v150, v61
  v_mul_f32 v151, v151, v61
  v_cvt_pk_bf16_f32 v168, v144, v145
  v_mfma_f32_16x16x32_bf16 v[136:139], v[68:71], v[216:219], v[136:139]
  v_cvt_pk_bf16_f32 v169, v146, v147
  v_cvt_pk_bf16_f32 v170, v148, v149
  v_cvt_pk_bf16_f32 v171, v150, v151
  v_mfma_f32_16x16x32_bf16 v[128:131], v[72:75], a[32:35], v[128:131]
  buffer_store_dwordx4 v[168:171], v28, s[36:39], s96 offen sc1
  s_add_u32 s96, s96, 16384
  v_mfma_f32_16x16x32_bf16 v[132:135], v[72:75], a[36:39], v[132:135]
  v_mul_f32 v152, v152, v62
  v_mul_f32 v153, v153, v62
  v_mul_f32 v154, v154, v62
  v_mfma_f32_16x16x32_bf16 v[136:139], v[72:75], a[40:43], v[136:139]
  v_mul_f32 v155, v155, v62
  v_cvt_pk_bf16_f32 v174, v152, v153
  v_cvt_pk_bf16_f32 v175, v154, v155
  v_mfma_f32_16x16x32_bf16 v[128:131], v[76:79], a[48:51], v[128:131]
  buffer_store_dwordx4 v[172:175], v28, s[36:39], s96 offen sc1
  s_add_u32 s96, s96, 114688
  v_mfma_f32_16x16x32_bf16 v[132:135], v[76:79], a[52:55], v[132:135]
  v_mfma_f32_16x16x32_bf16 v[136:139], v[76:79], a[56:59], v[136:139]
  v_mfma_f32_16x16x32_bf16 v[128:131], v[80:83], a[64:67], v[128:131]
  v_mfma_f32_16x16x32_bf16 v[132:135], v[80:83], a[68:71], v[132:135]
  v_mfma_f32_16x16x32_bf16 v[136:139], v[80:83], a[72:75], v[136:139]
  v_mfma_f32_16x16x32_bf16 v[128:131], v[84:87], a[80:83], v[128:131]
  v_mfma_f32_16x16x32_bf16 v[132:135], v[84:87], a[84:87], v[132:135]
  v_mfma_f32_16x16x32_bf16 v[136:139], v[84:87], a[88:91], v[136:139]
  v_mfma_f32_16x16x32_bf16 v[128:131], v[88:91], a[96:99], v[128:131]
  v_mfma_f32_16x16x32_bf16 v[132:135], v[88:91], a[100:103], v[132:135]
  v_mfma_f32_16x16x32_bf16 v[136:139], v[88:91], a[104:107], v[136:139]
  v_mfma_f32_16x16x32_bf16 v[128:131], v[92:95], a[112:115], v[128:131]
  v_mfma_f32_16x16x32_bf16 v[132:135], v[92:95], a[116:119], v[132:135]
  v_mfma_f32_16x16x32_bf16 v[136:139], v[92:95], a[120:123], v[136:139]
  s_nop 5
  v_mul_f32 v128, v128, v60
  v_mul_f32 v129, v129, v60
  v_mul_f32 v130, v130, v60
  v_mul_f32 v131, v131, v60
  v_mul_f32 v132, v132, v61
  v_mul_f32 v133, v133, v61
  v_mul_f32 v134, v134, v61
  v_mul_f32 v135, v135, v61
  v_cvt_pk_bf16_f32 v176, v128, v129
  v_cvt_pk_bf16_f32 v177, v130, v131
  v_cvt_pk_bf16_f32 v178, v132, v133
  v_cvt_pk_bf16_f32 v179, v134, v135
  buffer_store_dwordx4 v[176:179], v28, s[36:39], s96 offen sc1
  s_add_u32 s96, s96, 16384
  v_mul_f32 v136, v136, v62
  v_mul_f32 v137, v137, v62
  v_mul_f32 v138, v138, v62
  v_mul_f32 v139, v139, v62
  v_cvt_pk_bf16_f32 v180, v136, v137
  v_cvt_pk_bf16_f32 v181, v138, v139
  buffer_store_dwordx4 v[180:183], v28, s[36:39], s96 offen sc1
  s_add_u32 s96, s96, 114688
L_tail:
  v_and_b32 v106, 32, v1
  s_bfe_u32 s52, s47, 0x10001
  s_and_b32 s52, s52, s43
  s_bfe_u32 s53, s47, 0x10004
  s_andn2_b32 s56, s52, s53
  s_and_b32 s52, s52, s53
  s_lshl_b32 s53, s52, 7
  s_sub_u32 s99, s99, s53
  s_mul_i32 s52, s52, -444
  s_lshl_b32 s53, s56, 20
  s_add_u32 s52, s52, s53
  v_mul_lo_u32 v104, s52, v106
  v_add_u32 v104, v6, v104
  s_bfe_u32 s52, s48, 0x10001
  s_and_b32 s52, s52, s43
  s_bfe_u32 s53, s48, 0x10004
  s_andn2_b32 s57, s52, s53
  s_and_b32 s52, s52, s53
  s_lshl_b32 s53, s52, 7
  s_sub_u32 s100, s100, s53
  s_mul_i32 s52, s52, -444
  s_lshl_b32 s53, s57, 20
  s_add_u32 s52, s52, s53
  v_mul_lo_u32 v105, s52, v106
  v_add_u32 v105, v6, v105
  s_lshl_b32 s53, s56, 25
  s_add_u32 s99, s99, s53
  s_cmp_ge_u32 s48, 96
  s_cselect_b32 s57, 0, s57
  s_cmp_ge_u32 s48, 112
  s_cselect_b32 s57, 1, s57
  s_mov_b32 s52, 0xffff0000
  buffer_load_dwordx2 v[96:97], v7, s[36:39], s101 offen sc1
  s_waitcnt vmcnt(1)
  s_barrier
  s_mov_b64 exec, s[14:15]
  buffer_store_dwordx2 v[4:5], v9, s[36:39], s3 offen sc1
  s_mov_b64 exec, -1
  s_add_u32 s3, s3, 32768
  s_cmp_lg_u32 s56, 0
  s_cbranch_scc1 L_skipA
  s_waitcnt vmcnt(1)
L_pollA:
  v_cmp_eq_u64 vcc, v[96:97], v[4:5]
  s_sub_u32 s50, s50, 1
  s_cmp_lt_i32 s50, 1
  s_cbranch_scc1 L_goA
  s_cmp_eq_u64 vcc, exec
  s_cbranch_scc1 L_goA
  buffer_load_dwordx2 v[96:97], v7, s[36:39], s101 offen sc1
  s_waitcnt vmcnt(0)
  s_branch L_pollA
L_goA:
  buffer_load_dwordx4 v[192:195], v30, s[36:39], s97 offen sc1
  s_add_u32 s97, s97, 2048
  buffer_load_dwordx4 v[196:199], v30, s[36:39], s97 offen sc1
  s_add_u32 s97, s97, 2048
  buffer_load_dwordx4 v[200:203], v30, s[36:39], s97 offen sc1
  s_add_u32 s97, s97, 2048
  buffer_load_dwordx4 v[204:207], v30, s[36:39], s97 offen sc1
  s_add_u32 s97, s97, 2048
  buffer_load_dwordx4 v[208:211], v30, s[36:39], s97 offen sc1
  s_add_u32 s97, s97, 2048
  buffer_load_dwordx4 v[212:215], v30, s[36:39], s97 offen sc1
  s_add_u32 s97, s97, 2048
  buffer_load_dwordx4 v[216:219], v30, s[36:39], s97 offen sc1
  s_add_u32 s97, s97, 2048
  buffer_load_dwordx4 v[220:223], v30, s[36:39], s97 offen sc1
L_redA:
  buffer_load_dwordx2 v[98:99], v7, s[36:39], s59 offen sc1
  s_waitcnt vmcnt(8)
  v_lshlrev_b32 v64, 16, v192
  v_and_b32 v65, s52, v192
  v_lshlrev_b32 v66, 16, v193
  v_and_b32 v67, s52, v193
  v_lshlrev_b32 v68, 16, v194
  v_and_b32 v69, s52, v194
  v_lshlrev_b32 v70, 16, v195
  v_and_b32 v71, s52, v195
  s_waitcnt vmcnt(7)
  v_lshlrev_b32 v72, 16, v196
  v_and_b32 v73, s52, v196
  v_pk_add_f32 v[64:65], v[64:65], v[72:73]
  v_lshlrev_b32 v72, 16, v197
  v_and_b32 v73, s52, v197
  v_pk_add_f32 v[66:67], v[66:67], v[72:73]
  v_lshlrev_b32 v72, 16, v198
  v_and_b32 v73, s52, v198
  v_pk_add_f32 v[68:69], v[68:69], v[72:73]
  v_lshlrev_b32 v72, 16, v199
  v_and_b32 v73, s52, v199
  v_pk_add_f32 v[70:71], v[70:71], v[72:73]
  s_waitcnt vmcnt(6)
  v_lshlrev_b32 v72, 16, v200
  v_and_b32 v73, s52, v200
  v_pk_add_f32 v[64:65], v[64:65], v[72:73]
  v_lshlrev_b32 v72, 16, v201
  v_and_b32 v73, s52, v201
  v_pk_add_f32 v[66:67], v[66:67], v[72:73]
  v_lshlrev_b32 v72, 16, v202
  v_and_b32 v73, s52, v202
  v_pk_add_f32 v[68:69], v[68:69], v[72:73]
  v_lshlrev_b32 v72, 16, v203
  v_and_b32 v73, s52, v203
  v_pk_add_f32 v[70:71], v[70:71], v[72:73]
  s_waitcnt vmcnt(5)
  v_lshlrev_b32 v72, 16, v204
  v_and_b32 v73, s52, v204
  v_pk_add_f32 v[64:65], v[64:65], v[72:73]
  v_lshlrev_b32 v72, 16, v205
  v_and_b32 v73, s52, v205
  v_pk_add_f32 v[66:67], v[66:67], v[72:73]
  v_lshlrev_b32 v72, 16, v206
  v_and_b32 v73, s52, v206
  v_pk_add_f32 v[68:69], v[68:69], v[72:73]
  v_lshlrev_b32 v72, 16, v207
  v_and_b32 v73, s52, v207
  v_pk_add_f32 v[70:71], v[70:71], v[72:73]
  s_waitcnt vmcnt(4)
  v_lshlrev_b32 v72, 16, v208
  v_and_b32 v73, s52, v208
  v_pk_add_f32 v[64:65], v[64:65], v[72:73]
  v_lshlrev_b32 v72, 16, v209
  v_and_b32 v73, s52, v209
  v_pk_add_f32 v[66:67], v[66:67], v[72:73]
  v_lshlrev_b32 v72, 16, v210
  v_and_b32 v73, s52, v210
  v_pk_add_f32 v[68:69], v[68:69], v[72:73]
  v_lshlrev_b32 v72, 16, v211
  v_and_b32 v73, s52, v211
  v_pk_add_f32 v[70:71], v[70:71], v[72:73]
  s_waitcnt vmcnt(3)
  v_lshlrev_b32 v72, 16, v212
  v_and_b32 v73, s52, v212
  v_pk_add_f32 v[64:65], v[64:65], v[72:73]
  v_lshlrev_b32 v72, 16, v213
  v_and_b32 v73, s52, v213
  v_pk_add_f32 v[66:67], v[66:67], v[72:73]
  v_lshlrev_b32 v72, 16, v214
  v_and_b32 v73, s52, v214
  v_pk_add_f32 v[68:69], v[68:69], v[72:73]
  v_lshlrev_b32 v72, 16, v215
  v_and_b32 v73, s52, v215
  v_pk_add_f32 v[70:71], v[70:71], v[72:73]
  s_waitcnt vmcnt(2)
  v_lshlrev_b32 v72, 16, v216
  v_and_b32 v73, s52, v216
  v_pk_add_f32 v[64:65], v[64:65], v[72:73]
  v_lshlrev_b32 v72, 16, v217
  v_and_b32 v73, s52, v217
  v_pk_add_f32 v[66:67], v[66:67], v[72:73]
  v_lshlrev_b32 v72, 16, v218
  v_and_b32 v73, s52, v218
  v_pk_add_f32 v[68:69], v[68:69], v[72:73]
  v_lshlrev_b32 v72, 16, v219
  v_and_b32 v73, s52, v219
  v_pk_add_f32 v[70:71], v[70:71], v[72:73]
  s_waitcnt vmcnt(1)
  v_lshlrev_b32 v72, 16, v220
  v_and_b32 v73, s52, v220
  v_pk_add_f32 v[64:65], v[64:65], v[72:73]
  v_lshlrev_b32 v72, 16, v221
  v_and_b32 v73, s52, v221
  v_pk_add_f32 v[66:67], v[66:67], v[72:73]
  v_lshlrev_b32 v72, 16, v222
  v_and_b32 v73, s52, v222
  v_pk_add_f32 v[68:69], v[68:69], v[72:73]
  v_lshlrev_b32 v72, 16, v223
  v_and_b32 v73, s52, v223
  v_pk_add_f32 v[70:71], v[70:71], v[72:73]
  s_nop 1
  v_permlane32_swap_b32 v64, v68
  v_permlane32_swap_b32 v65, v69
  v_permlane32_swap_b32 v66, v70
  v_permlane32_swap_b32 v67, v71
  s_nop 0
  v_pk_add_f32 v[64:65], v[64:65], v[68:69]
  v_pk_add_f32 v[66:67], v[66:67], v[70:71]
  v_cvt_pk_bf16_f32 v74, v64, v65
  v_cvt_pk_bf16_f32 v75, v66, v67
  s_cmp_lg_u32 s57, 0
  s_cbranch_scc0 L_doB
  buffer_store_dwordx2 v[74:75], v104, s[76:79], s99 offen
  s_branch L_fin
L_noncea:
  s_sub_u32 s50, s50, 1
  s_cmp_lt_i32 s50, 1
  s_cbranch_scc1 L_havenoncea
  buffer_load_dwordx2 v[4:5], v8, s[80:83], 0 offen sc1
  s_waitcnt vmcnt(0)
  v_readfirstlane_b32 s52, v5
  s_nop 0
  s_cmp_eq_u32 s52, 1
  s_cbranch_scc1 L_havenoncea
  s_branch L_noncea
L_nonceb:
  s_sub_u32 s50, s50, 1
  s_cmp_lt_i32 s50, 1
  s_cbranch_scc1 L_havenonceb
  buffer_load_dwordx2 v[4:5], v8, s[80:83], 0 offen sc1
  s_waitcnt vmcnt(0)
  v_readfirstlane_b32 s52, v5
  s_nop 0
  s_cmp_eq_u32 s52, 1
  s_cbranch_scc1 L_havenonceb
  s_branch L_nonceb
L_skipA:
  s_cmp_lg_u32 s57, 0
  s_cbranch_scc1 L_fin
  buffer_load_dwordx2 v[98:99], v7, s[36:39], s59 offen sc1
L_doB:
  s_waitcnt vmcnt(0)
L_pollB:
  v_cmp_eq_u64 vcc, v[98:99], v[4:5]
  s_sub_u32 s50, s50, 1
  s_cmp_lt_i32 s50, 1
  s_cbranch_scc1 L_goB
  s_cmp_eq_u64 vcc, exec
  s_cbranch_scc1 L_goB
  buffer_load_dwordx2 v[98:99], v7, s[36:39], s59 offen sc1
  s_waitcnt vmcnt(0)
  s_branch L_pollB
L_goB:
  buffer_load_dwordx4 v[192:195], v30, s[36:39], s98 offen sc1
  s_add_u32 s98, s98, 2048
  buffer_load_dwordx4 v[196:199], v30, s[36:39], s98 offen sc1
  s_add_u32 s98, s98, 2048
  buffer_load_dwordx4 v[200:203], v30, s[36:39], s98 offen sc1
  s_add_u32 s98, s98, 2048
  buffer_load_dwordx4 v[204:207], v30, s[36:39], s98 offen sc1
  s_add_u32 s98, s98, 2048
  buffer_load_dwordx4 v[208:211], v30, s[36:39], s98 offen sc1
  s_add_u32 s98, s98, 2048
  buffer_load_dwordx4 v[212:215], v30, s[36:39], s98 offen sc1
  s_add_u32 s98, s98, 2048
  buffer_load_dwordx4 v[216:219], v30, s[36:39], s98 offen sc1
  s_add_u32 s98, s98, 2048
  buffer_load_dwordx4 v[220:223], v30, s[36:39], s98 offen sc1
  buffer_store_dwordx2 v[74:75], v104, s[76:79], s99 offen
  s_waitcnt vmcnt(8)
  v_lshlrev_b32 v80, 16, v192
  v_and_b32 v81, s52, v192
  v_lshlrev_b32 v82, 16, v193
  v_and_b32 v83, s52, v193
  v_lshlrev_b32 v84, 16, v194
  v_and_b32 v85, s52, v194
  v_lshlrev_b32 v86, 16, v195
  v_and_b32 v87, s52, v195
  s_waitcnt vmcnt(7)
  v_lshlrev_b32 v88, 16, v196
  v_and_b32 v89, s52, v196
  v_pk_add_f32 v[80:81], v[80:81], v[88:89]
  v_lshlrev_b32 v88, 16, v197
  v_and_b32 v89, s52, v197
  v_pk_add_f32 v[82:83], v[82:83], v[88:89]
  v_lshlrev_b32 v88, 16, v198
  v_and_b32 v89, s52, v198
  v_pk_add_f32 v[84:85], v[84:85], v[88:89]
  v_lshlrev_b32 v88, 16, v199
  v_and_b32 v89, s52, v199
  v_pk_add_f32 v[86:87], v[86:87], v[88:89]
  s_waitcnt vmcnt(6)
  v_lshlrev_b32 v88, 16, v200
  v_and_b32 v89, s52, v200
  v_pk_add_f32 v[80:81], v[80:81], v[88:89]
  v_lshlrev_b32 v88, 16, v201
  v_and_b32 v89, s52, v201
  v_pk_add_f32 v[82:83], v[82:83], v[88:89]
  v_lshlrev_b32 v88, 16, v202
  v_and_b32 v89, s52, v202
  v_pk_add_f32 v[84:85], v[84:85], v[88:89]
  v_lshlrev_b32 v88, 16, v203
  v_and_b32 v89, s52, v203
  v_pk_add_f32 v[86:87], v[86:87], v[88:89]
  s_waitcnt vmcnt(5)
  v_lshlrev_b32 v88, 16, v204
  v_and_b32 v89, s52, v204
  v_pk_add_f32 v[80:81], v[80:81], v[88:89]
  v_lshlrev_b32 v88, 16, v205
  v_and_b32 v89, s52, v205
  v_pk_add_f32 v[82:83], v[82:83], v[88:89]
  v_lshlrev_b32 v88, 16, v206
  v_and_b32 v89, s52, v206
  v_pk_add_f32 v[84:85], v[84:85], v[88:89]
  v_lshlrev_b32 v88, 16, v207
  v_and_b32 v89, s52, v207
  v_pk_add_f32 v[86:87], v[86:87], v[88:89]
  s_waitcnt vmcnt(4)
  v_lshlrev_b32 v88, 16, v208
  v_and_b32 v89, s52, v208
  v_pk_add_f32 v[80:81], v[80:81], v[88:89]
  v_lshlrev_b32 v88, 16, v209
  v_and_b32 v89, s52, v209
  v_pk_add_f32 v[82:83], v[82:83], v[88:89]
  v_lshlrev_b32 v88, 16, v210
  v_and_b32 v89, s52, v210
  v_pk_add_f32 v[84:85], v[84:85], v[88:89]
  v_lshlrev_b32 v88, 16, v211
  v_and_b32 v89, s52, v211
  v_pk_add_f32 v[86:87], v[86:87], v[88:89]
  s_waitcnt vmcnt(3)
  v_lshlrev_b32 v88, 16, v212
  v_and_b32 v89, s52, v212
  v_pk_add_f32 v[80:81], v[80:81], v[88:89]
  v_lshlrev_b32 v88, 16, v213
  v_and_b32 v89, s52, v213
  v_pk_add_f32 v[82:83], v[82:83], v[88:89]
  v_lshlrev_b32 v88, 16, v214
  v_and_b32 v89, s52, v214
  v_pk_add_f32 v[84:85], v[84:85], v[88:89]
  v_lshlrev_b32 v88, 16, v215
  v_and_b32 v89, s52, v215
  v_pk_add_f32 v[86:87], v[86:87], v[88:89]
  s_waitcnt vmcnt(2)
  v_lshlrev_b32 v88, 16, v216
  v_and_b32 v89, s52, v216
  v_pk_add_f32 v[80:81], v[80:81], v[88:89]
  v_lshlrev_b32 v88, 16, v217
  v_and_b32 v89, s52, v217
  v_pk_add_f32 v[82:83], v[82:83], v[88:89]
  v_lshlrev_b32 v88, 16, v218
  v_and_b32 v89, s52, v218
  v_pk_add_f32 v[84:85], v[84:85], v[88:89]
  v_lshlrev_b32 v88, 16, v219
  v_and_b32 v89, s52, v219
  v_pk_add_f32 v[86:87], v[86:87], v[88:89]
  s_waitcnt vmcnt(1)
  v_lshlrev_b32 v88, 16, v220
  v_and_b32 v89, s52, v220
  v_pk_add_f32 v[80:81], v[80:81], v[88:89]
  v_lshlrev_b32 v88, 16, v221
  v_and_b32 v89, s52, v221
  v_pk_add_f32 v[82:83], v[82:83], v[88:89]
  v_lshlrev_b32 v88, 16, v222
  v_and_b32 v89, s52, v222
  v_pk_add_f32 v[84:85], v[84:85], v[88:89]
  v_lshlrev_b32 v88, 16, v223
  v_and_b32 v89, s52, v223
  v_pk_add_f32 v[86:87], v[86:87], v[88:89]
  s_nop 1
  v_permlane32_swap_b32 v80, v84
  v_permlane32_swap_b32 v81, v85
  v_permlane32_swap_b32 v82, v86
  v_permlane32_swap_b32 v83, v87
  s_nop 0
  v_pk_add_f32 v[80:81], v[80:81], v[84:85]
  v_pk_add_f32 v[82:83], v[82:83], v[86:87]
  v_cvt_pk_bf16_f32 v90, v80, v81
  v_cvt_pk_bf16_f32 v91, v82, v83
  buffer_store_dwordx2 v[90:91], v105, s[76:79], s100 offen
L_fin:
L_end:
  s_endpgm
.section .rodata,"a"
.p2align 6
.amdhsa_kernel standalone__gqa_block_cached__near_ridge_kernel
  .amdhsa_next_free_vgpr 400
  .amdhsa_next_free_sgpr 102
  .amdhsa_accum_offset 256
  .amdhsa_group_segment_fixed_size 0
  .amdhsa_kernarg_size 64
  .amdhsa_user_sgpr_count 2
  .amdhsa_user_sgpr_kernarg_segment_ptr 1
  .amdhsa_system_sgpr_workgroup_id_x 1
.end_amdhsa_kernel
```
